```python
import torch

def _softmax(x, axis=-1):
    return torch.softmax(x, dim=axis)
def _gelu(x):
    return torch.nn.functional.gelu(x, approximate="tanh")
def _silu(x):
    return torch.nn.functional.silu(x)
def _sigmoid(x):
    return torch.sigmoid(x)
def _layernorm(x, axis=-1, eps=1e-5):
    m = x.mean(dim=axis, keepdim=True)
    v = x.var(dim=axis, keepdim=True, unbiased=False)
    return (x - m) / torch.sqrt(v + eps)
def _scatter_add(tgt, idx, src, axis=0):
    return tgt.clone().index_add_(axis, idx, src)
def _segment_sum(src, seg, n):
    out = torch.zeros((n,) + src.shape[1:], dtype=src.dtype)
    return out.index_add_(0, seg, src)
def _pad(x, pw):
    flat = tuple(v for pair in reversed(pw) for v in pair)
    return torch.nn.functional.pad(x, flat)

kernel_name = 'parallel_sum__sliding_local_dilated__dense_activation_gelu__prompt'

def setup_inputs():

    _w = (lambda a: (lambda t: t.to(torch.bfloat16) if t.is_floating_point() else t)(torch.as_tensor(a)))
    def _A_setup():
        B, S, D = 1, 2048, 448
        return {
            "x": _w((lambda *s: torch.randn(*s, dtype=torch.bfloat16) * 0.05)(B, S, D)),
            "wqkv": _w((lambda *s: torch.randn(*s, dtype=torch.bfloat16) * 0.05)(D, 3 * D)),
            "wo": _w((lambda *s: torch.randn(*s, dtype=torch.bfloat16) * 0.05)(D, D)),
        }
    _A_in = _A_setup()

    def _B_setup():
        B, S, D, F = 1, 2048, 448, 1792
        return {
            "x": _w((lambda *s: torch.randn(*s, dtype=torch.bfloat16) * 0.05)(B, S, D)),
            "w1": _w((lambda *s: torch.randn(*s, dtype=torch.bfloat16) * 0.8)(D, F) * (D ** -0.5)),
            "b1": _w((lambda *s: torch.randn(*s, dtype=torch.bfloat16) * 0.8)(F) * 0.01),
            "w2": _w((lambda *s: torch.randn(*s, dtype=torch.bfloat16) * 0.8)(F, D) * (F ** -0.5)),
            "b2": _w((lambda *s: torch.randn(*s, dtype=torch.bfloat16) * 0.8)(D) * 0.01),
        }
    _B_in = _B_setup()

    return {
        "A_x": _A_in["x"],
        "A_wqkv": _A_in["wqkv"],
        "A_wo": _A_in["wo"],
        "B_x": _B_in["x"],
        "B_w1": _B_in["w1"],
        "B_b1": _B_in["b1"],
        "B_w2": _B_in["w2"],
        "B_b2": _B_in["b2"],
    }

def reference(A_x, A_wqkv, A_wo, B_x, B_w1, B_b1, B_w2, B_b2):
    def _A_ref(x, wqkv, wo):
        B, S, D = x.shape
        H = 16; Dh = D // H
        W, dil = 8, 2
        qkv = (lambda x, *d: x.permute(*d))((x @ wqkv).reshape(B, S, 3, H, Dh), 2, 0, 3, 1, 4)
        q, k, v = qkv[0], qkv[1], qkv[2]
        scale = Dh ** -0.5
        pos = torch.arange(S)
        off = torch.arange(W) * dil
        idx = pos[:, None] - off[None, :]
        mask = idx >= 0
        idx_c = torch.where(mask, idx, 0).reshape(-1)
        kg = k[:, :, idx_c, :].reshape(B, H, S, W, Dh)
        vg = v[:, :, idx_c, :].reshape(B, H, S, W, Dh)
        logits = torch.einsum("bhsd,bhswd->bhsw", q, kg) * scale
        logits = torch.where(mask[None, None, :, :], logits, -1e9)
        attn = _softmax(logits, axis=-1)
        o = torch.einsum("bhsw,bhswd->bhsd", attn, vg)
        return (lambda x, *d: x.permute(*d))(o, 0, 2, 1, 3).reshape(B, S, D) @ wo

    def _B_ref(x, w1, b1, w2, b2):
        h = torch.einsum("bsd,df->bsf", x, w1) + b1
        h = _gelu(h)
        return torch.einsum("bsf,fd->bsd", h, w2) + b2

    x = A_x
    xn = _layernorm(x, axis=-1)
    return x + _A_ref(xn, A_wqkv, A_wo) + _B_ref(xn, B_w1, B_b1, B_w2, B_b2)
```

```asm
; @launch grid=(256,1,1) block=(512,1,1) lds=163840
.amdgcn_target "amdgcn-amd-amdhsa--gfx950"
.text
.globl parallel_sum__sliding_local_dilated__dense_activation_gelu__prompt_kernel
.p2align 8
.type parallel_sum__sliding_local_dilated__dense_activation_gelu__prompt_kernel,@function
parallel_sum__sliding_local_dilated__dense_activation_gelu__prompt_kernel:
    s_load_dwordx2 s[36:37], s[0:1], 0
    s_cmp_ge_u32 s2, 256
    s_cbranch_scc1 L_end
    s_lshr_b32 s28, s2, 3
    s_getpc_b64 s[40:41]
L_pc:
    v_lshrrev_b32 v4, 5, v0
    v_lshl_add_u32 v4, v4, 5, s28
    v_lshlrev_b32 v4, 7, v4
    v_min_u32 v4, L_end-L_pc, v4
    s_mov_b32 exec_lo, 1
    s_mov_b32 exec_hi, 1
    global_load_dword v255, v4, s[40:41]
    s_mov_b64 exec, -1
    s_bitcmp1_b32 s2, 7
    s_cselect_b32 s31, s2, s28
    s_cselect_b32 s26, s28, s2
    s_and_b32 s31, s31, 1
    s_lshr_b32 s32, s2, 1
    s_and_b32 s32, s32, 2
    s_or_b32 s31, s31, s32
    s_bfe_u32 s32, s2, 0x30004
    s_lshl3_add_u32 s27, s31, s32
    s_mul_i32 s59, s27, 57344
    v_lshrrev_b32 v1, 3, v0
    v_and_b32 v2, 7, v0
    v_lshlrev_b32 v2, 4, v2
    v_mul_u32_u24 v3, 896, v1
    v_add_u32 v3, v3, v2
    s_mov_b32 s38, 1835008
    s_mov_b32 s39, 0x20000
    s_waitcnt lgkmcnt(0)
    buffer_load_dwordx4 v[32:35], v3, s[36:39], s59 offen offset:0
    buffer_load_dwordx4 v[36:39], v3, s[36:39], s59 offen offset:128
    buffer_load_dwordx4 v[40:43], v3, s[36:39], s59 offen offset:256
    buffer_load_dwordx4 v[44:47], v3, s[36:39], s59 offen offset:384
    buffer_load_dwordx4 v[48:51], v3, s[36:39], s59 offen offset:512
    buffer_load_dwordx4 v[52:55], v3, s[36:39], s59 offen offset:640
    buffer_load_dwordx4 v[56:59], v3, s[36:39], s59 offen offset:768
    s_load_dwordx16 s[4:19], s[0:1], 0
    s_load_dwordx4 s[20:23], s[0:1], 64
    s_load_dwordx2 s[24:25], s[0:1], 80
    v_lshrrev_b32 v4, 6, v0
    s_nop 0
    v_readfirstlane_b32 s3, v4
    v_and_b32 v0, 63, v0
    s_and_b32 s26, s26, 1
    s_and_b32 s31, s2, 2
    s_or_b32 s26, s26, s31
    s_and_b32 s28, s28, 15
    s_mov_b32 s29, 0x3f803f80
    s_mov_b32 s30, 0xffff0000
    s_mul_i32 s31, s28, 9363
    s_lshr_b32 s31, s31, 16
    s_mul_i32 s33, s31, 7
    s_sub_u32 s63, s28, s33
    s_mul_i32 s31, s31, 3
    s_cmp_eq_u32 s32, 7
    s_cselect_b32 s32, 3, s32
    s_cmp_ge_u32 s2, 128
    s_cselect_b32 s31, s32, s31
    s_cselect_b32 s33, 16, 0
    s_add_u32 s33, s33, 912
    s_lshl_b32 s97, s31, 7
    s_add_u32 s98, s97, 128
    s_cmp_eq_u32 s98, 896
    s_cselect_b32 s98, 0, s98
    s_add_u32 s99, s98, 128
    s_cmp_eq_u32 s99, 896
    s_cselect_b32 s99, 0, s99
    s_add_u32 s100, s99, 128
    s_cmp_eq_u32 s100, 896
    s_cselect_b32 s100, 0, s100
    s_add_u32 s101, s100, 128
    s_cmp_eq_u32 s101, 896
    s_cselect_b32 s101, 0, s101
    s_add_u32 s61, s101, 128
    s_cmp_eq_u32 s61, 896
    s_cselect_b32 s61, 0, s61
    s_add_u32 s62, s61, 128
    s_cmp_eq_u32 s62, 896
    s_cselect_b32 s62, 0, s62
    v_mad_u32_u24 v4, v1, s33, v2
    s_sub_u32 s31, 0, s97
    s_cselect_b32 s32, 896, 0
    s_add_u32 s31, s31, s32
    v_add_u32 v100, s31, v4
    s_sub_u32 s31, 128, s97
    s_cselect_b32 s32, 896, 0
    s_add_u32 s31, s31, s32
    v_add_u32 v101, s31, v4
    s_sub_u32 s31, 256, s97
    s_cselect_b32 s32, 896, 0
    s_add_u32 s31, s31, s32
    v_add_u32 v102, s31, v4
    s_sub_u32 s31, 384, s97
    s_cselect_b32 s32, 896, 0
    s_add_u32 s31, s31, s32
    v_add_u32 v103, s31, v4
    s_sub_u32 s31, 512, s97
    s_cselect_b32 s32, 896, 0
    s_add_u32 s31, s31, s32
    v_add_u32 v104, s31, v4
    s_sub_u32 s31, 640, s97
    s_cselect_b32 s32, 896, 0
    s_add_u32 s31, s31, s32
    v_add_u32 v105, s31, v4
    s_sub_u32 s31, 768, s97
    s_cselect_b32 s32, 896, 0
    s_add_u32 s31, s31, s32
    v_add_u32 v106, s31, v4
    s_waitcnt lgkmcnt(0)
    s_lshl_b32 s31, s27, 20
    s_add_u32 s48, s24, s31
    s_addc_u32 s49, s25, 0
    s_mov_b32 s50, 688128
    s_mov_b32 s51, 0x20000
    s_mov_b32 s1, 0
    s_and_b32 s96, s27, 7
    s_lshl_b32 s96, s96, 10
    s_add_u32 s96, s96, 655360
    s_add_u32 s96, s96, s1
    s_mul_i32 s58, s26, 114688
    s_add_u32 s58, s58, s1
    s_cmp_ge_u32 s2, 128
    s_cbranch_scc1 L_att
    s_mov_b32 s40, s12
    s_mov_b32 s41, s13
    s_mov_b32 s42, 1605632
    s_mov_b32 s43, 0x20000
    s_mov_b32 s44, s16
    s_mov_b32 s45, s17
    s_mov_b32 s46, 1605632
    s_mov_b32 s47, 0x20000
    s_mov_b32 s52, s14
    s_mov_b32 s53, s15
    s_mov_b32 s54, 3584
    s_mov_b32 s55, 0x20000
    s_and_b32 s32, s3, 3
    s_and_b32 s33, s32, 1
    s_lshr_b32 s34, s32, 1
    s_mul_i32 s56, s26, 896
    s_mul_i32 s57, s26, 401408
    s_lshl_b32 s31, s63, 3
    v_add_u32 v15, s31, v0
    v_subrev_u32 v19, 56, v15
    v_min_u32 v15, v15, v19
    v_lshlrev_b32 v15, 4, v15
    s_cmp_eq_u32 s3, 0
    s_cselect_b32 s15, s56, 0x7f000000
    v_lshrrev_b32 v30, 3, v0
    s_lshl_b32 s31, s32, 4
    v_add_u32 v16, s31, v30
    v_bfe_u32 v18, v0, 4, 1
    v_lshlrev_b32 v18, 2, v18
    v_and_b32 v31, 7, v0
    v_xor_b32 v31, v31, v18
    v_lshlrev_b32 v31, 4, v31
    v_mul_u32_u24 v9, 3584, v16
    v_add_u32 v9, v9, v31
    v_add_u32 v10, 27648, v9
    s_lshl_b32 s35, s32, 11
    s_lshl_b32 s4, s63, 7
    s_mul_i32 s97, s97, 1792
    s_add_u32 s97, s97, s56
    s_mul_i32 s98, s98, 1792
    s_add_u32 s98, s98, s56
    s_mul_i32 s99, s99, 1792
    s_add_u32 s99, s99, s56
    s_mul_i32 s100, s100, 1792
    s_add_u32 s100, s100, s56
    s_mul_i32 s101, s101, 1792
    s_add_u32 s101, s101, s56
    s_mul_i32 s61, s61, 1792
    s_add_u32 s61, s61, s56
    s_mul_i32 s62, s62, 1792
    s_add_u32 s62, s62, s56
    v_and_b32 v16, 31, v0
    s_lshl_b32 s31, s33, 5
    v_add_u32 v16, s31, v16
    v_lshrrev_b32 v17, 5, v0
    v_mul_u32_u24 v5, 912, v16
    v_lshl_add_u32 v5, v17, 4, v5
    v_mul_u32_u24 v11, 144, v16
    v_lshl_add_u32 v6, v17, 5, v11
    s_lshl_b32 s31, s34, 6
    v_add_u32 v6, s31, v6
    v_lshl_add_u32 v11, v17, 4, v11
    v_lshlrev_b32 v7, 6, v17
    s_lshl_b32 s31, s34, 7
    s_add_u32 s31, s31, 157696
    v_add_u32 v7, s31, v7
    v_lshrrev_b32 v16, 5, v0
    v_bfe_u32 v17, v0, 2, 2
    v_lshl_add_u32 v16, v16, 3, v17
    v_lshlrev_b32 v12, 7, v16
    v_and_b32 v16, 1, v0
    v_bfe_u32 v18, v0, 4, 1
    v_lshl_add_u32 v16, v16, 1, v18
    v_lshrrev_b32 v17, 1, v17
    v_xor_b32 v17, s34, v17
    v_lshl_add_u32 v16, v17, 2, v16
    v_lshl_add_u32 v12, v16, 4, v12
    v_bfe_u32 v16, v0, 1, 1
    v_lshl_add_u32 v12, v16, 3, v12
    v_add_u32 v13, 57344, v12
    v_add_u32 v14, 114688, v12
    s_cmp_ge_u32 s3, 4
    s_cselect_b64 vcc, -1, 0
    s_cbranch_vccnz L_ffn_b
    buffer_load_dwordx4 v[60:63], v15, s[52:55], s15 offen
    v_mov_b32 v16, 0
    v_mov_b32 v17, 0
    s_waitcnt vmcnt(7)
    v_dot2c_f32_bf16 v16, s29, v32
    v_dot2c_f32_bf16 v17, v32, v32
    v_dot2c_f32_bf16 v16, s29, v33
    v_dot2c_f32_bf16 v17, v33, v33
    v_dot2c_f32_bf16 v16, s29, v34
    v_dot2c_f32_bf16 v17, v34, v34
    v_dot2c_f32_bf16 v16, s29, v35
    v_dot2c_f32_bf16 v17, v35, v35
    s_waitcnt vmcnt(6)
    v_dot2c_f32_bf16 v16, s29, v36
    v_dot2c_f32_bf16 v17, v36, v36
    v_dot2c_f32_bf16 v16, s29, v37
    v_dot2c_f32_bf16 v17, v37, v37
    v_dot2c_f32_bf16 v16, s29, v38
    v_dot2c_f32_bf16 v17, v38, v38
    v_dot2c_f32_bf16 v16, s29, v39
    v_dot2c_f32_bf16 v17, v39, v39
    s_waitcnt vmcnt(5)
    v_dot2c_f32_bf16 v16, s29, v40
    v_dot2c_f32_bf16 v17, v40, v40
    v_dot2c_f32_bf16 v16, s29, v41
    v_dot2c_f32_bf16 v17, v41, v41
    v_dot2c_f32_bf16 v16, s29, v42
    v_dot2c_f32_bf16 v17, v42, v42
    v_dot2c_f32_bf16 v16, s29, v43
    v_dot2c_f32_bf16 v17, v43, v43
    s_waitcnt vmcnt(4)
    v_dot2c_f32_bf16 v16, s29, v44
    v_dot2c_f32_bf16 v17, v44, v44
    v_dot2c_f32_bf16 v16, s29, v45
    v_dot2c_f32_bf16 v17, v45, v45
    v_dot2c_f32_bf16 v16, s29, v46
    v_dot2c_f32_bf16 v17, v46, v46
    v_dot2c_f32_bf16 v16, s29, v47
    v_dot2c_f32_bf16 v17, v47, v47
    s_waitcnt vmcnt(3)
    v_dot2c_f32_bf16 v16, s29, v48
    v_dot2c_f32_bf16 v17, v48, v48
    v_dot2c_f32_bf16 v16, s29, v49
    v_dot2c_f32_bf16 v17, v49, v49
    v_dot2c_f32_bf16 v16, s29, v50
    v_dot2c_f32_bf16 v17, v50, v50
    v_dot2c_f32_bf16 v16, s29, v51
    v_dot2c_f32_bf16 v17, v51, v51
    s_waitcnt vmcnt(2)
    v_dot2c_f32_bf16 v16, s29, v52
    v_dot2c_f32_bf16 v17, v52, v52
    v_dot2c_f32_bf16 v16, s29, v53
    v_dot2c_f32_bf16 v17, v53, v53
    v_dot2c_f32_bf16 v16, s29, v54
    v_dot2c_f32_bf16 v17, v54, v54
    v_dot2c_f32_bf16 v16, s29, v55
    v_dot2c_f32_bf16 v17, v55, v55
    s_waitcnt vmcnt(1)
    v_dot2c_f32_bf16 v16, s29, v56
    v_dot2c_f32_bf16 v17, v56, v56
    v_dot2c_f32_bf16 v16, s29, v57
    v_dot2c_f32_bf16 v17, v57, v57
    v_dot2c_f32_bf16 v16, s29, v58
    v_dot2c_f32_bf16 v17, v58, v58
    v_dot2c_f32_bf16 v16, s29, v59
    v_dot2c_f32_bf16 v17, v59, v59
    s_nop 1
    v_add_f32_dpp v16, v16, v16 quad_perm:[1,0,3,2] row_mask:0xf bank_mask:0xf
    v_add_f32_dpp v17, v17, v17 quad_perm:[1,0,3,2] row_mask:0xf bank_mask:0xf
    s_nop 0
    v_add_f32_dpp v16, v16, v16 quad_perm:[2,3,0,1] row_mask:0xf bank_mask:0xf
    v_add_f32_dpp v17, v17, v17 quad_perm:[2,3,0,1] row_mask:0xf bank_mask:0xf
    s_nop 0
    v_add_f32_dpp v16, v16, v16 row_half_mirror row_mask:0xf bank_mask:0xf
    v_add_f32_dpp v17, v17, v17 row_half_mirror row_mask:0xf bank_mask:0xf
    v_mul_f32 v16, 0x3b124925, v16
    v_mul_f32 v17, 0x3b124925, v17
    v_fma_f32 v17, -v16, v16, v17
    v_max_f32 v17, 0, v17
    v_add_f32 v17, 0x3727c5ac, v17
    v_rsq_f32 v18, v17
    s_nop 0
    v_mul_f32 v18, 0x3eeff558, v18
    v_mul_f32 v20, v16, v18
    v_sub_f32 v20, 0, v20
    s_add_u32 m0, s35, 59392
    s_add_u32 s59, s97, s4
    buffer_load_dwordx4 v9, s[40:43], s59 offen lds
    buffer_load_dwordx4 v10, s[40:43], s59 offen offset:1024 lds
    s_add_u32 m0, s35, 67584
    s_add_u32 s59, s98, s4
    buffer_load_dwordx4 v9, s[40:43], s59 offen lds
    v_lshlrev_b32 v22, 16, v32
    v_and_b32 v23, s30, v32
    v_lshlrev_b32 v24, 16, v33
    v_and_b32 v25, s30, v33
    v_lshlrev_b32 v26, 16, v34
    v_and_b32 v27, s30, v34
    v_lshlrev_b32 v28, 16, v35
    v_and_b32 v29, s30, v35
    v_pk_fma_f32 v[22:23], v[22:23], v[18:19], v[20:21] op_sel_hi:[1,0,0]
    v_pk_fma_f32 v[24:25], v[24:25], v[18:19], v[20:21] op_sel_hi:[1,0,0]
    v_pk_fma_f32 v[26:27], v[26:27], v[18:19], v[20:21] op_sel_hi:[1,0,0]
    v_pk_fma_f32 v[28:29], v[28:29], v[18:19], v[20:21] op_sel_hi:[1,0,0]
    v_cvt_pk_bf16_f32 v32, v22, v23
    v_cvt_pk_bf16_f32 v33, v24, v25
    v_cvt_pk_bf16_f32 v34, v26, v27
    v_cvt_pk_bf16_f32 v35, v28, v29
    ds_write_b128 v100, v[32:35] offset:0
    buffer_load_dwordx4 v10, s[40:43], s59 offen offset:1024 lds
    v_lshlrev_b32 v22, 16, v36
    v_and_b32 v23, s30, v36
    v_lshlrev_b32 v24, 16, v37
    v_and_b32 v25, s30, v37
    v_lshlrev_b32 v26, 16, v38
    v_and_b32 v27, s30, v38
    v_lshlrev_b32 v28, 16, v39
    v_and_b32 v29, s30, v39
    v_pk_fma_f32 v[22:23], v[22:23], v[18:19], v[20:21] op_sel_hi:[1,0,0]
    v_pk_fma_f32 v[24:25], v[24:25], v[18:19], v[20:21] op_sel_hi:[1,0,0]
    v_pk_fma_f32 v[26:27], v[26:27], v[18:19], v[20:21] op_sel_hi:[1,0,0]
    v_pk_fma_f32 v[28:29], v[28:29], v[18:19], v[20:21] op_sel_hi:[1,0,0]
    v_cvt_pk_bf16_f32 v36, v22, v23
    v_cvt_pk_bf16_f32 v37, v24, v25
    v_cvt_pk_bf16_f32 v38, v26, v27
    v_cvt_pk_bf16_f32 v39, v28, v29
    ds_write_b128 v101, v[36:39] offset:0
    s_add_u32 m0, s35, 75776
    s_add_u32 s59, s99, s4
    buffer_load_dwordx4 v9, s[40:43], s59 offen lds
    v_lshlrev_b32 v22, 16, v40
    v_and_b32 v23, s30, v40
    v_lshlrev_b32 v24, 16, v41
    v_and_b32 v25, s30, v41
    v_lshlrev_b32 v26, 16, v42
    v_and_b32 v27, s30, v42
    v_lshlrev_b32 v28, 16, v43
    v_and_b32 v29, s30, v43
    v_pk_fma_f32 v[22:23], v[22:23], v[18:19], v[20:21] op_sel_hi:[1,0,0]
    v_pk_fma_f32 v[24:25], v[24:25], v[18:19], v[20:21] op_sel_hi:[1,0,0]
    v_pk_fma_f32 v[26:27], v[26:27], v[18:19], v[20:21] op_sel_hi:[1,0,0]
    v_pk_fma_f32 v[28:29], v[28:29], v[18:19], v[20:21] op_sel_hi:[1,0,0]
    v_cvt_pk_bf16_f32 v40, v22, v23
    v_cvt_pk_bf16_f32 v41, v24, v25
    v_cvt_pk_bf16_f32 v42, v26, v27
    v_cvt_pk_bf16_f32 v43, v28, v29
    ds_write_b128 v102, v[40:43] offset:0
    buffer_load_dwordx4 v10, s[40:43], s59 offen offset:1024 lds
    v_lshlrev_b32 v22, 16, v44
    v_and_b32 v23, s30, v44
    v_lshlrev_b32 v24, 16, v45
    v_and_b32 v25, s30, v45
    v_lshlrev_b32 v26, 16, v46
    v_and_b32 v27, s30, v46
    v_lshlrev_b32 v28, 16, v47
    v_and_b32 v29, s30, v47
    v_pk_fma_f32 v[22:23], v[22:23], v[18:19], v[20:21] op_sel_hi:[1,0,0]
    v_pk_fma_f32 v[24:25], v[24:25], v[18:19], v[20:21] op_sel_hi:[1,0,0]
    v_pk_fma_f32 v[26:27], v[26:27], v[18:19], v[20:21] op_sel_hi:[1,0,0]
    v_pk_fma_f32 v[28:29], v[28:29], v[18:19], v[20:21] op_sel_hi:[1,0,0]
    v_cvt_pk_bf16_f32 v44, v22, v23
    v_cvt_pk_bf16_f32 v45, v24, v25
    v_cvt_pk_bf16_f32 v46, v26, v27
    v_cvt_pk_bf16_f32 v47, v28, v29
    ds_write_b128 v103, v[44:47] offset:0
    s_add_u32 m0, s35, 83968
    s_add_u32 s59, s100, s4
    buffer_load_dwordx4 v9, s[40:43], s59 offen lds
    v_lshlrev_b32 v22, 16, v48
    v_and_b32 v23, s30, v48
    v_lshlrev_b32 v24, 16, v49
    v_and_b32 v25, s30, v49
    v_lshlrev_b32 v26, 16, v50
    v_and_b32 v27, s30, v50
    v_lshlrev_b32 v28, 16, v51
    v_and_b32 v29, s30, v51
    v_pk_fma_f32 v[22:23], v[22:23], v[18:19], v[20:21] op_sel_hi:[1,0,0]
    v_pk_fma_f32 v[24:25], v[24:25], v[18:19], v[20:21] op_sel_hi:[1,0,0]
    v_pk_fma_f32 v[26:27], v[26:27], v[18:19], v[20:21] op_sel_hi:[1,0,0]
    v_pk_fma_f32 v[28:29], v[28:29], v[18:19], v[20:21] op_sel_hi:[1,0,0]
    v_cvt_pk_bf16_f32 v48, v22, v23
    v_cvt_pk_bf16_f32 v49, v24, v25
    v_cvt_pk_bf16_f32 v50, v26, v27
    v_cvt_pk_bf16_f32 v51, v28, v29
    ds_write_b128 v104, v[48:51] offset:0
    buffer_load_dwordx4 v10, s[40:43], s59 offen offset:1024 lds
    v_lshlrev_b32 v22, 16, v52
    v_and_b32 v23, s30, v52
    v_lshlrev_b32 v24, 16, v53
    v_and_b32 v25, s30, v53
    v_lshlrev_b32 v26, 16, v54
    v_and_b32 v27, s30, v54
    v_lshlrev_b32 v28, 16, v55
    v_and_b32 v29, s30, v55
    v_pk_fma_f32 v[22:23], v[22:23], v[18:19], v[20:21] op_sel_hi:[1,0,0]
    v_pk_fma_f32 v[24:25], v[24:25], v[18:19], v[20:21] op_sel_hi:[1,0,0]
    v_pk_fma_f32 v[26:27], v[26:27], v[18:19], v[20:21] op_sel_hi:[1,0,0]
    v_pk_fma_f32 v[28:29], v[28:29], v[18:19], v[20:21] op_sel_hi:[1,0,0]
    v_cvt_pk_bf16_f32 v52, v22, v23
    v_cvt_pk_bf16_f32 v53, v24, v25
    v_cvt_pk_bf16_f32 v54, v26, v27
    v_cvt_pk_bf16_f32 v55, v28, v29
    ds_write_b128 v105, v[52:55] offset:0
    s_add_u32 m0, s35, 92160
    s_add_u32 s59, s101, s4
    buffer_load_dwordx4 v9, s[40:43], s59 offen lds
    v_lshlrev_b32 v22, 16, v56
    v_and_b32 v23, s30, v56
    v_lshlrev_b32 v24, 16, v57
    v_and_b32 v25, s30, v57
    v_lshlrev_b32 v26, 16, v58
    v_and_b32 v27, s30, v58
    v_lshlrev_b32 v28, 16, v59
    v_and_b32 v29, s30, v59
    v_pk_fma_f32 v[22:23], v[22:23], v[18:19], v[20:21] op_sel_hi:[1,0,0]
    v_pk_fma_f32 v[24:25], v[24:25], v[18:19], v[20:21] op_sel_hi:[1,0,0]
    v_pk_fma_f32 v[26:27], v[26:27], v[18:19], v[20:21] op_sel_hi:[1,0,0]
    v_pk_fma_f32 v[28:29], v[28:29], v[18:19], v[20:21] op_sel_hi:[1,0,0]
    v_cvt_pk_bf16_f32 v56, v22, v23
    v_cvt_pk_bf16_f32 v57, v24, v25
    v_cvt_pk_bf16_f32 v58, v26, v27
    v_cvt_pk_bf16_f32 v59, v28, v29
    ds_write_b128 v106, v[56:59] offset:0
    buffer_load_dwordx4 v10, s[40:43], s59 offen offset:1024 lds
    s_mov_b32 s61, 0xc09d30fc
    s_mov_b32 s62, 0x3eeff558
    s_waitcnt vmcnt(10)
    s_cmp_lg_u32 s3, 0
    s_cbranch_scc1 L_nobias
    v_lshlrev_b32 v68, 16, v60
    v_and_b32 v69, s30, v60
    v_lshlrev_b32 v70, 16, v61
    v_and_b32 v71, s30, v61
    v_lshlrev_b32 v72, 16, v62
    v_and_b32 v73, s30, v62
    v_lshlrev_b32 v74, 16, v63
    v_and_b32 v75, s30, v63
    v_mul_f32 v68, s62, v68
    v_mul_f32 v69, s62, v69
    v_mul_f32 v70, s62, v70
    v_mul_f32 v71, s62, v71
    v_mul_f32 v72, s62, v72
    v_mul_f32 v73, s62, v73
    v_mul_f32 v74, s62, v74
    v_mul_f32 v75, s62, v75
    v_lshlrev_b32 v16, 5, v0
    v_add_u32 v16, 157696, v16
    ds_write_b128 v16, v[68:71]
    ds_write_b128 v16, v[72:75] offset:16
L_nobias:
    s_cmp_eq_u32 s3, 0
    s_cbranch_scc1 L_stub_A0
    s_cmp_eq_u32 s3, 1
    s_cbranch_scc1 L_stub_B0
    s_cmp_eq_u32 s3, 2
    s_cbranch_scc1 L_stub_A1
    s_cbranch_scc0 L_stub_B1
L_warm:
    s_branch L_page1
.p2align 12
L_page1:
    s_waitcnt lgkmcnt(0)
    s_waitcnt vmcnt(6)
    s_barrier
    ds_read_b128 v[92:95], v7 offset:0
    ds_read_b128 v[96:99], v7 offset:16
    ds_read_b128 v[100:103], v7 offset:32
    ds_read_b128 v[104:107], v7 offset:48
    ds_read_b128 v[140:143], v5 offset:0
    ds_read_b64_tr_b16 v[108:109], v13 offset:2048
    ds_read_b64_tr_b16 v[110:111], v13 offset:2560
    ds_read_b128 v[144:147], v5 offset:32
    ds_read_b64_tr_b16 v[112:113], v13 offset:4096
    ds_read_b64_tr_b16 v[114:115], v13 offset:4608
    ds_read_b128 v[148:151], v5 offset:64
    ds_read_b64_tr_b16 v[116:117], v13 offset:6144
    ds_read_b64_tr_b16 v[118:119], v13 offset:6656
    ds_read_b128 v[152:155], v5 offset:96
    ds_read_b64_tr_b16 v[120:121], v13 offset:8192
    ds_read_b64_tr_b16 v[122:123], v13 offset:8704
    ds_read_b128 v[156:159], v5 offset:128
    ds_read_b64_tr_b16 v[124:125], v13 offset:10240
    ds_read_b64_tr_b16 v[126:127], v13 offset:10752
    s_waitcnt lgkmcnt(9)
    v_mfma_f32_32x32x16_bf16 v[92:107], v[108:111], v[140:143], v[92:107]
    ds_read_b128 v[160:163], v5 offset:160
    ds_read_b64_tr_b16 v[128:129], v13 offset:12288
    ds_read_b64_tr_b16 v[130:131], v13 offset:12800
    v_mfma_f32_32x32x16_bf16 v[92:107], v[112:115], v[144:147], v[92:107]
    ds_read_b128 v[164:167], v5 offset:192
    ds_read_b64_tr_b16 v[132:133], v13 offset:14336
    ds_read_b64_tr_b16 v[134:135], v13 offset:14848
    s_waitcnt lgkmcnt(9)
    v_mfma_f32_32x32x16_bf16 v[92:107], v[116:119], v[148:151], v[92:107]
    ds_read_b128 v[168:171], v5 offset:224
    ds_read_b64_tr_b16 v[136:137], v13 offset:16384
    ds_read_b64_tr_b16 v[138:139], v13 offset:16896
    v_mfma_f32_32x32x16_bf16 v[92:107], v[120:123], v[152:155], v[92:107]
    s_waitcnt vmcnt(2)
    s_barrier
    ds_read_b128 v[172:175], v5 offset:256
    ds_read_b64_tr_b16 v[108:109], v13 offset:18432
    ds_read_b64_tr_b16 v[110:111], v13 offset:18944
    s_waitcnt lgkmcnt(9)
    v_mfma_f32_32x32x16_bf16 v[92:107], v[124:127], v[156:159], v[92:107]
    ds_read_b128 v[176:179], v5 offset:288
    ds_read_b64_tr_b16 v[112:113], v13 offset:20480
    ds_read_b64_tr_b16 v[114:115], v13 offset:20992
    v_mfma_f32_32x32x16_bf16 v[92:107], v[128:131], v[160:163], v[92:107]
    ds_read_b128 v[180:183], v5 offset:320
    ds_read_b64_tr_b16 v[116:117], v13 offset:22528
    ds_read_b64_tr_b16 v[118:119], v13 offset:23040
    s_waitcnt lgkmcnt(9)
    v_mfma_f32_32x32x16_bf16 v[92:107], v[132:135], v[164:167], v[92:107]
    ds_read_b128 v[184:187], v5 offset:352
    ds_read_b64_tr_b16 v[120:121], v13 offset:24576
    ds_read_b64_tr_b16 v[122:123], v13 offset:25088
    v_mfma_f32_32x32x16_bf16 v[92:107], v[136:139], v[168:171], v[92:107]
    ds_read_b128 v[188:191], v5 offset:384
    ds_read_b64_tr_b16 v[124:125], v13 offset:26624
    ds_read_b64_tr_b16 v[126:127], v13 offset:27136
    s_waitcnt lgkmcnt(9)
    v_mfma_f32_32x32x16_bf16 v[92:107], v[108:111], v[172:175], v[92:107]
    ds_read_b128 v[192:195], v5 offset:416
    ds_read_b64_tr_b16 v[128:129], v13 offset:28672
    ds_read_b64_tr_b16 v[130:131], v13 offset:29184
    ds_read_b128 v[32:35], v7 offset:256
    ds_read_b128 v[36:39], v7 offset:272
    ds_read_b128 v[40:43], v7 offset:288
    ds_read_b128 v[44:47], v7 offset:304
    v_mfma_f32_32x32x16_bf16 v[92:107], v[112:115], v[176:179], v[92:107]
    ds_read_b128 v[196:199], v5 offset:448
    ds_read_b64_tr_b16 v[132:133], v13 offset:30720
    ds_read_b64_tr_b16 v[134:135], v13 offset:31232
    s_waitcnt lgkmcnt(13)
    v_mfma_f32_32x32x16_bf16 v[92:107], v[116:119], v[180:183], v[92:107]
    ds_read_b128 v[200:203], v5 offset:480
    ds_read_b64_tr_b16 v[136:137], v13 offset:32768
    ds_read_b64_tr_b16 v[138:139], v13 offset:33280
    v_mfma_f32_32x32x16_bf16 v[92:107], v[120:123], v[184:187], v[92:107]
    s_waitcnt vmcnt(0)
    s_barrier
    ds_read_b128 v[204:207], v5 offset:512
    ds_read_b64_tr_b16 v[108:109], v13 offset:34816
    ds_read_b64_tr_b16 v[110:111], v13 offset:35328
    s_waitcnt lgkmcnt(13)
    v_mfma_f32_32x32x16_bf16 v[92:107], v[124:127], v[188:191], v[92:107]
    ds_read_b128 v[208:211], v5 offset:544
    ds_read_b64_tr_b16 v[112:113], v13 offset:36864
    ds_read_b64_tr_b16 v[114:115], v13 offset:37376
    v_mfma_f32_32x32x16_bf16 v[92:107], v[128:131], v[192:195], v[92:107]
    ds_read_b128 v[212:215], v5 offset:576
    ds_read_b64_tr_b16 v[116:117], v13 offset:38912
    ds_read_b64_tr_b16 v[118:119], v13 offset:39424
    s_waitcnt lgkmcnt(9)
    v_mfma_f32_32x32x16_bf16 v[92:107], v[132:135], v[196:199], v[92:107]
    ds_read_b128 v[216:219], v5 offset:608
    ds_read_b64_tr_b16 v[120:121], v13 offset:40960
    ds_read_b64_tr_b16 v[122:123], v13 offset:41472
    v_mfma_f32_32x32x16_bf16 v[92:107], v[136:139], v[200:203], v[92:107]
    ds_read_b128 v[220:223], v5 offset:640
    ds_read_b64_tr_b16 v[124:125], v13 offset:43008
    ds_read_b64_tr_b16 v[126:127], v13 offset:43520
    s_waitcnt lgkmcnt(9)
    v_mfma_f32_32x32x16_bf16 v[92:107], v[108:111], v[204:207], v[92:107]
    ds_read_b128 v[224:227], v5 offset:672
    ds_read_b64_tr_b16 v[128:129], v13 offset:45056
    ds_read_b64_tr_b16 v[130:131], v13 offset:45568
    v_mfma_f32_32x32x16_bf16 v[92:107], v[112:115], v[208:211], v[92:107]
    ds_read_b128 v[228:231], v5 offset:704
    ds_read_b64_tr_b16 v[132:133], v13 offset:47104
    ds_read_b64_tr_b16 v[134:135], v13 offset:47616
    s_waitcnt lgkmcnt(9)
    v_mfma_f32_32x32x16_bf16 v[92:107], v[116:119], v[212:215], v[92:107]
    ds_read_b128 v[232:235], v5 offset:736
    ds_read_b64_tr_b16 v[136:137], v13 offset:49152
    ds_read_b64_tr_b16 v[138:139], v13 offset:49664
    v_mfma_f32_32x32x16_bf16 v[92:107], v[120:123], v[216:219], v[92:107]
    ds_read_b128 v[236:239], v5 offset:768
    ds_read_b64_tr_b16 v[108:109], v13 offset:51200
    ds_read_b64_tr_b16 v[110:111], v13 offset:51712
    s_waitcnt lgkmcnt(9)
    v_mfma_f32_32x32x16_bf16 v[92:107], v[124:127], v[220:223], v[92:107]
    ds_read_b128 v[240:243], v5 offset:800
    ds_read_b64_tr_b16 v[112:113], v13 offset:53248
    ds_read_b64_tr_b16 v[114:115], v13 offset:53760
    v_mfma_f32_32x32x16_bf16 v[92:107], v[128:131], v[224:227], v[92:107]
    ds_read_b128 v[244:247], v5 offset:832
    ds_read_b64_tr_b16 v[116:117], v13 offset:55296
    ds_read_b64_tr_b16 v[118:119], v13 offset:55808
    s_waitcnt lgkmcnt(9)
    v_mfma_f32_32x32x16_bf16 v[92:107], v[132:135], v[228:231], v[92:107]
    ds_read_b128 v[248:251], v5 offset:864
    ds_read_b64_tr_b16 v[120:121], v13 offset:57344
    ds_read_b64_tr_b16 v[122:123], v13 offset:57856
    v_mfma_f32_32x32x16_bf16 v[92:107], v[136:139], v[232:235], v[92:107]
    s_barrier
    ds_read_b64_tr_b16 v[124:125], v14 offset:2048
    ds_read_b64_tr_b16 v[126:127], v14 offset:2560
    s_waitcnt lgkmcnt(8)
    v_mfma_f32_32x32x16_bf16 v[92:107], v[108:111], v[236:239], v[92:107]
    ds_read_b64_tr_b16 v[128:129], v14 offset:4096
    ds_read_b64_tr_b16 v[130:131], v14 offset:4608
    v_mfma_f32_32x32x16_bf16 v[92:107], v[112:115], v[240:243], v[92:107]
    ds_read_b64_tr_b16 v[132:133], v14 offset:6144
    ds_read_b64_tr_b16 v[134:135], v14 offset:6656
    s_waitcnt lgkmcnt(6)
    v_mfma_f32_32x32x16_bf16 v[92:107], v[116:119], v[244:247], v[92:107]
    ds_read_b64_tr_b16 v[136:137], v14 offset:8192
    ds_read_b64_tr_b16 v[138:139], v14 offset:8704
    v_mfma_f32_32x32x16_bf16 v[92:107], v[120:123], v[248:251], v[92:107]
    ds_read_b64_tr_b16 v[108:109], v14 offset:10240
    ds_read_b64_tr_b16 v[110:111], v14 offset:10752
    s_waitcnt lgkmcnt(6)
    v_mfma_f32_32x32x16_bf16 v[32:47], v[124:127], v[140:143], v[32:47]
    ds_read_b64_tr_b16 v[112:113], v14 offset:12288
    ds_read_b64_tr_b16 v[114:115], v14 offset:12800
    v_mfma_f32_32x32x16_bf16 v[32:47], v[128:131], v[144:147], v[32:47]
    ds_read_b64_tr_b16 v[116:117], v14 offset:14336
    ds_read_b64_tr_b16 v[118:119], v14 offset:14848
    s_nop 2
    v_fma_f32 v60, -v92, v92, s61
    v_fma_f32 v61, -v93, v93, s61
    v_fma_f32 v62, -v94, v94, s61
    v_fma_f32 v63, -v95, v95, s61
    v_mul_f32 v60, v60, v92
    v_mul_f32 v61, v61, v93
    v_mul_f32 v62, v62, v94
    s_waitcnt lgkmcnt(6)
    v_mfma_f32_32x32x16_bf16 v[32:47], v[132:135], v[148:151], v[32:47]
    ds_read_b64_tr_b16 v[120:121], v14 offset:16384
    ds_read_b64_tr_b16 v[122:123], v14 offset:16896
    v_mul_f32 v63, v63, v95
    v_exp_f32 v60, v60
    v_exp_f32 v61, v61
    v_exp_f32 v62, v62
    v_exp_f32 v63, v63
    v_fma_f32 v60, v60, s62, s62
    v_fma_f32 v61, v61, s62, s62
    v_mfma_f32_32x32x16_bf16 v[32:47], v[136:139], v[152:155], v[32:47]
    ds_read_b64_tr_b16 v[124:125], v14 offset:18432
    ds_read_b64_tr_b16 v[126:127], v14 offset:18944
    v_fma_f32 v62, v62, s62, s62
    v_fma_f32 v63, v63, s62, s62
    v_rcp_f32 v60, v60
    v_rcp_f32 v61, v61
    v_rcp_f32 v62, v62
    v_rcp_f32 v63, v63
    v_mul_f32 v60, v60, v92
    s_waitcnt lgkmcnt(6)
    v_mfma_f32_32x32x16_bf16 v[32:47], v[108:111], v[156:159], v[32:47]
    ds_read_b64_tr_b16 v[128:129], v14 offset:20480
    ds_read_b64_tr_b16 v[130:131], v14 offset:20992
    v_mul_f32 v61, v61, v93
    v_mul_f32 v62, v62, v94
    v_mul_f32 v63, v63, v95
    v_cvt_pk_bf16_f32 v68, v60, v61
    v_cvt_pk_bf16_f32 v69, v62, v63
    v_fma_f32 v64, -v96, v96, s61
    v_fma_f32 v65, -v97, v97, s61
    v_mfma_f32_32x32x16_bf16 v[32:47], v[112:115], v[160:163], v[32:47]
    ds_read_b64_tr_b16 v[132:133], v14 offset:22528
    ds_read_b64_tr_b16 v[134:135], v14 offset:23040
    v_fma_f32 v66, -v98, v98, s61
    v_fma_f32 v67, -v99, v99, s61
    v_mul_f32 v64, v64, v96
    v_mul_f32 v65, v65, v97
    v_mul_f32 v66, v66, v98
    v_mul_f32 v67, v67, v99
    v_exp_f32 v64, v64
    s_waitcnt lgkmcnt(6)
    v_mfma_f32_32x32x16_bf16 v[32:47], v[116:119], v[164:167], v[32:47]
    ds_read_b64_tr_b16 v[136:137], v14 offset:24576
    ds_read_b64_tr_b16 v[138:139], v14 offset:25088
    v_exp_f32 v65, v65
    v_exp_f32 v66, v66
    v_exp_f32 v67, v67
    v_fma_f32 v64, v64, s62, s62
    v_fma_f32 v65, v65, s62, s62
    v_fma_f32 v66, v66, s62, s62
    v_fma_f32 v67, v67, s62, s62
    v_mfma_f32_32x32x16_bf16 v[32:47], v[120:123], v[168:171], v[32:47]
    s_barrier
    ds_read_b64_tr_b16 v[108:109], v14 offset:26624
    ds_read_b64_tr_b16 v[110:111], v14 offset:27136
    v_rcp_f32 v64, v64
    v_rcp_f32 v65, v65
    v_rcp_f32 v66, v66
    v_rcp_f32 v67, v67
    v_mul_f32 v64, v64, v96
    v_mul_f32 v65, v65, v97
    v_mul_f32 v66, v66, v98
    s_waitcnt lgkmcnt(6)
    v_mfma_f32_32x32x16_bf16 v[32:47], v[124:127], v[172:175], v[32:47]
    ds_read_b64_tr_b16 v[112:113], v14 offset:28672
    ds_read_b64_tr_b16 v[114:115], v14 offset:29184
    v_mul_f32 v67, v67, v99
    v_cvt_pk_bf16_f32 v70, v64, v65
    v_cvt_pk_bf16_f32 v71, v66, v67
    v_fma_f32 v60, -v100, v100, s61
    v_fma_f32 v61, -v101, v101, s61
    v_fma_f32 v62, -v102, v102, s61
    v_fma_f32 v63, -v103, v103, s61
    v_mfma_f32_32x32x16_bf16 v[32:47], v[128:131], v[176:179], v[32:47]
    ds_read_b64_tr_b16 v[116:117], v14 offset:30720
    ds_read_b64_tr_b16 v[118:119], v14 offset:31232
    v_mul_f32 v60, v60, v100
    v_mul_f32 v61, v61, v101
    v_mul_f32 v62, v62, v102
    v_mul_f32 v63, v63, v103
    v_exp_f32 v60, v60
    v_exp_f32 v61, v61
    v_exp_f32 v62, v62
    s_waitcnt lgkmcnt(6)
    v_mfma_f32_32x32x16_bf16 v[32:47], v[132:135], v[180:183], v[32:47]
    ds_read_b64_tr_b16 v[120:121], v14 offset:32768
    ds_read_b64_tr_b16 v[122:123], v14 offset:33280
    v_exp_f32 v63, v63
    v_fma_f32 v60, v60, s62, s62
    v_fma_f32 v61, v61, s62, s62
    v_fma_f32 v62, v62, s62, s62
    v_fma_f32 v63, v63, s62, s62
    v_rcp_f32 v60, v60
    v_rcp_f32 v61, v61
    v_mfma_f32_32x32x16_bf16 v[32:47], v[136:139], v[184:187], v[32:47]
    ds_read_b64_tr_b16 v[124:125], v14 offset:34816
    ds_read_b64_tr_b16 v[126:127], v14 offset:35328
    v_rcp_f32 v62, v62
    v_rcp_f32 v63, v63
    v_mul_f32 v60, v60, v100
    v_mul_f32 v61, v61, v101
    v_mul_f32 v62, v62, v102
    v_mul_f32 v63, v63, v103
    v_cvt_pk_bf16_f32 v72, v60, v61
    s_waitcnt lgkmcnt(6)
    v_mfma_f32_32x32x16_bf16 v[32:47], v[108:111], v[188:191], v[32:47]
    ds_read_b64_tr_b16 v[128:129], v14 offset:36864
    ds_read_b64_tr_b16 v[130:131], v14 offset:37376
    v_cvt_pk_bf16_f32 v73, v62, v63
    v_fma_f32 v64, -v104, v104, s61
    v_fma_f32 v65, -v105, v105, s61
    v_fma_f32 v66, -v106, v106, s61
    v_fma_f32 v67, -v107, v107, s61
    v_mul_f32 v64, v64, v104
    v_mul_f32 v65, v65, v105
    v_mfma_f32_32x32x16_bf16 v[32:47], v[112:115], v[192:195], v[32:47]
    ds_read_b64_tr_b16 v[132:133], v14 offset:38912
    ds_read_b64_tr_b16 v[134:135], v14 offset:39424
    v_mul_f32 v66, v66, v106
    v_mul_f32 v67, v67, v107
    v_exp_f32 v64, v64
    v_exp_f32 v65, v65
    v_exp_f32 v66, v66
    v_exp_f32 v67, v67
    v_fma_f32 v64, v64, s62, s62
    s_waitcnt lgkmcnt(6)
    v_mfma_f32_32x32x16_bf16 v[32:47], v[116:119], v[196:199], v[32:47]
    ds_read_b64_tr_b16 v[136:137], v14 offset:40960
    ds_read_b64_tr_b16 v[138:139], v14 offset:41472
    v_fma_f32 v65, v65, s62, s62
    v_fma_f32 v66, v66, s62, s62
    v_fma_f32 v67, v67, s62, s62
    v_rcp_f32 v64, v64
    v_rcp_f32 v65, v65
    v_rcp_f32 v66, v66
    v_rcp_f32 v67, v67
    v_mfma_f32_32x32x16_bf16 v[32:47], v[120:123], v[200:203], v[32:47]
    ds_read_b64_tr_b16 v[108:109], v13 offset:2048
    ds_read_b64_tr_b16 v[110:111], v13 offset:2560
    v_mul_f32 v64, v64, v104
    v_mul_f32 v65, v65, v105
    v_mul_f32 v66, v66, v106
    v_mul_f32 v67, v67, v107
    v_cvt_pk_bf16_f32 v74, v64, v65
    v_cvt_pk_bf16_f32 v75, v66, v67
    s_waitcnt lgkmcnt(6)
    v_mfma_f32_32x32x16_bf16 v[32:47], v[124:127], v[204:207], v[32:47]
    ds_read_b64_tr_b16 v[112:113], v13 offset:4096
    ds_read_b64_tr_b16 v[114:115], v13 offset:4608
    v_mfma_f32_32x32x16_bf16 v[32:47], v[128:131], v[208:211], v[32:47]
    ds_read_b64_tr_b16 v[116:117], v13 offset:6144
    ds_read_b64_tr_b16 v[118:119], v13 offset:6656
    s_waitcnt lgkmcnt(6)
    v_mfma_f32_32x32x16_bf16 v[32:47], v[132:135], v[212:215], v[32:47]
    ds_read_b64_tr_b16 v[120:121], v13 offset:8192
    ds_read_b64_tr_b16 v[122:123], v13 offset:8704
    v_mfma_f32_32x32x16_bf16 v[32:47], v[136:139], v[216:219], v[32:47]
    ds_read_b64_tr_b16 v[124:125], v13 offset:10240
    ds_read_b64_tr_b16 v[126:127], v13 offset:10752
    s_waitcnt lgkmcnt(6)
    v_mfma_f32_32x32x16_bf16 v[32:47], v[108:111], v[220:223], v[32:47]
    ds_read_b64_tr_b16 v[128:129], v13 offset:12288
    ds_read_b64_tr_b16 v[130:131], v13 offset:12800
    v_mfma_f32_32x32x16_bf16 v[32:47], v[112:115], v[224:227], v[32:47]
    ds_read_b64_tr_b16 v[132:133], v13 offset:14336
    ds_read_b64_tr_b16 v[134:135], v13 offset:14848
    s_waitcnt lgkmcnt(6)
    v_mfma_f32_32x32x16_bf16 v[32:47], v[116:119], v[228:231], v[32:47]
    ds_read_b64_tr_b16 v[136:137], v13 offset:16384
    ds_read_b64_tr_b16 v[138:139], v13 offset:16896
    v_mfma_f32_32x32x16_bf16 v[32:47], v[120:123], v[232:235], v[32:47]
    s_barrier
    ds_read_b64_tr_b16 v[108:109], v13 offset:18432
    ds_read_b64_tr_b16 v[110:111], v13 offset:18944
    s_waitcnt lgkmcnt(6)
    v_mfma_f32_32x32x16_bf16 v[32:47], v[124:127], v[236:239], v[32:47]
    ds_read_b128 v[92:95], v7 offset:512
    ds_read_b128 v[96:99], v7 offset:528
    ds_read_b128 v[100:103], v7 offset:544
    ds_read_b128 v[104:107], v7 offset:560
    ds_read_b64_tr_b16 v[112:113], v13 offset:20480
    ds_read_b64_tr_b16 v[114:115], v13 offset:20992
    v_mfma_f32_32x32x16_bf16 v[32:47], v[128:131], v[240:243], v[32:47]
    ds_read_b64_tr_b16 v[116:117], v13 offset:22528
    ds_read_b64_tr_b16 v[118:119], v13 offset:23040
    s_waitcnt lgkmcnt(10)
    v_mfma_f32_32x32x16_bf16 v[32:47], v[132:135], v[244:247], v[32:47]
    ds_read_b64_tr_b16 v[120:121], v13 offset:24576
    ds_read_b64_tr_b16 v[122:123], v13 offset:25088
    v_mfma_f32_32x32x16_bf16 v[32:47], v[136:139], v[248:251], v[32:47]
    ds_read_b64_tr_b16 v[124:125], v13 offset:26624
    ds_read_b64_tr_b16 v[126:127], v13 offset:27136
    s_waitcnt lgkmcnt(6)
    v_mfma_f32_32x32x16_bf16 v[92:107], v[108:111], v[140:143], v[92:107]
    ds_read_b64_tr_b16 v[128:129], v13 offset:28672
    ds_read_b64_tr_b16 v[130:131], v13 offset:29184
    v_mfma_f32_32x32x16_bf16 v[92:107], v[112:115], v[144:147], v[92:107]
    ds_read_b64_tr_b16 v[132:133], v13 offset:30720
    ds_read_b64_tr_b16 v[134:135], v13 offset:31232
    s_nop 2
    v_fma_f32 v60, -v32, v32, s61
    v_fma_f32 v61, -v33, v33, s61
    v_fma_f32 v62, -v34, v34, s61
    v_fma_f32 v63, -v35, v35, s61
    v_mul_f32 v60, v60, v32
    v_mul_f32 v61, v61, v33
    s_waitcnt lgkmcnt(6)
    v_mfma_f32_32x32x16_bf16 v[92:107], v[116:119], v[148:151], v[92:107]
    ds_read_b64_tr_b16 v[136:137], v13 offset:32768
    ds_read_b64_tr_b16 v[138:139], v13 offset:33280
    v_mul_f32 v62, v62, v34
    v_mul_f32 v63, v63, v35
    v_exp_f32 v60, v60
    v_exp_f32 v61, v61
    v_exp_f32 v62, v62
    v_mfma_f32_32x32x16_bf16 v[92:107], v[120:123], v[152:155], v[92:107]
    ds_read_b64_tr_b16 v[108:109], v13 offset:34816
    ds_read_b64_tr_b16 v[110:111], v13 offset:35328
    v_exp_f32 v63, v63
    v_fma_f32 v60, v60, s62, s62
    v_fma_f32 v61, v61, s62, s62
    v_fma_f32 v62, v62, s62, s62
    v_fma_f32 v63, v63, s62, s62
    s_waitcnt lgkmcnt(6)
    v_mfma_f32_32x32x16_bf16 v[92:107], v[124:127], v[156:159], v[92:107]
    ds_read_b64_tr_b16 v[112:113], v13 offset:36864
    ds_read_b64_tr_b16 v[114:115], v13 offset:37376
    v_rcp_f32 v60, v60
    v_rcp_f32 v61, v61
    v_rcp_f32 v62, v62
    v_rcp_f32 v63, v63
    v_mul_f32 v60, v60, v32
    v_mfma_f32_32x32x16_bf16 v[92:107], v[128:131], v[160:163], v[92:107]
    ds_read_b64_tr_b16 v[116:117], v13 offset:38912
    ds_read_b64_tr_b16 v[118:119], v13 offset:39424
    v_mul_f32 v61, v61, v33
    v_mul_f32 v62, v62, v34
    v_mul_f32 v63, v63, v35
    v_cvt_pk_bf16_f32 v76, v60, v61
    v_cvt_pk_bf16_f32 v77, v62, v63
    s_waitcnt lgkmcnt(6)
    v_mfma_f32_32x32x16_bf16 v[92:107], v[132:135], v[164:167], v[92:107]
    ds_read_b64_tr_b16 v[120:121], v13 offset:40960
    ds_read_b64_tr_b16 v[122:123], v13 offset:41472
    v_fma_f32 v64, -v36, v36, s61
    v_fma_f32 v65, -v37, v37, s61
    v_fma_f32 v66, -v38, v38, s61
    v_fma_f32 v67, -v39, v39, s61
    v_mul_f32 v64, v64, v36
    v_mul_f32 v65, v65, v37
    v_mfma_f32_32x32x16_bf16 v[92:107], v[136:139], v[168:171], v[92:107]
    ds_read_b64_tr_b16 v[124:125], v13 offset:43008
    ds_read_b64_tr_b16 v[126:127], v13 offset:43520
    v_mul_f32 v66, v66, v38
    v_mul_f32 v67, v67, v39
    v_exp_f32 v64, v64
    v_exp_f32 v65, v65
    v_exp_f32 v66, v66
    s_waitcnt lgkmcnt(6)
    v_mfma_f32_32x32x16_bf16 v[92:107], v[108:111], v[172:175], v[92:107]
    ds_read_b64_tr_b16 v[128:129], v13 offset:45056
    ds_read_b64_tr_b16 v[130:131], v13 offset:45568
    v_exp_f32 v67, v67
    v_fma_f32 v64, v64, s62, s62
    v_fma_f32 v65, v65, s62, s62
    v_fma_f32 v66, v66, s62, s62
    v_fma_f32 v67, v67, s62, s62
    v_mfma_f32_32x32x16_bf16 v[92:107], v[112:115], v[176:179], v[92:107]
    ds_read_b64_tr_b16 v[132:133], v13 offset:47104
    ds_read_b64_tr_b16 v[134:135], v13 offset:47616
    v_rcp_f32 v64, v64
    v_rcp_f32 v65, v65
    v_rcp_f32 v66, v66
    v_rcp_f32 v67, v67
    v_mul_f32 v64, v64, v36
    s_waitcnt lgkmcnt(6)
    v_mfma_f32_32x32x16_bf16 v[92:107], v[116:119], v[180:183], v[92:107]
    ds_read_b64_tr_b16 v[136:137], v13 offset:49152
    ds_read_b64_tr_b16 v[138:139], v13 offset:49664
    v_mul_f32 v65, v65, v37
    v_mul_f32 v66, v66, v38
    v_mul_f32 v67, v67, v39
    v_cvt_pk_bf16_f32 v78, v64, v65
    v_cvt_pk_bf16_f32 v79, v66, v67
    v_mfma_f32_32x32x16_bf16 v[92:107], v[120:123], v[184:187], v[92:107]
    s_barrier
    ds_read_b64_tr_b16 v[108:109], v12 offset:18432
    ds_read_b64_tr_b16 v[110:111], v12 offset:18944
    v_fma_f32 v60, -v40, v40, s61
    v_fma_f32 v61, -v41, v41, s61
    v_fma_f32 v62, -v42, v42, s61
    v_fma_f32 v63, -v43, v43, s61
    v_mul_f32 v60, v60, v40
    v_mul_f32 v61, v61, v41
    s_waitcnt lgkmcnt(6)
    v_mfma_f32_32x32x16_bf16 v[92:107], v[124:127], v[188:191], v[92:107]
    ds_read_b64_tr_b16 v[112:113], v12 offset:20480
    ds_read_b64_tr_b16 v[114:115], v12 offset:20992
    v_mul_f32 v62, v62, v42
    v_mul_f32 v63, v63, v43
    v_exp_f32 v60, v60
    v_exp_f32 v61, v61
    v_exp_f32 v62, v62
    v_mfma_f32_32x32x16_bf16 v[92:107], v[128:131], v[192:195], v[92:107]
    ds_read_b64_tr_b16 v[116:117], v12 offset:22528
    ds_read_b64_tr_b16 v[118:119], v12 offset:23040
    v_exp_f32 v63, v63
    v_fma_f32 v60, v60, s62, s62
    v_fma_f32 v61, v61, s62, s62
    v_fma_f32 v62, v62, s62, s62
    v_fma_f32 v63, v63, s62, s62
    s_waitcnt lgkmcnt(6)
    v_mfma_f32_32x32x16_bf16 v[92:107], v[132:135], v[196:199], v[92:107]
    ds_read_b64_tr_b16 v[120:121], v12 offset:24576
    ds_read_b64_tr_b16 v[122:123], v12 offset:25088
    v_rcp_f32 v60, v60
    v_rcp_f32 v61, v61
    v_rcp_f32 v62, v62
    v_rcp_f32 v63, v63
    v_mul_f32 v60, v60, v40
    v_mfma_f32_32x32x16_bf16 v[92:107], v[136:139], v[200:203], v[92:107]
    ds_read_b64_tr_b16 v[124:125], v12 offset:26624
    ds_read_b64_tr_b16 v[126:127], v12 offset:27136
    v_mul_f32 v61, v61, v41
    v_mul_f32 v62, v62, v42
    v_mul_f32 v63, v63, v43
    v_cvt_pk_bf16_f32 v80, v60, v61
    v_cvt_pk_bf16_f32 v81, v62, v63
    s_waitcnt lgkmcnt(6)
    v_mfma_f32_32x32x16_bf16 v[92:107], v[108:111], v[204:207], v[92:107]
    ds_read_b64_tr_b16 v[128:129], v12 offset:28672
    ds_read_b64_tr_b16 v[130:131], v12 offset:29184
    v_fma_f32 v64, -v44, v44, s61
    v_fma_f32 v65, -v45, v45, s61
    v_fma_f32 v66, -v46, v46, s61
    v_fma_f32 v67, -v47, v47, s61
    v_mul_f32 v64, v64, v44
    v_mul_f32 v65, v65, v45
    v_mfma_f32_32x32x16_bf16 v[92:107], v[112:115], v[208:211], v[92:107]
    ds_read_b64_tr_b16 v[132:133], v12 offset:30720
    ds_read_b64_tr_b16 v[134:135], v12 offset:31232
    v_mul_f32 v66, v66, v46
    v_mul_f32 v67, v67, v47
    v_exp_f32 v64, v64
    v_exp_f32 v65, v65
    v_exp_f32 v66, v66
    s_waitcnt lgkmcnt(6)
    v_mfma_f32_32x32x16_bf16 v[92:107], v[116:119], v[212:215], v[92:107]
    ds_read_b64_tr_b16 v[136:137], v12 offset:32768
    ds_read_b64_tr_b16 v[138:139], v12 offset:33280
    v_exp_f32 v67, v67
    v_fma_f32 v64, v64, s62, s62
    v_fma_f32 v65, v65, s62, s62
    v_fma_f32 v66, v66, s62, s62
    v_fma_f32 v67, v67, s62, s62
    v_mfma_f32_32x32x16_bf16 v[92:107], v[120:123], v[216:219], v[92:107]
    ds_read_b64_tr_b16 v[108:109], v12 offset:34816
    ds_read_b64_tr_b16 v[110:111], v12 offset:35328
    v_rcp_f32 v64, v64
    v_rcp_f32 v65, v65
    v_rcp_f32 v66, v66
    v_rcp_f32 v67, v67
    v_mul_f32 v64, v64, v44
    s_waitcnt lgkmcnt(6)
    v_mfma_f32_32x32x16_bf16 v[92:107], v[124:127], v[220:223], v[92:107]
    ds_read_b64_tr_b16 v[112:113], v12 offset:36864
    ds_read_b64_tr_b16 v[114:115], v12 offset:37376
    v_mul_f32 v65, v65, v45
    v_mul_f32 v66, v66, v46
    v_mul_f32 v67, v67, v47
    v_cvt_pk_bf16_f32 v82, v64, v65
    v_cvt_pk_bf16_f32 v83, v66, v67
    v_mfma_f32_32x32x16_bf16 v[92:107], v[128:131], v[224:227], v[92:107]
    s_barrier
    ds_write_b128 v6, v[68:71] offset:0
    ds_write_b128 v6, v[72:75] offset:16
    ds_write_b128 v6, v[76:79] offset:9216
    ds_write_b128 v6, v[80:83] offset:9232
    ds_read_b64_tr_b16 v[116:117], v12 offset:38912
    ds_read_b64_tr_b16 v[118:119], v12 offset:39424
    s_waitcnt lgkmcnt(10)
    v_mfma_f32_32x32x16_bf16 v[92:107], v[132:135], v[228:231], v[92:107]
    ds_read_b64_tr_b16 v[120:121], v12 offset:40960
    ds_read_b64_tr_b16 v[122:123], v12 offset:41472
    v_mfma_f32_32x32x16_bf16 v[92:107], v[136:139], v[232:235], v[92:107]
    s_waitcnt lgkmcnt(8)
    v_mfma_f32_32x32x16_bf16 v[92:107], v[108:111], v[236:239], v[92:107]
    v_mfma_f32_32x32x16_bf16 v[92:107], v[112:115], v[240:243], v[92:107]
    s_waitcnt lgkmcnt(4)
    s_barrier
    s_waitcnt lgkmcnt(0)
    v_mfma_f32_32x32x16_bf16 v[92:107], v[116:119], v[244:247], v[92:107]
    v_mfma_f32_32x32x16_bf16 v[92:107], v[120:123], v[248:251], v[92:107]
    ds_read_b128 v[32:35], v7 offset:768
    ds_read_b128 v[36:39], v7 offset:784
    ds_read_b128 v[40:43], v7 offset:800
    ds_read_b128 v[44:47], v7 offset:816
    s_nop 7
    v_fma_f32 v60, -v92, v92, s61
    v_fma_f32 v61, -v93, v93, s61
    v_fma_f32 v62, -v94, v94, s61
    v_fma_f32 v63, -v95, v95, s61
    v_mul_f32 v60, v60, v92
    v_mul_f32 v61, v61, v93
    v_mul_f32 v62, v62, v94
    v_mul_f32 v63, v63, v95
    v_exp_f32 v60, v60
    v_exp_f32 v61, v61
    v_exp_f32 v62, v62
    v_exp_f32 v63, v63
    v_fma_f32 v60, v60, s62, s62
    v_fma_f32 v61, v61, s62, s62
    v_fma_f32 v62, v62, s62, s62
    v_fma_f32 v63, v63, s62, s62
    v_rcp_f32 v60, v60
    v_rcp_f32 v61, v61
    v_rcp_f32 v62, v62
    v_rcp_f32 v63, v63
    v_mul_f32 v60, v60, v92
    v_mul_f32 v61, v61, v93
    v_mul_f32 v62, v62, v94
    v_mul_f32 v63, v63, v95
    v_cvt_pk_bf16_f32 v68, v60, v61
    v_cvt_pk_bf16_f32 v69, v62, v63
    v_fma_f32 v64, -v96, v96, s61
    v_fma_f32 v65, -v97, v97, s61
    v_fma_f32 v66, -v98, v98, s61
    v_fma_f32 v67, -v99, v99, s61
    v_mul_f32 v64, v64, v96
    v_mul_f32 v65, v65, v97
    v_mul_f32 v66, v66, v98
    v_mul_f32 v67, v67, v99
    s_branch L_page2
.p2align 12
L_stub_A0:
    s_branch L_warm
    s_nop 0
L_page2:
    s_barrier
    v_exp_f32 v64, v64
    v_exp_f32 v65, v65
    v_exp_f32 v66, v66
    v_exp_f32 v67, v67
    v_fma_f32 v64, v64, s62, s62
    v_fma_f32 v65, v65, s62, s62
    v_fma_f32 v66, v66, s62, s62
    v_fma_f32 v67, v67, s62, s62
    v_rcp_f32 v64, v64
    v_rcp_f32 v65, v65
    v_rcp_f32 v66, v66
    v_rcp_f32 v67, v67
    v_mul_f32 v64, v64, v96
    v_mul_f32 v65, v65, v97
    v_mul_f32 v66, v66, v98
    v_mul_f32 v67, v67, v99
    v_cvt_pk_bf16_f32 v70, v64, v65
    v_cvt_pk_bf16_f32 v71, v66, v67
    v_fma_f32 v60, -v100, v100, s61
    v_fma_f32 v61, -v101, v101, s61
    v_fma_f32 v62, -v102, v102, s61
    v_fma_f32 v63, -v103, v103, s61
    v_mul_f32 v60, v60, v100
    v_mul_f32 v61, v61, v101
    v_mul_f32 v62, v62, v102
    v_mul_f32 v63, v63, v103
    v_exp_f32 v60, v60
    v_exp_f32 v61, v61
    v_exp_f32 v62, v62
    v_exp_f32 v63, v63
    v_fma_f32 v60, v60, s62, s62
    v_fma_f32 v61, v61, s62, s62
    v_fma_f32 v62, v62, s62, s62
    v_fma_f32 v63, v63, s62, s62
    v_rcp_f32 v60, v60
    v_rcp_f32 v61, v61
    v_rcp_f32 v62, v62
    v_rcp_f32 v63, v63
    v_mul_f32 v60, v60, v100
    v_mul_f32 v61, v61, v101
    v_mul_f32 v62, v62, v102
    v_mul_f32 v63, v63, v103
    v_cvt_pk_bf16_f32 v72, v60, v61
    v_cvt_pk_bf16_f32 v73, v62, v63
    v_fma_f32 v64, -v104, v104, s61
    v_fma_f32 v65, -v105, v105, s61
    v_fma_f32 v66, -v106, v106, s61
    v_fma_f32 v67, -v107, v107, s61
    v_mul_f32 v64, v64, v104
    v_mul_f32 v65, v65, v105
    v_mul_f32 v66, v66, v106
    v_mul_f32 v67, v67, v107
    v_exp_f32 v64, v64
    s_barrier
    ds_read_b64_tr_b16 v[124:125], v13 offset:2048
    ds_read_b64_tr_b16 v[126:127], v13 offset:2560
    ds_read_b64_tr_b16 v[128:129], v13 offset:4096
    ds_read_b64_tr_b16 v[130:131], v13 offset:4608
    ds_read_b64_tr_b16 v[132:133], v13 offset:6144
    ds_read_b64_tr_b16 v[134:135], v13 offset:6656
    ds_read_b64_tr_b16 v[136:137], v13 offset:8192
    ds_read_b64_tr_b16 v[138:139], v13 offset:8704
    ds_read_b64_tr_b16 v[108:109], v13 offset:10240
    ds_read_b64_tr_b16 v[110:111], v13 offset:10752
    v_exp_f32 v65, v65
    v_exp_f32 v66, v66
    v_exp_f32 v67, v67
    v_fma_f32 v64, v64, s62, s62
    s_waitcnt lgkmcnt(6)
    v_mfma_f32_32x32x16_bf16 v[32:47], v[124:127], v[140:143], v[32:47]
    ds_read_b64_tr_b16 v[112:113], v13 offset:12288
    ds_read_b64_tr_b16 v[114:115], v13 offset:12800
    v_fma_f32 v65, v65, s62, s62
    v_mfma_f32_32x32x16_bf16 v[32:47], v[128:131], v[144:147], v[32:47]
    ds_read_b64_tr_b16 v[116:117], v13 offset:14336
    ds_read_b64_tr_b16 v[118:119], v13 offset:14848
    v_fma_f32 v66, v66, s62, s62
    s_waitcnt lgkmcnt(6)
    v_mfma_f32_32x32x16_bf16 v[32:47], v[132:135], v[148:151], v[32:47]
    ds_read_b64_tr_b16 v[120:121], v13 offset:16384
    ds_read_b64_tr_b16 v[122:123], v13 offset:16896
    v_fma_f32 v67, v67, s62, s62
    v_mfma_f32_32x32x16_bf16 v[32:47], v[136:139], v[152:155], v[32:47]
    ds_read_b64_tr_b16 v[124:125], v13 offset:18432
    ds_read_b64_tr_b16 v[126:127], v13 offset:18944
    v_rcp_f32 v64, v64
    s_waitcnt lgkmcnt(6)
    v_mfma_f32_32x32x16_bf16 v[32:47], v[108:111], v[156:159], v[32:47]
    ds_read_b64_tr_b16 v[128:129], v13 offset:20480
    ds_read_b64_tr_b16 v[130:131], v13 offset:20992
    v_rcp_f32 v65, v65
    v_mfma_f32_32x32x16_bf16 v[32:47], v[112:115], v[160:163], v[32:47]
    ds_read_b64_tr_b16 v[132:133], v13 offset:22528
    ds_read_b64_tr_b16 v[134:135], v13 offset:23040
    s_waitcnt lgkmcnt(6)
    v_mfma_f32_32x32x16_bf16 v[32:47], v[116:119], v[164:167], v[32:47]
    ds_read_b64_tr_b16 v[136:137], v13 offset:24576
    ds_read_b64_tr_b16 v[138:139], v13 offset:25088
    v_rcp_f32 v66, v66
    v_mfma_f32_32x32x16_bf16 v[32:47], v[120:123], v[168:171], v[32:47]
    ds_read_b64_tr_b16 v[108:109], v13 offset:26624
    ds_read_b64_tr_b16 v[110:111], v13 offset:27136
    v_rcp_f32 v67, v67
    s_waitcnt lgkmcnt(6)
    v_mfma_f32_32x32x16_bf16 v[32:47], v[124:127], v[172:175], v[32:47]
    ds_read_b64_tr_b16 v[112:113], v13 offset:28672
    ds_read_b64_tr_b16 v[114:115], v13 offset:29184
    v_mul_f32 v64, v64, v104
    v_mfma_f32_32x32x16_bf16 v[32:47], v[128:131], v[176:179], v[32:47]
    ds_read_b64_tr_b16 v[116:117], v13 offset:30720
    ds_read_b64_tr_b16 v[118:119], v13 offset:31232
    v_mul_f32 v65, v65, v105
    s_waitcnt lgkmcnt(6)
    v_mfma_f32_32x32x16_bf16 v[32:47], v[132:135], v[180:183], v[32:47]
    ds_read_b64_tr_b16 v[120:121], v13 offset:32768
    ds_read_b64_tr_b16 v[122:123], v13 offset:33280
    v_mfma_f32_32x32x16_bf16 v[32:47], v[136:139], v[184:187], v[32:47]
    s_barrier
    ds_read_b64_tr_b16 v[124:125], v13 offset:34816
    ds_read_b64_tr_b16 v[126:127], v13 offset:35328
    v_mul_f32 v66, v66, v106
    s_waitcnt lgkmcnt(6)
    v_mfma_f32_32x32x16_bf16 v[32:47], v[108:111], v[188:191], v[32:47]
    ds_read_b64_tr_b16 v[128:129], v13 offset:36864
    ds_read_b64_tr_b16 v[130:131], v13 offset:37376
    v_mul_f32 v67, v67, v107
    v_mfma_f32_32x32x16_bf16 v[32:47], v[112:115], v[192:195], v[32:47]
    ds_read_b64_tr_b16 v[132:133], v13 offset:38912
    ds_read_b64_tr_b16 v[134:135], v13 offset:39424
    v_cvt_pk_bf16_f32 v74, v64, v65
    s_waitcnt lgkmcnt(6)
    v_mfma_f32_32x32x16_bf16 v[32:47], v[116:119], v[196:199], v[32:47]
    ds_read_b64_tr_b16 v[136:137], v13 offset:40960
    ds_read_b64_tr_b16 v[138:139], v13 offset:41472
    v_cvt_pk_bf16_f32 v75, v66, v67
    v_mfma_f32_32x32x16_bf16 v[32:47], v[120:123], v[200:203], v[32:47]
    ds_read_b64_tr_b16 v[108:109], v13 offset:43008
    ds_read_b64_tr_b16 v[110:111], v13 offset:43520
    s_waitcnt lgkmcnt(6)
    v_mfma_f32_32x32x16_bf16 v[32:47], v[124:127], v[204:207], v[32:47]
    ds_read_b64_tr_b16 v[112:113], v13 offset:45056
    ds_read_b64_tr_b16 v[114:115], v13 offset:45568
    v_mfma_f32_32x32x16_bf16 v[32:47], v[128:131], v[208:211], v[32:47]
    ds_read_b64_tr_b16 v[116:117], v13 offset:47104
    ds_read_b64_tr_b16 v[118:119], v13 offset:47616
    s_waitcnt lgkmcnt(6)
    v_mfma_f32_32x32x16_bf16 v[32:47], v[132:135], v[212:215], v[32:47]
    ds_read_b64_tr_b16 v[120:121], v13 offset:49152
    ds_read_b64_tr_b16 v[122:123], v13 offset:49664
    v_mfma_f32_32x32x16_bf16 v[32:47], v[136:139], v[216:219], v[32:47]
    ds_read_b64_tr_b16 v[124:125], v12 offset:18432
    ds_read_b64_tr_b16 v[126:127], v12 offset:18944
    s_waitcnt lgkmcnt(6)
    v_mfma_f32_32x32x16_bf16 v[32:47], v[108:111], v[220:223], v[32:47]
    ds_read_b64_tr_b16 v[128:129], v12 offset:20480
    ds_read_b64_tr_b16 v[130:131], v12 offset:20992
    v_mfma_f32_32x32x16_bf16 v[32:47], v[112:115], v[224:227], v[32:47]
    ds_read_b64_tr_b16 v[132:133], v12 offset:22528
    ds_read_b64_tr_b16 v[134:135], v12 offset:23040
    s_waitcnt lgkmcnt(6)
    v_mfma_f32_32x32x16_bf16 v[32:47], v[116:119], v[228:231], v[32:47]
    ds_read_b64_tr_b16 v[136:137], v12 offset:24576
    ds_read_b64_tr_b16 v[138:139], v12 offset:25088
    v_mfma_f32_32x32x16_bf16 v[32:47], v[120:123], v[232:235], v[32:47]
    s_waitcnt lgkmcnt(4)
    v_mfma_f32_32x32x16_bf16 v[32:47], v[124:127], v[236:239], v[32:47]
    v_mfma_f32_32x32x16_bf16 v[32:47], v[128:131], v[240:243], v[32:47]
    s_barrier
    s_waitcnt lgkmcnt(0)
    v_mfma_f32_32x32x16_bf16 v[32:47], v[132:135], v[244:247], v[32:47]
    v_mfma_f32_32x32x16_bf16 v[32:47], v[136:139], v[248:251], v[32:47]
    ds_read_b128 v[92:95], v7 offset:1024
    ds_read_b128 v[96:99], v7 offset:1040
    ds_read_b128 v[100:103], v7 offset:1056
    ds_read_b128 v[104:107], v7 offset:1072
    s_nop 7
    v_fma_f32 v60, -v32, v32, s61
    v_fma_f32 v61, -v33, v33, s61
    v_fma_f32 v62, -v34, v34, s61
    v_fma_f32 v63, -v35, v35, s61
    v_mul_f32 v60, v60, v32
    v_mul_f32 v61, v61, v33
    v_mul_f32 v62, v62, v34
    v_mul_f32 v63, v63, v35
    v_exp_f32 v60, v60
    v_exp_f32 v61, v61
    v_exp_f32 v62, v62
    v_exp_f32 v63, v63
    v_fma_f32 v60, v60, s62, s62
    v_fma_f32 v61, v61, s62, s62
    v_fma_f32 v62, v62, s62, s62
    v_fma_f32 v63, v63, s62, s62
    v_rcp_f32 v60, v60
    v_rcp_f32 v61, v61
    v_rcp_f32 v62, v62
    v_rcp_f32 v63, v63
    v_mul_f32 v60, v60, v32
    v_mul_f32 v61, v61, v33
    v_mul_f32 v62, v62, v34
    v_mul_f32 v63, v63, v35
    v_cvt_pk_bf16_f32 v76, v60, v61
    v_cvt_pk_bf16_f32 v77, v62, v63
    v_fma_f32 v64, -v36, v36, s61
    v_fma_f32 v65, -v37, v37, s61
    v_fma_f32 v66, -v38, v38, s61
    v_fma_f32 v67, -v39, v39, s61
    s_barrier
    v_mul_f32 v64, v64, v36
    v_mul_f32 v65, v65, v37
    v_mul_f32 v66, v66, v38
    v_mul_f32 v67, v67, v39
    v_exp_f32 v64, v64
    v_exp_f32 v65, v65
    v_exp_f32 v66, v66
    v_exp_f32 v67, v67
    v_fma_f32 v64, v64, s62, s62
    v_fma_f32 v65, v65, s62, s62
    v_fma_f32 v66, v66, s62, s62
    v_fma_f32 v67, v67, s62, s62
    v_rcp_f32 v64, v64
    v_rcp_f32 v65, v65
    v_rcp_f32 v66, v66
    v_rcp_f32 v67, v67
    v_mul_f32 v64, v64, v36
    v_mul_f32 v65, v65, v37
    v_mul_f32 v66, v66, v38
    v_mul_f32 v67, v67, v39
    v_cvt_pk_bf16_f32 v78, v64, v65
    v_cvt_pk_bf16_f32 v79, v66, v67
    v_fma_f32 v60, -v40, v40, s61
    v_fma_f32 v61, -v41, v41, s61
    v_fma_f32 v62, -v42, v42, s61
    v_fma_f32 v63, -v43, v43, s61
    v_mul_f32 v60, v60, v40
    v_mul_f32 v61, v61, v41
    v_mul_f32 v62, v62, v42
    v_mul_f32 v63, v63, v43
    v_exp_f32 v60, v60
    v_exp_f32 v61, v61
    v_exp_f32 v62, v62
    v_exp_f32 v63, v63
    v_fma_f32 v60, v60, s62, s62
    v_fma_f32 v61, v61, s62, s62
    v_fma_f32 v62, v62, s62, s62
    v_fma_f32 v63, v63, s62, s62
    v_rcp_f32 v60, v60
    v_rcp_f32 v61, v61
    v_rcp_f32 v62, v62
    v_rcp_f32 v63, v63
    v_mul_f32 v60, v60, v40
    v_mul_f32 v61, v61, v41
    v_mul_f32 v62, v62, v42
    v_mul_f32 v63, v63, v43
    v_cvt_pk_bf16_f32 v80, v60, v61
    v_cvt_pk_bf16_f32 v81, v62, v63
    v_fma_f32 v64, -v44, v44, s61
    v_fma_f32 v65, -v45, v45, s61
    v_fma_f32 v66, -v46, v46, s61
    v_fma_f32 v67, -v47, v47, s61
    v_mul_f32 v64, v64, v44
    s_barrier
    ds_read_b64_tr_b16 v[108:109], v14 offset:26624
    ds_read_b64_tr_b16 v[110:111], v14 offset:27136
    ds_read_b64_tr_b16 v[112:113], v14 offset:28672
    ds_read_b64_tr_b16 v[114:115], v14 offset:29184
    ds_read_b64_tr_b16 v[116:117], v14 offset:30720
    ds_read_b64_tr_b16 v[118:119], v14 offset:31232
    ds_read_b64_tr_b16 v[120:121], v14 offset:32768
    ds_read_b64_tr_b16 v[122:123], v14 offset:33280
    ds_read_b64_tr_b16 v[124:125], v14 offset:34816
    ds_read_b64_tr_b16 v[126:127], v14 offset:35328
    v_mul_f32 v65, v65, v45
    v_mul_f32 v66, v66, v46
    v_mul_f32 v67, v67, v47
    v_exp_f32 v64, v64
    s_waitcnt lgkmcnt(6)
    v_mfma_f32_32x32x16_bf16 v[92:107], v[108:111], v[140:143], v[92:107]
    ds_read_b64_tr_b16 v[128:129], v14 offset:36864
    ds_read_b64_tr_b16 v[130:131], v14 offset:37376
    v_exp_f32 v65, v65
    v_exp_f32 v66, v66
    v_mfma_f32_32x32x16_bf16 v[92:107], v[112:115], v[144:147], v[92:107]
    ds_read_b64_tr_b16 v[132:133], v14 offset:38912
    ds_read_b64_tr_b16 v[134:135], v14 offset:39424
    v_exp_f32 v67, v67
    v_fma_f32 v64, v64, s62, s62
    s_waitcnt lgkmcnt(6)
    v_mfma_f32_32x32x16_bf16 v[92:107], v[116:119], v[148:151], v[92:107]
    ds_read_b64_tr_b16 v[136:137], v14 offset:40960
    ds_read_b64_tr_b16 v[138:139], v14 offset:41472
    v_fma_f32 v65, v65, s62, s62
    v_mfma_f32_32x32x16_bf16 v[92:107], v[120:123], v[152:155], v[92:107]
    ds_read_b64_tr_b16 v[108:109], v13 offset:2048
    ds_read_b64_tr_b16 v[110:111], v13 offset:2560
    v_fma_f32 v66, v66, s62, s62
    v_fma_f32 v67, v67, s62, s62
    s_waitcnt lgkmcnt(6)
    v_mfma_f32_32x32x16_bf16 v[92:107], v[124:127], v[156:159], v[92:107]
    ds_read_b64_tr_b16 v[112:113], v13 offset:4096
    ds_read_b64_tr_b16 v[114:115], v13 offset:4608
    v_rcp_f32 v64, v64
    v_mfma_f32_32x32x16_bf16 v[92:107], v[128:131], v[160:163], v[92:107]
    ds_read_b64_tr_b16 v[116:117], v13 offset:6144
    ds_read_b64_tr_b16 v[118:119], v13 offset:6656
    v_rcp_f32 v65, v65
    v_rcp_f32 v66, v66
    s_waitcnt lgkmcnt(6)
    v_mfma_f32_32x32x16_bf16 v[92:107], v[132:135], v[164:167], v[92:107]
    ds_read_b64_tr_b16 v[120:121], v13 offset:8192
    ds_read_b64_tr_b16 v[122:123], v13 offset:8704
    v_rcp_f32 v67, v67
    v_mfma_f32_32x32x16_bf16 v[92:107], v[136:139], v[168:171], v[92:107]
    ds_read_b64_tr_b16 v[124:125], v13 offset:10240
    ds_read_b64_tr_b16 v[126:127], v13 offset:10752
    v_mul_f32 v64, v64, v44
    v_mul_f32 v65, v65, v45
    s_waitcnt lgkmcnt(6)
    v_mfma_f32_32x32x16_bf16 v[92:107], v[108:111], v[172:175], v[92:107]
    ds_read_b64_tr_b16 v[128:129], v13 offset:12288
    ds_read_b64_tr_b16 v[130:131], v13 offset:12800
    v_mul_f32 v66, v66, v46
    v_mfma_f32_32x32x16_bf16 v[92:107], v[112:115], v[176:179], v[92:107]
    ds_read_b64_tr_b16 v[132:133], v13 offset:14336
    ds_read_b64_tr_b16 v[134:135], v13 offset:14848
    v_mul_f32 v67, v67, v47
    v_cvt_pk_bf16_f32 v82, v64, v65
    s_waitcnt lgkmcnt(6)
    v_mfma_f32_32x32x16_bf16 v[92:107], v[116:119], v[180:183], v[92:107]
    ds_read_b64_tr_b16 v[136:137], v13 offset:16384
    ds_read_b64_tr_b16 v[138:139], v13 offset:16896
    v_cvt_pk_bf16_f32 v83, v66, v67
    v_mfma_f32_32x32x16_bf16 v[92:107], v[120:123], v[184:187], v[92:107]
    s_barrier
    ds_write_b128 v6, v[68:71] offset:0
    ds_write_b128 v6, v[72:75] offset:16
    ds_write_b128 v6, v[76:79] offset:9216
    ds_write_b128 v6, v[80:83] offset:9232
    ds_read_b64_tr_b16 v[108:109], v13 offset:18432
    ds_read_b64_tr_b16 v[110:111], v13 offset:18944
    s_waitcnt lgkmcnt(10)
    v_mfma_f32_32x32x16_bf16 v[92:107], v[124:127], v[188:191], v[92:107]
    ds_read_b64_tr_b16 v[112:113], v13 offset:20480
    ds_read_b64_tr_b16 v[114:115], v13 offset:20992
    v_mfma_f32_32x32x16_bf16 v[92:107], v[128:131], v[192:195], v[92:107]
    ds_read_b64_tr_b16 v[116:117], v13 offset:22528
    ds_read_b64_tr_b16 v[118:119], v13 offset:23040
    s_waitcnt lgkmcnt(10)
    v_mfma_f32_32x32x16_bf16 v[92:107], v[132:135], v[196:199], v[92:107]
    ds_read_b64_tr_b16 v[120:121], v13 offset:24576
    ds_read_b64_tr_b16 v[122:123], v13 offset:25088
    v_mfma_f32_32x32x16_bf16 v[92:107], v[136:139], v[200:203], v[92:107]
    ds_read_b64_tr_b16 v[124:125], v13 offset:26624
    ds_read_b64_tr_b16 v[126:127], v13 offset:27136
    s_waitcnt lgkmcnt(6)
    v_mfma_f32_32x32x16_bf16 v[92:107], v[108:111], v[204:207], v[92:107]
    ds_read_b64_tr_b16 v[128:129], v13 offset:28672
    ds_read_b64_tr_b16 v[130:131], v13 offset:29184
    v_mfma_f32_32x32x16_bf16 v[92:107], v[112:115], v[208:211], v[92:107]
    ds_read_b64_tr_b16 v[132:133], v13 offset:30720
    ds_read_b64_tr_b16 v[134:135], v13 offset:31232
    s_waitcnt lgkmcnt(6)
    v_mfma_f32_32x32x16_bf16 v[92:107], v[116:119], v[212:215], v[92:107]
    ds_read_b64_tr_b16 v[136:137], v13 offset:32768
    ds_read_b64_tr_b16 v[138:139], v13 offset:33280
    v_mfma_f32_32x32x16_bf16 v[92:107], v[120:123], v[216:219], v[92:107]
    ds_read_b64_tr_b16 v[108:109], v13 offset:34816
    ds_read_b64_tr_b16 v[110:111], v13 offset:35328
    s_waitcnt lgkmcnt(6)
    v_mfma_f32_32x32x16_bf16 v[92:107], v[124:127], v[220:223], v[92:107]
    ds_read_b64_tr_b16 v[112:113], v13 offset:36864
    ds_read_b64_tr_b16 v[114:115], v13 offset:37376
    v_mfma_f32_32x32x16_bf16 v[92:107], v[128:131], v[224:227], v[92:107]
    ds_read_b64_tr_b16 v[116:117], v13 offset:38912
    ds_read_b64_tr_b16 v[118:119], v13 offset:39424
    s_waitcnt lgkmcnt(6)
    v_mfma_f32_32x32x16_bf16 v[92:107], v[132:135], v[228:231], v[92:107]
    ds_read_b64_tr_b16 v[120:121], v13 offset:40960
    ds_read_b64_tr_b16 v[122:123], v13 offset:41472
    v_mfma_f32_32x32x16_bf16 v[92:107], v[136:139], v[232:235], v[92:107]
    s_barrier
    s_waitcnt lgkmcnt(4)
    v_mfma_f32_32x32x16_bf16 v[92:107], v[108:111], v[236:239], v[92:107]
    v_mfma_f32_32x32x16_bf16 v[92:107], v[112:115], v[240:243], v[92:107]
    s_waitcnt lgkmcnt(0)
    v_mfma_f32_32x32x16_bf16 v[92:107], v[116:119], v[244:247], v[92:107]
    v_mfma_f32_32x32x16_bf16 v[92:107], v[120:123], v[248:251], v[92:107]
    ds_read_b128 v[32:35], v7 offset:1280
    ds_read_b128 v[36:39], v7 offset:1296
    ds_read_b128 v[40:43], v7 offset:1312
    ds_read_b128 v[44:47], v7 offset:1328
    s_nop 7
    v_fma_f32 v60, -v92, v92, s61
    v_fma_f32 v61, -v93, v93, s61
    v_fma_f32 v62, -v94, v94, s61
    v_fma_f32 v63, -v95, v95, s61
    v_mul_f32 v60, v60, v92
    v_mul_f32 v61, v61, v93
    v_mul_f32 v62, v62, v94
    v_mul_f32 v63, v63, v95
    v_exp_f32 v60, v60
    v_exp_f32 v61, v61
    v_exp_f32 v62, v62
    v_exp_f32 v63, v63
    v_fma_f32 v60, v60, s62, s62
    v_fma_f32 v61, v61, s62, s62
    v_fma_f32 v62, v62, s62, s62
    v_fma_f32 v63, v63, s62, s62
    v_rcp_f32 v60, v60
    v_rcp_f32 v61, v61
    v_rcp_f32 v62, v62
    v_rcp_f32 v63, v63
    v_mul_f32 v60, v60, v92
    v_mul_f32 v61, v61, v93
    v_mul_f32 v62, v62, v94
    v_mul_f32 v63, v63, v95
    v_cvt_pk_bf16_f32 v68, v60, v61
    v_cvt_pk_bf16_f32 v69, v62, v63
    v_fma_f32 v64, -v96, v96, s61
    v_fma_f32 v65, -v97, v97, s61
    v_fma_f32 v66, -v98, v98, s61
    v_fma_f32 v67, -v99, v99, s61
    v_mul_f32 v64, v64, v96
    v_mul_f32 v65, v65, v97
    v_mul_f32 v66, v66, v98
    v_mul_f32 v67, v67, v99
    v_exp_f32 v64, v64
    v_exp_f32 v65, v65
    v_exp_f32 v66, v66
    v_exp_f32 v67, v67
    v_fma_f32 v64, v64, s62, s62
    v_fma_f32 v65, v65, s62, s62
    v_fma_f32 v66, v66, s62, s62
    v_fma_f32 v67, v67, s62, s62
    v_rcp_f32 v64, v64
    s_barrier
    v_rcp_f32 v65, v65
    v_rcp_f32 v66, v66
    v_rcp_f32 v67, v67
    v_mul_f32 v64, v64, v96
    v_mul_f32 v65, v65, v97
    v_mul_f32 v66, v66, v98
    v_mul_f32 v67, v67, v99
    v_cvt_pk_bf16_f32 v70, v64, v65
    v_cvt_pk_bf16_f32 v71, v66, v67
    v_fma_f32 v60, -v100, v100, s61
    v_fma_f32 v61, -v101, v101, s61
    v_fma_f32 v62, -v102, v102, s61
    v_fma_f32 v63, -v103, v103, s61
    v_mul_f32 v60, v60, v100
    v_mul_f32 v61, v61, v101
    v_mul_f32 v62, v62, v102
    v_mul_f32 v63, v63, v103
    v_exp_f32 v60, v60
    v_exp_f32 v61, v61
    v_exp_f32 v62, v62
    v_exp_f32 v63, v63
    v_fma_f32 v60, v60, s62, s62
    v_fma_f32 v61, v61, s62, s62
    v_fma_f32 v62, v62, s62, s62
    v_fma_f32 v63, v63, s62, s62
    v_rcp_f32 v60, v60
    v_rcp_f32 v61, v61
    v_rcp_f32 v62, v62
    v_rcp_f32 v63, v63
    v_mul_f32 v60, v60, v100
    v_mul_f32 v61, v61, v101
    v_mul_f32 v62, v62, v102
    v_mul_f32 v63, v63, v103
    v_cvt_pk_bf16_f32 v72, v60, v61
    v_cvt_pk_bf16_f32 v73, v62, v63
    v_fma_f32 v64, -v104, v104, s61
    v_fma_f32 v65, -v105, v105, s61
    v_fma_f32 v66, -v106, v106, s61
    v_fma_f32 v67, -v107, v107, s61
    v_mul_f32 v64, v64, v104
    s_branch L_page3
.p2align 12
L_stub_A1:
    s_branch L_warm
    s_nop 0
L_page3:
    s_barrier
    ds_read_b64_tr_b16 v[124:125], v14 offset:10240
    ds_read_b64_tr_b16 v[126:127], v14 offset:10752
    ds_read_b64_tr_b16 v[128:129], v14 offset:12288
    ds_read_b64_tr_b16 v[130:131], v14 offset:12800
    ds_read_b64_tr_b16 v[132:133], v14 offset:14336
    ds_read_b64_tr_b16 v[134:135], v14 offset:14848
    ds_read_b64_tr_b16 v[136:137], v14 offset:16384
    ds_read_b64_tr_b16 v[138:139], v14 offset:16896
    ds_read_b64_tr_b16 v[108:109], v14 offset:18432
    ds_read_b64_tr_b16 v[110:111], v14 offset:18944
    v_mul_f32 v65, v65, v105
    v_mul_f32 v66, v66, v106
    v_mul_f32 v67, v67, v107
    v_exp_f32 v64, v64
    s_waitcnt lgkmcnt(6)
    v_mfma_f32_32x32x16_bf16 v[32:47], v[124:127], v[140:143], v[32:47]
    ds_read_b64_tr_b16 v[112:113], v14 offset:20480
    ds_read_b64_tr_b16 v[114:115], v14 offset:20992
    v_exp_f32 v65, v65
    v_exp_f32 v66, v66
    v_mfma_f32_32x32x16_bf16 v[32:47], v[128:131], v[144:147], v[32:47]
    ds_read_b64_tr_b16 v[116:117], v14 offset:22528
    ds_read_b64_tr_b16 v[118:119], v14 offset:23040
    v_exp_f32 v67, v67
    s_waitcnt lgkmcnt(6)
    v_mfma_f32_32x32x16_bf16 v[32:47], v[132:135], v[148:151], v[32:47]
    ds_read_b64_tr_b16 v[120:121], v14 offset:24576
    ds_read_b64_tr_b16 v[122:123], v14 offset:25088
    v_fma_f32 v64, v64, s62, s62
    v_mfma_f32_32x32x16_bf16 v[32:47], v[136:139], v[152:155], v[32:47]
    ds_read_b64_tr_b16 v[124:125], v14 offset:26624
    ds_read_b64_tr_b16 v[126:127], v14 offset:27136
    v_fma_f32 v65, v65, s62, s62
    s_waitcnt lgkmcnt(6)
    v_mfma_f32_32x32x16_bf16 v[32:47], v[108:111], v[156:159], v[32:47]
    ds_read_b64_tr_b16 v[128:129], v14 offset:28672
    ds_read_b64_tr_b16 v[130:131], v14 offset:29184
    v_fma_f32 v66, v66, s62, s62
    v_mfma_f32_32x32x16_bf16 v[32:47], v[112:115], v[160:163], v[32:47]
    ds_read_b64_tr_b16 v[132:133], v14 offset:30720
    ds_read_b64_tr_b16 v[134:135], v14 offset:31232
    v_fma_f32 v67, v67, s62, s62
    s_waitcnt lgkmcnt(6)
    v_mfma_f32_32x32x16_bf16 v[32:47], v[116:119], v[164:167], v[32:47]
    ds_read_b64_tr_b16 v[136:137], v14 offset:32768
    ds_read_b64_tr_b16 v[138:139], v14 offset:33280
    v_rcp_f32 v64, v64
    v_mfma_f32_32x32x16_bf16 v[32:47], v[120:123], v[168:171], v[32:47]
    ds_read_b64_tr_b16 v[108:109], v14 offset:34816
    ds_read_b64_tr_b16 v[110:111], v14 offset:35328
    v_rcp_f32 v65, v65
    s_waitcnt lgkmcnt(6)
    v_mfma_f32_32x32x16_bf16 v[32:47], v[124:127], v[172:175], v[32:47]
    ds_read_b64_tr_b16 v[112:113], v14 offset:36864
    ds_read_b64_tr_b16 v[114:115], v14 offset:37376
    v_rcp_f32 v66, v66
    v_mfma_f32_32x32x16_bf16 v[32:47], v[128:131], v[176:179], v[32:47]
    ds_read_b64_tr_b16 v[116:117], v14 offset:38912
    ds_read_b64_tr_b16 v[118:119], v14 offset:39424
    v_rcp_f32 v67, v67
    s_waitcnt lgkmcnt(6)
    v_mfma_f32_32x32x16_bf16 v[32:47], v[132:135], v[180:183], v[32:47]
    ds_read_b64_tr_b16 v[120:121], v14 offset:40960
    ds_read_b64_tr_b16 v[122:123], v14 offset:41472
    v_mul_f32 v64, v64, v104
    v_mfma_f32_32x32x16_bf16 v[32:47], v[136:139], v[184:187], v[32:47]
    s_barrier
    ds_read_b64_tr_b16 v[124:125], v13 offset:2048
    ds_read_b64_tr_b16 v[126:127], v13 offset:2560
    v_mul_f32 v65, v65, v105
    s_waitcnt lgkmcnt(6)
    v_mfma_f32_32x32x16_bf16 v[32:47], v[108:111], v[188:191], v[32:47]
    ds_read_b64_tr_b16 v[128:129], v13 offset:4096
    ds_read_b64_tr_b16 v[130:131], v13 offset:4608
    v_mul_f32 v66, v66, v106
    v_mfma_f32_32x32x16_bf16 v[32:47], v[112:115], v[192:195], v[32:47]
    ds_read_b64_tr_b16 v[132:133], v13 offset:6144
    ds_read_b64_tr_b16 v[134:135], v13 offset:6656
    v_mul_f32 v67, v67, v107
    s_waitcnt lgkmcnt(6)
    v_mfma_f32_32x32x16_bf16 v[32:47], v[116:119], v[196:199], v[32:47]
    ds_read_b64_tr_b16 v[136:137], v13 offset:8192
    ds_read_b64_tr_b16 v[138:139], v13 offset:8704
    v_cvt_pk_bf16_f32 v74, v64, v65
    v_mfma_f32_32x32x16_bf16 v[32:47], v[120:123], v[200:203], v[32:47]
    ds_read_b64_tr_b16 v[108:109], v13 offset:10240
    ds_read_b64_tr_b16 v[110:111], v13 offset:10752
    v_cvt_pk_bf16_f32 v75, v66, v67
    s_waitcnt lgkmcnt(6)
    v_mfma_f32_32x32x16_bf16 v[32:47], v[124:127], v[204:207], v[32:47]
    ds_read_b64_tr_b16 v[112:113], v13 offset:12288
    ds_read_b64_tr_b16 v[114:115], v13 offset:12800
    v_mfma_f32_32x32x16_bf16 v[32:47], v[128:131], v[208:211], v[32:47]
    ds_read_b64_tr_b16 v[116:117], v13 offset:14336
    ds_read_b64_tr_b16 v[118:119], v13 offset:14848
    s_waitcnt lgkmcnt(6)
    v_mfma_f32_32x32x16_bf16 v[32:47], v[132:135], v[212:215], v[32:47]
    ds_read_b64_tr_b16 v[120:121], v13 offset:16384
    ds_read_b64_tr_b16 v[122:123], v13 offset:16896
    v_mfma_f32_32x32x16_bf16 v[32:47], v[136:139], v[216:219], v[32:47]
    ds_read_b64_tr_b16 v[124:125], v13 offset:18432
    ds_read_b64_tr_b16 v[126:127], v13 offset:18944
    s_waitcnt lgkmcnt(6)
    v_mfma_f32_32x32x16_bf16 v[32:47], v[108:111], v[220:223], v[32:47]
    ds_read_b64_tr_b16 v[128:129], v13 offset:20480
    ds_read_b64_tr_b16 v[130:131], v13 offset:20992
    v_mfma_f32_32x32x16_bf16 v[32:47], v[112:115], v[224:227], v[32:47]
    ds_read_b64_tr_b16 v[132:133], v13 offset:22528
    ds_read_b64_tr_b16 v[134:135], v13 offset:23040
    s_waitcnt lgkmcnt(6)
    v_mfma_f32_32x32x16_bf16 v[32:47], v[116:119], v[228:231], v[32:47]
    ds_read_b64_tr_b16 v[136:137], v13 offset:24576
    ds_read_b64_tr_b16 v[138:139], v13 offset:25088
    v_mfma_f32_32x32x16_bf16 v[32:47], v[120:123], v[232:235], v[32:47]
    s_barrier
    s_waitcnt lgkmcnt(4)
    v_mfma_f32_32x32x16_bf16 v[32:47], v[124:127], v[236:239], v[32:47]
    v_mfma_f32_32x32x16_bf16 v[32:47], v[128:131], v[240:243], v[32:47]
    s_waitcnt lgkmcnt(0)
    v_mfma_f32_32x32x16_bf16 v[32:47], v[132:135], v[244:247], v[32:47]
    v_mfma_f32_32x32x16_bf16 v[32:47], v[136:139], v[248:251], v[32:47]
    ds_read_b128 v[92:95], v7 offset:1536
    ds_read_b128 v[96:99], v7 offset:1552
    ds_read_b128 v[100:103], v7 offset:1568
    ds_read_b128 v[104:107], v7 offset:1584
    s_mov_b32 s52, s22
    s_mov_b32 s53, s23
    s_mov_b32 s54, 256
    s_mov_b32 s55, 0x20000
    s_lshl_b32 s0, s27, 2
    v_mov_b32 v252, 0
    buffer_load_dword v253, v252, s[52:55], s0 offen sc1
    s_nop 0
    v_fma_f32 v60, -v32, v32, s61
    v_fma_f32 v61, -v33, v33, s61
    v_fma_f32 v62, -v34, v34, s61
    v_fma_f32 v63, -v35, v35, s61
    v_mul_f32 v60, v60, v32
    v_mul_f32 v61, v61, v33
    v_mul_f32 v62, v62, v34
    v_mul_f32 v63, v63, v35
    v_exp_f32 v60, v60
    v_exp_f32 v61, v61
    v_exp_f32 v62, v62
    v_exp_f32 v63, v63
    v_fma_f32 v60, v60, s62, s62
    v_fma_f32 v61, v61, s62, s62
    v_fma_f32 v62, v62, s62, s62
    v_fma_f32 v63, v63, s62, s62
    v_rcp_f32 v60, v60
    v_rcp_f32 v61, v61
    v_rcp_f32 v62, v62
    v_rcp_f32 v63, v63
    v_mul_f32 v60, v60, v32
    v_mul_f32 v61, v61, v33
    v_mul_f32 v62, v62, v34
    v_mul_f32 v63, v63, v35
    v_cvt_pk_bf16_f32 v76, v60, v61
    v_cvt_pk_bf16_f32 v77, v62, v63
    v_fma_f32 v64, -v36, v36, s61
    v_fma_f32 v65, -v37, v37, s61
    v_fma_f32 v66, -v38, v38, s61
    v_fma_f32 v67, -v39, v39, s61
    s_barrier
    v_mul_f32 v64, v64, v36
    v_mul_f32 v65, v65, v37
    v_mul_f32 v66, v66, v38
    v_mul_f32 v67, v67, v39
    v_exp_f32 v64, v64
    v_exp_f32 v65, v65
    v_exp_f32 v66, v66
    v_exp_f32 v67, v67
    v_fma_f32 v64, v64, s62, s62
    v_fma_f32 v65, v65, s62, s62
    v_fma_f32 v66, v66, s62, s62
    v_fma_f32 v67, v67, s62, s62
    v_rcp_f32 v64, v64
    v_rcp_f32 v65, v65
    v_rcp_f32 v66, v66
    v_rcp_f32 v67, v67
    v_mul_f32 v64, v64, v36
    v_mul_f32 v65, v65, v37
    v_mul_f32 v66, v66, v38
    v_mul_f32 v67, v67, v39
    v_cvt_pk_bf16_f32 v78, v64, v65
    v_cvt_pk_bf16_f32 v79, v66, v67
    v_fma_f32 v60, -v40, v40, s61
    v_fma_f32 v61, -v41, v41, s61
    v_fma_f32 v62, -v42, v42, s61
    v_fma_f32 v63, -v43, v43, s61
    v_mul_f32 v60, v60, v40
    v_mul_f32 v61, v61, v41
    v_mul_f32 v62, v62, v42
    v_mul_f32 v63, v63, v43
    v_exp_f32 v60, v60
    v_exp_f32 v61, v61
    v_exp_f32 v62, v62
    v_exp_f32 v63, v63
    v_fma_f32 v60, v60, s62, s62
    v_fma_f32 v61, v61, s62, s62
    v_fma_f32 v62, v62, s62, s62
    v_fma_f32 v63, v63, s62, s62
    v_rcp_f32 v60, v60
    v_rcp_f32 v61, v61
    v_rcp_f32 v62, v62
    v_rcp_f32 v63, v63
    v_mul_f32 v60, v60, v40
    v_mul_f32 v61, v61, v41
    v_mul_f32 v62, v62, v42
    v_mul_f32 v63, v63, v43
    v_cvt_pk_bf16_f32 v80, v60, v61
    v_cvt_pk_bf16_f32 v81, v62, v63
    v_fma_f32 v64, -v44, v44, s61
    s_barrier
    ds_read_b64_tr_b16 v[108:109], v13 offset:51200
    ds_read_b64_tr_b16 v[110:111], v13 offset:51712
    ds_read_b64_tr_b16 v[112:113], v13 offset:53248
    ds_read_b64_tr_b16 v[114:115], v13 offset:53760
    ds_read_b64_tr_b16 v[116:117], v13 offset:55296
    ds_read_b64_tr_b16 v[118:119], v13 offset:55808
    ds_read_b64_tr_b16 v[120:121], v13 offset:57344
    ds_read_b64_tr_b16 v[122:123], v13 offset:57856
    ds_read_b64_tr_b16 v[124:125], v14 offset:2048
    ds_read_b64_tr_b16 v[126:127], v14 offset:2560
    v_fma_f32 v65, -v45, v45, s61
    v_fma_f32 v66, -v46, v46, s61
    v_fma_f32 v67, -v47, v47, s61
    v_mul_f32 v64, v64, v44
    s_waitcnt lgkmcnt(6)
    v_mfma_f32_32x32x16_bf16 v[92:107], v[108:111], v[140:143], v[92:107]
    ds_read_b64_tr_b16 v[128:129], v14 offset:4096
    ds_read_b64_tr_b16 v[130:131], v14 offset:4608
    v_mul_f32 v65, v65, v45
    v_mul_f32 v66, v66, v46
    v_mul_f32 v67, v67, v47
    v_mfma_f32_32x32x16_bf16 v[92:107], v[112:115], v[144:147], v[92:107]
    ds_read_b64_tr_b16 v[132:133], v14 offset:6144
    ds_read_b64_tr_b16 v[134:135], v14 offset:6656
    v_exp_f32 v64, v64
    v_exp_f32 v65, v65
    v_exp_f32 v66, v66
    s_waitcnt lgkmcnt(6)
    v_mfma_f32_32x32x16_bf16 v[92:107], v[116:119], v[148:151], v[92:107]
    ds_read_b64_tr_b16 v[136:137], v14 offset:8192
    ds_read_b64_tr_b16 v[138:139], v14 offset:8704
    v_exp_f32 v67, v67
    v_fma_f32 v64, v64, s62, s62
    v_fma_f32 v65, v65, s62, s62
    v_mfma_f32_32x32x16_bf16 v[92:107], v[120:123], v[152:155], v[92:107]
    ds_read_b64_tr_b16 v[108:109], v14 offset:10240
    ds_read_b64_tr_b16 v[110:111], v14 offset:10752
    v_fma_f32 v66, v66, s62, s62
    v_fma_f32 v67, v67, s62, s62
    v_rcp_f32 v64, v64
    s_waitcnt lgkmcnt(6)
    v_mfma_f32_32x32x16_bf16 v[92:107], v[124:127], v[156:159], v[92:107]
    ds_read_b64_tr_b16 v[112:113], v14 offset:12288
    ds_read_b64_tr_b16 v[114:115], v14 offset:12800
    v_rcp_f32 v65, v65
    v_rcp_f32 v66, v66
    v_rcp_f32 v67, v67
    v_mfma_f32_32x32x16_bf16 v[92:107], v[128:131], v[160:163], v[92:107]
    ds_read_b64_tr_b16 v[116:117], v14 offset:14336
    ds_read_b64_tr_b16 v[118:119], v14 offset:14848
    v_mul_f32 v64, v64, v44
    v_mul_f32 v65, v65, v45
    v_mul_f32 v66, v66, v46
    s_waitcnt lgkmcnt(6)
    v_mfma_f32_32x32x16_bf16 v[92:107], v[132:135], v[164:167], v[92:107]
    ds_read_b64_tr_b16 v[120:121], v14 offset:16384
    ds_read_b64_tr_b16 v[122:123], v14 offset:16896
    v_mul_f32 v67, v67, v47
    v_cvt_pk_bf16_f32 v82, v64, v65
    v_cvt_pk_bf16_f32 v83, v66, v67
    v_mfma_f32_32x32x16_bf16 v[92:107], v[136:139], v[168:171], v[92:107]
    s_barrier
    ds_write_b128 v6, v[68:71] offset:0
    ds_write_b128 v6, v[72:75] offset:16
    ds_write_b128 v6, v[76:79] offset:9216
    ds_write_b128 v6, v[80:83] offset:9232
    ds_read_b64_tr_b16 v[124:125], v14 offset:18432
    ds_read_b64_tr_b16 v[126:127], v14 offset:18944
    s_waitcnt lgkmcnt(10)
    v_mfma_f32_32x32x16_bf16 v[92:107], v[108:111], v[172:175], v[92:107]
    ds_read_b64_tr_b16 v[128:129], v14 offset:20480
    ds_read_b64_tr_b16 v[130:131], v14 offset:20992
    v_mfma_f32_32x32x16_bf16 v[92:107], v[112:115], v[176:179], v[92:107]
    ds_read_b64_tr_b16 v[132:133], v14 offset:22528
    ds_read_b64_tr_b16 v[134:135], v14 offset:23040
    s_waitcnt lgkmcnt(10)
    v_mfma_f32_32x32x16_bf16 v[92:107], v[116:119], v[180:183], v[92:107]
    ds_read_b64_tr_b16 v[136:137], v14 offset:24576
    ds_read_b64_tr_b16 v[138:139], v14 offset:25088
    v_mfma_f32_32x32x16_bf16 v[92:107], v[120:123], v[184:187], v[92:107]
    ds_read_b64_tr_b16 v[108:109], v14 offset:26624
    ds_read_b64_tr_b16 v[110:111], v14 offset:27136
    s_waitcnt lgkmcnt(6)
    v_mfma_f32_32x32x16_bf16 v[92:107], v[124:127], v[188:191], v[92:107]
    ds_read_b64_tr_b16 v[112:113], v14 offset:28672
    ds_read_b64_tr_b16 v[114:115], v14 offset:29184
    v_mfma_f32_32x32x16_bf16 v[92:107], v[128:131], v[192:195], v[92:107]
    ds_read_b64_tr_b16 v[116:117], v14 offset:30720
    ds_read_b64_tr_b16 v[118:119], v14 offset:31232
    s_waitcnt lgkmcnt(6)
    v_mfma_f32_32x32x16_bf16 v[92:107], v[132:135], v[196:199], v[92:107]
    ds_read_b64_tr_b16 v[120:121], v14 offset:32768
    ds_read_b64_tr_b16 v[122:123], v14 offset:33280
    v_mfma_f32_32x32x16_bf16 v[92:107], v[136:139], v[200:203], v[92:107]
    ds_read_b64_tr_b16 v[124:125], v14 offset:34816
    ds_read_b64_tr_b16 v[126:127], v14 offset:35328
    s_waitcnt lgkmcnt(6)
    v_mfma_f32_32x32x16_bf16 v[92:107], v[108:111], v[204:207], v[92:107]
    ds_read_b64_tr_b16 v[128:129], v14 offset:36864
    ds_read_b64_tr_b16 v[130:131], v14 offset:37376
    v_mfma_f32_32x32x16_bf16 v[92:107], v[112:115], v[208:211], v[92:107]
    ds_read_b64_tr_b16 v[132:133], v14 offset:38912
    ds_read_b64_tr_b16 v[134:135], v14 offset:39424
    s_waitcnt lgkmcnt(6)
    v_mfma_f32_32x32x16_bf16 v[92:107], v[116:119], v[212:215], v[92:107]
    ds_read_b64_tr_b16 v[136:137], v14 offset:40960
    ds_read_b64_tr_b16 v[138:139], v14 offset:41472
    v_mfma_f32_32x32x16_bf16 v[92:107], v[120:123], v[216:219], v[92:107]
    ds_read_b64_tr_b16 v[108:109], v13 offset:2048
    ds_read_b64_tr_b16 v[110:111], v13 offset:2560
    s_waitcnt lgkmcnt(6)
    v_mfma_f32_32x32x16_bf16 v[92:107], v[124:127], v[220:223], v[92:107]
    ds_read_b64_tr_b16 v[112:113], v13 offset:4096
    ds_read_b64_tr_b16 v[114:115], v13 offset:4608
    v_mfma_f32_32x32x16_bf16 v[92:107], v[128:131], v[224:227], v[92:107]
    ds_read_b64_tr_b16 v[116:117], v13 offset:6144
    ds_read_b64_tr_b16 v[118:119], v13 offset:6656
    s_waitcnt lgkmcnt(6)
    v_mfma_f32_32x32x16_bf16 v[92:107], v[132:135], v[228:231], v[92:107]
    ds_read_b64_tr_b16 v[120:121], v13 offset:8192
    ds_read_b64_tr_b16 v[122:123], v13 offset:8704
    v_mfma_f32_32x32x16_bf16 v[92:107], v[136:139], v[232:235], v[92:107]
    s_barrier
    s_waitcnt lgkmcnt(4)
    v_mfma_f32_32x32x16_bf16 v[92:107], v[108:111], v[236:239], v[92:107]
    v_mfma_f32_32x32x16_bf16 v[92:107], v[112:115], v[240:243], v[92:107]
    s_waitcnt lgkmcnt(0)
    v_mfma_f32_32x32x16_bf16 v[92:107], v[116:119], v[244:247], v[92:107]
    v_mfma_f32_32x32x16_bf16 v[92:107], v[120:123], v[248:251], v[92:107]
    s_nop 11
    v_fma_f32 v60, -v92, v92, s61
    v_fma_f32 v61, -v93, v93, s61
    v_fma_f32 v62, -v94, v94, s61
    v_fma_f32 v63, -v95, v95, s61
    v_mul_f32 v60, v60, v92
    v_mul_f32 v61, v61, v93
    v_mul_f32 v62, v62, v94
    v_mul_f32 v63, v63, v95
    v_exp_f32 v60, v60
    v_exp_f32 v61, v61
    v_exp_f32 v62, v62
    v_exp_f32 v63, v63
    v_fma_f32 v60, v60, s62, s62
    v_fma_f32 v61, v61, s62, s62
    v_fma_f32 v62, v62, s62, s62
    v_fma_f32 v63, v63, s62, s62
    v_rcp_f32 v60, v60
    v_rcp_f32 v61, v61
    v_rcp_f32 v62, v62
    v_rcp_f32 v63, v63
    v_mul_f32 v60, v60, v92
    v_mul_f32 v61, v61, v93
    v_mul_f32 v62, v62, v94
    v_mul_f32 v63, v63, v95
    v_cvt_pk_bf16_f32 v68, v60, v61
    v_cvt_pk_bf16_f32 v69, v62, v63
    v_fma_f32 v64, -v96, v96, s61
    v_fma_f32 v65, -v97, v97, s61
    v_fma_f32 v66, -v98, v98, s61
    v_fma_f32 v67, -v99, v99, s61
    v_mul_f32 v64, v64, v96
    v_mul_f32 v65, v65, v97
    v_mul_f32 v66, v66, v98
    s_barrier
    v_mul_f32 v67, v67, v99
    v_exp_f32 v64, v64
    v_exp_f32 v65, v65
    v_exp_f32 v66, v66
    v_exp_f32 v67, v67
    v_fma_f32 v64, v64, s62, s62
    v_fma_f32 v65, v65, s62, s62
    v_fma_f32 v66, v66, s62, s62
    v_fma_f32 v67, v67, s62, s62
    v_rcp_f32 v64, v64
    v_rcp_f32 v65, v65
    v_rcp_f32 v66, v66
    v_rcp_f32 v67, v67
    v_mul_f32 v64, v64, v96
    v_mul_f32 v65, v65, v97
    v_mul_f32 v66, v66, v98
    v_mul_f32 v67, v67, v99
    v_cvt_pk_bf16_f32 v70, v64, v65
    v_cvt_pk_bf16_f32 v71, v66, v67
    v_fma_f32 v60, -v100, v100, s61
    v_fma_f32 v61, -v101, v101, s61
    v_fma_f32 v62, -v102, v102, s61
    v_fma_f32 v63, -v103, v103, s61
    v_mul_f32 v60, v60, v100
    v_mul_f32 v61, v61, v101
    v_mul_f32 v62, v62, v102
    v_mul_f32 v63, v63, v103
    v_exp_f32 v60, v60
    v_exp_f32 v61, v61
    v_exp_f32 v62, v62
    v_exp_f32 v63, v63
    v_fma_f32 v60, v60, s62, s62
    v_fma_f32 v61, v61, s62, s62
    v_fma_f32 v62, v62, s62, s62
    v_fma_f32 v63, v63, s62, s62
    v_rcp_f32 v60, v60
    v_rcp_f32 v61, v61
    v_rcp_f32 v62, v62
    v_rcp_f32 v63, v63
    v_mul_f32 v60, v60, v100
    v_mul_f32 v61, v61, v101
    v_mul_f32 v62, v62, v102
    v_mul_f32 v63, v63, v103
    v_cvt_pk_bf16_f32 v72, v60, v61
    v_cvt_pk_bf16_f32 v73, v62, v63
    v_fma_f32 v64, -v104, v104, s61
    v_fma_f32 v65, -v105, v105, s61
    v_fma_f32 v66, -v106, v106, s61
    v_fma_f32 v67, -v107, v107, s61
    v_mul_f32 v64, v64, v104
    s_barrier
    v_mul_f32 v65, v65, v105
    v_mul_f32 v66, v66, v106
    v_mul_f32 v67, v67, v107
    v_exp_f32 v64, v64
    v_exp_f32 v65, v65
    v_exp_f32 v66, v66
    v_exp_f32 v67, v67
    v_fma_f32 v64, v64, s62, s62
    v_fma_f32 v65, v65, s62, s62
    v_fma_f32 v66, v66, s62, s62
    v_fma_f32 v67, v67, s62, s62
    v_rcp_f32 v64, v64
    v_rcp_f32 v65, v65
    v_rcp_f32 v66, v66
    v_rcp_f32 v67, v67
    v_mul_f32 v64, v64, v104
    v_mul_f32 v65, v65, v105
    v_mul_f32 v66, v66, v106
    v_mul_f32 v67, v67, v107
    v_cvt_pk_bf16_f32 v74, v64, v65
    v_cvt_pk_bf16_f32 v75, v66, v67
    ds_write_b128 v6, v[68:71] offset:0
    ds_write_b128 v6, v[72:75] offset:16
    s_waitcnt lgkmcnt(0)
    s_barrier
    s_waitcnt vmcnt(0)
    v_readfirstlane_b32 s31, v253
    s_nop 0
    s_cmp_lg_u32 s31, 0
    s_cbranch_scc0 L_ack_f
L_ackd_f:
    s_and_b32 s31, s31, 2
    s_lshl_b32 s1, s31, 12
    s_add_u32 s96, s96, s1
    s_add_u32 s58, s58, s1
    s_cmp_gt_u32 s3, 0
    s_cbranch_scc1 L_fa_end
    v_mov_b32 v8, 0
    v_mov_b32 v21, 0
    v_min_u32 v16, 15, v0
    v_lshrrev_b32 v17, 2, v16
    v_and_b32 v16, 3, v16
    v_mul_u32_u24 v17, 128, v17
    v_mul_u32_u24 v16, 4, v16
    v_add_u32 v16, v16, v17
    v_mov_b32 v18, v16
    v_mov_b32 v17, 1
    s_barrier
    s_barrier
    s_barrier
    s_lshl_b32 s97, 1, s26
    s_or_b32 s98, s97, 0xf00
    s_lshl_b32 exec_lo, s97, 4
    s_mov_b32 exec_hi, 0
    s_barrier
    buffer_store_dword v17, v18, s[48:51], s96 offen sc1
    s_barrier
    s_lshl_b32 exec_lo, s97, 8
    s_mov_b32 exec_hi, 0
    buffer_store_dword v17, v18, s[48:51], s96 offen sc1
    s_mov_b32 exec_lo, s98
    s_mov_b32 exec_hi, 0
    s_mov_b32 s63, 4194304
L_watchfb:
    buffer_load_dword v254, v16, s[48:51], s96 offen sc1
    s_waitcnt vmcnt(0)
    v_cmp_eq_u32 vcc, 1, v254
    s_nop 0
    s_cmp_eq_u32 vcc_lo, s98
    s_cbranch_scc1 L_watchedfb
    s_sub_u32 s63, s63, 1
    s_cmp_lg_u32 s63, 0
    s_cbranch_scc1 L_watchfb
L_watchedfb:
    s_mov_b64 exec, -1
    s_barrier
L_fa_end:
    s_endpgm
.p2align 12
L_ffn_b:
    s_add_u32 s5, s4, 128
    s_cmp_eq_u32 s5, 896
    s_cselect_b32 s5, 0, s5
    s_add_u32 s6, s5, 128
    s_cmp_eq_u32 s6, 896
    s_cselect_b32 s6, 0, s6
    s_add_u32 s7, s6, 128
    s_cmp_eq_u32 s7, 896
    s_cselect_b32 s7, 0, s7
    s_add_u32 s8, s7, 128
    s_cmp_eq_u32 s8, 896
    s_cselect_b32 s8, 0, s8
    s_add_u32 s9, s8, 128
    s_cmp_eq_u32 s9, 896
    s_cselect_b32 s9, 0, s9
    s_add_u32 s14, s9, 128
    s_cmp_eq_u32 s14, 896
    s_cselect_b32 s14, 0, s14
    s_setprio 1
    v_mov_b32 v16, 0
    v_mov_b32 v17, 0
    s_waitcnt vmcnt(6)
    v_dot2c_f32_bf16 v16, s29, v32
    v_dot2c_f32_bf16 v17, v32, v32
    v_dot2c_f32_bf16 v16, s29, v33
    v_dot2c_f32_bf16 v17, v33, v33
    v_dot2c_f32_bf16 v16, s29, v34
    v_dot2c_f32_bf16 v17, v34, v34
    v_dot2c_f32_bf16 v16, s29, v35
    v_dot2c_f32_bf16 v17, v35, v35
    s_waitcnt vmcnt(5)
    v_dot2c_f32_bf16 v16, s29, v36
    v_dot2c_f32_bf16 v17, v36, v36
    v_dot2c_f32_bf16 v16, s29, v37
    v_dot2c_f32_bf16 v17, v37, v37
    v_dot2c_f32_bf16 v16, s29, v38
    v_dot2c_f32_bf16 v17, v38, v38
    v_dot2c_f32_bf16 v16, s29, v39
    v_dot2c_f32_bf16 v17, v39, v39
    s_waitcnt vmcnt(4)
    v_dot2c_f32_bf16 v16, s29, v40
    v_dot2c_f32_bf16 v17, v40, v40
    v_dot2c_f32_bf16 v16, s29, v41
    v_dot2c_f32_bf16 v17, v41, v41
    v_dot2c_f32_bf16 v16, s29, v42
    v_dot2c_f32_bf16 v17, v42, v42
    v_dot2c_f32_bf16 v16, s29, v43
    v_dot2c_f32_bf16 v17, v43, v43
    s_waitcnt vmcnt(3)
    v_dot2c_f32_bf16 v16, s29, v44
    v_dot2c_f32_bf16 v17, v44, v44
    v_dot2c_f32_bf16 v16, s29, v45
    v_dot2c_f32_bf16 v17, v45, v45
    v_dot2c_f32_bf16 v16, s29, v46
    v_dot2c_f32_bf16 v17, v46, v46
    v_dot2c_f32_bf16 v16, s29, v47
    v_dot2c_f32_bf16 v17, v47, v47
    s_waitcnt vmcnt(2)
    v_dot2c_f32_bf16 v16, s29, v48
    v_dot2c_f32_bf16 v17, v48, v48
    v_dot2c_f32_bf16 v16, s29, v49
    v_dot2c_f32_bf16 v17, v49, v49
    v_dot2c_f32_bf16 v16, s29, v50
    v_dot2c_f32_bf16 v17, v50, v50
    v_dot2c_f32_bf16 v16, s29, v51
    v_dot2c_f32_bf16 v17, v51, v51
    s_waitcnt vmcnt(1)
    v_dot2c_f32_bf16 v16, s29, v52
    v_dot2c_f32_bf16 v17, v52, v52
    v_dot2c_f32_bf16 v16, s29, v53
    v_dot2c_f32_bf16 v17, v53, v53
    v_dot2c_f32_bf16 v16, s29, v54
    v_dot2c_f32_bf16 v17, v54, v54
    v_dot2c_f32_bf16 v16, s29, v55
    v_dot2c_f32_bf16 v17, v55, v55
    s_waitcnt vmcnt(0)
    v_dot2c_f32_bf16 v16, s29, v56
    v_dot2c_f32_bf16 v17, v56, v56
    v_dot2c_f32_bf16 v16, s29, v57
    v_dot2c_f32_bf16 v17, v57, v57
    v_dot2c_f32_bf16 v16, s29, v58
    v_dot2c_f32_bf16 v17, v58, v58
    v_dot2c_f32_bf16 v16, s29, v59
    v_dot2c_f32_bf16 v17, v59, v59
    s_nop 1
    v_add_f32_dpp v16, v16, v16 quad_perm:[1,0,3,2] row_mask:0xf bank_mask:0xf
    v_add_f32_dpp v17, v17, v17 quad_perm:[1,0,3,2] row_mask:0xf bank_mask:0xf
    s_nop 0
    v_add_f32_dpp v16, v16, v16 quad_perm:[2,3,0,1] row_mask:0xf bank_mask:0xf
    v_add_f32_dpp v17, v17, v17 quad_perm:[2,3,0,1] row_mask:0xf bank_mask:0xf
    s_nop 0
    v_add_f32_dpp v16, v16, v16 row_half_mirror row_mask:0xf bank_mask:0xf
    v_add_f32_dpp v17, v17, v17 row_half_mirror row_mask:0xf bank_mask:0xf
    v_mul_f32 v16, 0x3b124925, v16
    v_mul_f32 v17, 0x3b124925, v17
    v_fma_f32 v17, -v16, v16, v17
    v_max_f32 v17, 0, v17
    v_add_f32 v17, 0x3727c5ac, v17
    v_rsq_f32 v18, v17
    s_nop 0
    v_mul_f32 v18, 0x3eeff558, v18
    v_mul_f32 v20, v16, v18
    v_sub_f32 v20, 0, v20
    v_lshlrev_b32 v22, 16, v32
    v_and_b32 v23, s30, v32
    v_lshlrev_b32 v24, 16, v33
    v_and_b32 v25, s30, v33
    v_lshlrev_b32 v26, 16, v34
    v_and_b32 v27, s30, v34
    v_lshlrev_b32 v28, 16, v35
    v_and_b32 v29, s30, v35
    v_pk_fma_f32 v[22:23], v[22:23], v[18:19], v[20:21] op_sel_hi:[1,0,0]
    v_pk_fma_f32 v[24:25], v[24:25], v[18:19], v[20:21] op_sel_hi:[1,0,0]
    v_pk_fma_f32 v[26:27], v[26:27], v[18:19], v[20:21] op_sel_hi:[1,0,0]
    v_pk_fma_f32 v[28:29], v[28:29], v[18:19], v[20:21] op_sel_hi:[1,0,0]
    v_cvt_pk_bf16_f32 v32, v22, v23
    v_cvt_pk_bf16_f32 v33, v24, v25
    v_cvt_pk_bf16_f32 v34, v26, v27
    v_cvt_pk_bf16_f32 v35, v28, v29
    ds_write_b128 v100, v[32:35] offset:0
    v_lshlrev_b32 v22, 16, v36
    v_and_b32 v23, s30, v36
    v_lshlrev_b32 v24, 16, v37
    v_and_b32 v25, s30, v37
    v_lshlrev_b32 v26, 16, v38
    v_and_b32 v27, s30, v38
    v_lshlrev_b32 v28, 16, v39
    v_and_b32 v29, s30, v39
    v_pk_fma_f32 v[22:23], v[22:23], v[18:19], v[20:21] op_sel_hi:[1,0,0]
    v_pk_fma_f32 v[24:25], v[24:25], v[18:19], v[20:21] op_sel_hi:[1,0,0]
    v_pk_fma_f32 v[26:27], v[26:27], v[18:19], v[20:21] op_sel_hi:[1,0,0]
    v_pk_fma_f32 v[28:29], v[28:29], v[18:19], v[20:21] op_sel_hi:[1,0,0]
    v_cvt_pk_bf16_f32 v36, v22, v23
    v_cvt_pk_bf16_f32 v37, v24, v25
    v_cvt_pk_bf16_f32 v38, v26, v27
    v_cvt_pk_bf16_f32 v39, v28, v29
    ds_write_b128 v101, v[36:39] offset:0
    v_lshlrev_b32 v22, 16, v40
    v_and_b32 v23, s30, v40
    v_lshlrev_b32 v24, 16, v41
    v_and_b32 v25, s30, v41
    v_lshlrev_b32 v26, 16, v42
    v_and_b32 v27, s30, v42
    v_lshlrev_b32 v28, 16, v43
    v_and_b32 v29, s30, v43
    v_pk_fma_f32 v[22:23], v[22:23], v[18:19], v[20:21] op_sel_hi:[1,0,0]
    v_pk_fma_f32 v[24:25], v[24:25], v[18:19], v[20:21] op_sel_hi:[1,0,0]
    v_pk_fma_f32 v[26:27], v[26:27], v[18:19], v[20:21] op_sel_hi:[1,0,0]
    v_pk_fma_f32 v[28:29], v[28:29], v[18:19], v[20:21] op_sel_hi:[1,0,0]
    v_cvt_pk_bf16_f32 v40, v22, v23
    v_cvt_pk_bf16_f32 v41, v24, v25
    v_cvt_pk_bf16_f32 v42, v26, v27
    v_cvt_pk_bf16_f32 v43, v28, v29
    ds_write_b128 v102, v[40:43] offset:0
    v_lshlrev_b32 v22, 16, v44
    v_and_b32 v23, s30, v44
    v_lshlrev_b32 v24, 16, v45
    v_and_b32 v25, s30, v45
    v_lshlrev_b32 v26, 16, v46
    v_and_b32 v27, s30, v46
    v_lshlrev_b32 v28, 16, v47
    v_and_b32 v29, s30, v47
    v_pk_fma_f32 v[22:23], v[22:23], v[18:19], v[20:21] op_sel_hi:[1,0,0]
    v_pk_fma_f32 v[24:25], v[24:25], v[18:19], v[20:21] op_sel_hi:[1,0,0]
    v_pk_fma_f32 v[26:27], v[26:27], v[18:19], v[20:21] op_sel_hi:[1,0,0]
    v_pk_fma_f32 v[28:29], v[28:29], v[18:19], v[20:21] op_sel_hi:[1,0,0]
    v_cvt_pk_bf16_f32 v44, v22, v23
    v_cvt_pk_bf16_f32 v45, v24, v25
    v_cvt_pk_bf16_f32 v46, v26, v27
    v_cvt_pk_bf16_f32 v47, v28, v29
    ds_write_b128 v103, v[44:47] offset:0
    v_lshlrev_b32 v22, 16, v48
    v_and_b32 v23, s30, v48
    v_lshlrev_b32 v24, 16, v49
    v_and_b32 v25, s30, v49
    v_lshlrev_b32 v26, 16, v50
    v_and_b32 v27, s30, v50
    v_lshlrev_b32 v28, 16, v51
    v_and_b32 v29, s30, v51
    v_pk_fma_f32 v[22:23], v[22:23], v[18:19], v[20:21] op_sel_hi:[1,0,0]
    v_pk_fma_f32 v[24:25], v[24:25], v[18:19], v[20:21] op_sel_hi:[1,0,0]
    v_pk_fma_f32 v[26:27], v[26:27], v[18:19], v[20:21] op_sel_hi:[1,0,0]
    v_pk_fma_f32 v[28:29], v[28:29], v[18:19], v[20:21] op_sel_hi:[1,0,0]
    v_cvt_pk_bf16_f32 v48, v22, v23
    v_cvt_pk_bf16_f32 v49, v24, v25
    v_cvt_pk_bf16_f32 v50, v26, v27
    v_cvt_pk_bf16_f32 v51, v28, v29
    ds_write_b128 v104, v[48:51] offset:0
    v_lshlrev_b32 v22, 16, v52
    v_and_b32 v23, s30, v52
    v_lshlrev_b32 v24, 16, v53
    v_and_b32 v25, s30, v53
    v_lshlrev_b32 v26, 16, v54
    v_and_b32 v27, s30, v54
    v_lshlrev_b32 v28, 16, v55
    v_and_b32 v29, s30, v55
    v_pk_fma_f32 v[22:23], v[22:23], v[18:19], v[20:21] op_sel_hi:[1,0,0]
    v_pk_fma_f32 v[24:25], v[24:25], v[18:19], v[20:21] op_sel_hi:[1,0,0]
    v_pk_fma_f32 v[26:27], v[26:27], v[18:19], v[20:21] op_sel_hi:[1,0,0]
    v_pk_fma_f32 v[28:29], v[28:29], v[18:19], v[20:21] op_sel_hi:[1,0,0]
    v_cvt_pk_bf16_f32 v52, v22, v23
    v_cvt_pk_bf16_f32 v53, v24, v25
    v_cvt_pk_bf16_f32 v54, v26, v27
    v_cvt_pk_bf16_f32 v55, v28, v29
    ds_write_b128 v105, v[52:55] offset:0
    v_lshlrev_b32 v22, 16, v56
    v_and_b32 v23, s30, v56
    v_lshlrev_b32 v24, 16, v57
    v_and_b32 v25, s30, v57
    v_lshlrev_b32 v26, 16, v58
    v_and_b32 v27, s30, v58
    v_lshlrev_b32 v28, 16, v59
    v_and_b32 v29, s30, v59
    v_pk_fma_f32 v[22:23], v[22:23], v[18:19], v[20:21] op_sel_hi:[1,0,0]
    v_pk_fma_f32 v[24:25], v[24:25], v[18:19], v[20:21] op_sel_hi:[1,0,0]
    v_pk_fma_f32 v[26:27], v[26:27], v[18:19], v[20:21] op_sel_hi:[1,0,0]
    v_pk_fma_f32 v[28:29], v[28:29], v[18:19], v[20:21] op_sel_hi:[1,0,0]
    v_cvt_pk_bf16_f32 v56, v22, v23
    v_cvt_pk_bf16_f32 v57, v24, v25
    v_cvt_pk_bf16_f32 v58, v26, v27
    v_cvt_pk_bf16_f32 v59, v28, v29
    ds_write_b128 v106, v[56:59] offset:0
    s_waitcnt lgkmcnt(0)
    s_barrier
    s_add_u32 m0, s35, 100352
    s_add_u32 s59, s61, s4
    buffer_load_dwordx4 v9, s[40:43], s59 offen lds
    buffer_load_dwordx4 v10, s[40:43], s59 offen offset:1024 lds
    s_add_u32 m0, s35, 108544
    s_add_u32 s59, s62, s4
    buffer_load_dwordx4 v9, s[40:43], s59 offen lds
    buffer_load_dwordx4 v10, s[40:43], s59 offen offset:1024 lds
    s_lshl_b32 s31, s32, 4
    v_add_u32 v26, s31, v30
    v_mul_u32_u24 v16, 896, v26
    v_add_u32 v16, v16, v31
    v_add_u32 v17, 6144, v16
    s_lshl_b32 s31, s34, 4
    v_add_u32 v26, s31, v30
    v_mul_u32_u24 v18, 896, v26
    v_add_u32 v18, v18, v31
    v_add_u32 v19, 6144, v18
    s_lshl_b32 s31, s26, 2
    s_lshr_b32 s17, 25428, s31
    s_and_b32 s17, s17, 7
    s_add_u32 s10, s33, 0
    s_cmp_ge_u32 s10, s17
    s_addc_u32 s10, s10, 0
    s_lshl_b32 s10, s10, 7
    s_add_u32 s11, s10, 28672
    s_add_u32 s12, s33, 2
    s_cmp_ge_u32 s12, s17
    s_addc_u32 s12, s12, 0
    s_lshl_b32 s12, s12, 7
    s_add_u32 s13, s12, 28672
    s_add_u32 s15, s33, 4
    s_cmp_ge_u32 s15, s17
    s_addc_u32 s15, s15, 0
    s_lshl_b32 s15, s15, 7
    s_add_u32 s16, s15, 28672
    s_lshl_b32 s17, s17, 7
    s_mov_b32 s36, s20
    s_mov_b32 s37, s21
    s_mov_b32 s38, 1835008
    s_mov_b32 s39, 0x20000
    s_lshl_b32 s31, s33, 11
    v_add_u32 v23, s31, v12
    v_add_u32 v24, s31, v13
    v_add_u32 v25, s31, v14
    s_mul_i32 s31, s33, -9216
    s_add_u32 s31, s31, 4608
    v_add_u32 v20, s31, v11
    s_lshl_b32 s31, s33, 12
    s_lshl_b32 s60, s34, 11
    s_add_u32 s31, s31, s60
    v_lshlrev_b32 v8, 4, v0
    v_add_u32 v8, s31, v8
    v_xor_b32 v22, 0x1000, v8
    v_lshlrev_b32 v21, 4, v0
    v_and_b32 v27, 31, v0
    v_lshrrev_b32 v28, 5, v0
    v_mul_u32_u24 v27, 896, v27
    v_lshl_add_u32 v27, v28, 5, v27
    s_barrier
    s_add_u32 m0, s35, 116736
    s_add_u32 s59, s97, s5
    buffer_load_dwordx4 v9, s[40:43], s59 offen lds
    buffer_load_dwordx4 v10, s[40:43], s59 offen offset:1024 lds
    s_add_u32 m0, s35, 124928
    s_add_u32 s59, s98, s5
    buffer_load_dwordx4 v9, s[40:43], s59 offen lds
    buffer_load_dwordx4 v10, s[40:43], s59 offen offset:1024 lds
    s_add_u32 m0, s35, 133120
    s_add_u32 s59, s99, s5
    buffer_load_dwordx4 v9, s[40:43], s59 offen lds
    buffer_load_dwordx4 v10, s[40:43], s59 offen offset:1024 lds
    s_waitcnt vmcnt(6)
    s_barrier
    s_add_u32 m0, s35, 141312
    s_add_u32 s59, s100, s5
    buffer_load_dwordx4 v9, s[40:43], s59 offen lds
    buffer_load_dwordx4 v10, s[40:43], s59 offen offset:1024 lds
    s_add_u32 m0, s35, 149504
    s_add_u32 s59, s101, s5
    buffer_load_dwordx4 v9, s[40:43], s59 offen lds
    buffer_load_dwordx4 v10, s[40:43], s59 offen offset:1024 lds
    s_add_u32 m0, s35, 59392
    s_add_u32 s59, s61, s5
    buffer_load_dwordx4 v9, s[40:43], s59 offen lds
    buffer_load_dwordx4 v10, s[40:43], s59 offen offset:1024 lds
    s_add_u32 m0, s35, 67584
    s_add_u32 s59, s62, s5
    buffer_load_dwordx4 v9, s[40:43], s59 offen lds
    buffer_load_dwordx4 v10, s[40:43], s59 offen offset:1024 lds
    s_add_u32 m0, s35, 75776
    s_add_u32 s59, s97, s6
    buffer_load_dwordx4 v9, s[40:43], s59 offen lds
    s_waitcnt vmcnt(9)
    s_barrier
    buffer_load_dwordx4 v10, s[40:43], s59 offen offset:1024 lds
    s_add_u32 m0, s35, 83968
    s_add_u32 s59, s98, s6
    buffer_load_dwordx4 v9, s[40:43], s59 offen lds
    buffer_load_dwordx4 v10, s[40:43], s59 offen offset:1024 lds
    s_add_u32 m0, s35, 92160
    s_add_u32 s59, s99, s6
    buffer_load_dwordx4 v9, s[40:43], s59 offen lds
    buffer_load_dwordx4 v10, s[40:43], s59 offen offset:1024 lds
    s_add_u32 m0, s35, 100352
    s_add_u32 s59, s100, s6
    buffer_load_dwordx4 v9, s[40:43], s59 offen lds
    buffer_load_dwordx4 v10, s[40:43], s59 offen offset:1024 lds
    s_waitcnt vmcnt(8)
    s_barrier
    s_add_u32 m0, s35, 18432
    s_add_u32 s59, s101, s6
    buffer_load_dwordx4 v9, s[40:43], s59 offen lds
    buffer_load_dwordx4 v10, s[40:43], s59 offen offset:1024 lds
    s_add_u32 m0, s35, 26624
    s_add_u32 s59, s61, s6
    buffer_load_dwordx4 v9, s[40:43], s59 offen lds
    buffer_load_dwordx4 v10, s[40:43], s59 offen offset:1024 lds
    s_add_u32 m0, s35, 34816
    s_add_u32 s59, s62, s6
    buffer_load_dwordx4 v9, s[40:43], s59 offen lds
    buffer_load_dwordx4 v10, s[40:43], s59 offen offset:1024 lds
    s_add_u32 m0, s35, 43008
    s_mul_i32 s18, s4, 448
    s_add_u32 s18, s18, s57
    s_add_u32 s59, s18, s10
    buffer_load_dwordx4 v18, s[44:47], s59 offen lds
    buffer_load_dwordx4 v19, s[44:47], s59 offen offset:1024 lds
    s_add_u32 m0, s35, 108544
    s_add_u32 s59, s18, s11
    buffer_load_dwordx4 v18, s[44:47], s59 offen lds
    buffer_load_dwordx4 v19, s[44:47], s59 offen offset:1024 lds
    s_add_u32 m0, s35, 116736
    s_add_u32 s59, s18, s12
    buffer_load_dwordx4 v18, s[44:47], s59 offen lds
    buffer_load_dwordx4 v19, s[44:47], s59 offen offset:1024 lds
    s_add_u32 m0, s35, 124928
    s_add_u32 s59, s18, s13
    buffer_load_dwordx4 v18, s[44:47], s59 offen lds
    buffer_load_dwordx4 v19, s[44:47], s59 offen offset:1024 lds
    s_waitcnt vmcnt(14)
    s_barrier
    s_add_u32 m0, s35, 133120
    s_add_u32 s59, s18, s15
    buffer_load_dwordx4 v18, s[44:47], s59 offen lds
    buffer_load_dwordx4 v19, s[44:47], s59 offen offset:1024 lds
    s_add_u32 m0, s35, 141312
    s_add_u32 s59, s18, s16
    buffer_load_dwordx4 v18, s[44:47], s59 offen lds
    buffer_load_dwordx4 v19, s[44:47], s59 offen offset:1024 lds
    s_add_u32 m0, s35, 149504
    s_add_u32 s59, s18, s17
    buffer_load_dwordx4 v16, s[44:47], s59 offen lds
    buffer_load_dwordx4 v17, s[44:47], s59 offen offset:1024 lds
    s_add_u32 m0, s35, 59392
    s_add_u32 s59, s97, s7
    buffer_load_dwordx4 v9, s[40:43], s59 offen lds
    buffer_load_dwordx4 v10, s[40:43], s59 offen offset:1024 lds
    s_waitcnt vmcnt(16)
    s_barrier
    s_add_u32 m0, s35, 67584
    s_add_u32 s59, s98, s7
    buffer_load_dwordx4 v9, s[40:43], s59 offen lds
    s_waitcnt vmcnt(1)
    s_barrier
    ds_read_b32 v26, v11
    s_waitcnt lgkmcnt(0)
    buffer_load_dwordx4 v10, s[40:43], s59 offen offset:1024 lds
    s_add_u32 m0, s35, 75776
    s_add_u32 s59, s99, s7
    buffer_load_dwordx4 v9, s[40:43], s59 offen lds
    buffer_load_dwordx4 v10, s[40:43], s59 offen offset:1024 lds
    s_add_u32 m0, s35, 83968
    s_add_u32 s59, s100, s7
    buffer_load_dwordx4 v9, s[40:43], s59 offen lds
    s_barrier
    ds_read_b128 v[32:35], v11 offset:0
    ds_read_b128 v[48:51], v20 offset:0
    ds_read_b64_tr_b16 v[108:109], v23 offset:43008
    ds_read_b64_tr_b16 v[110:111], v23 offset:43520
    ds_read_b128 v[36:39], v11 offset:32
    ds_read_b128 v[52:55], v20 offset:32
    ds_read_b64_tr_b16 v[112:113], v23 offset:47104
    ds_read_b64_tr_b16 v[114:115], v23 offset:47616
    ds_read_b128 v[40:43], v11 offset:64
    ds_read_b128 v[56:59], v20 offset:64
    ds_read_b64_tr_b16 v[116:117], v24 offset:51200
    ds_read_b64_tr_b16 v[118:119], v24 offset:51712
    buffer_load_dwordx4 v10, s[40:43], s59 offen offset:1024 lds
    s_waitcnt lgkmcnt(8)
    v_mfma_f32_32x32x16_bf16 v[140:155], v[108:111], v[32:35], 0
    ds_read_b128 v[44:47], v11 offset:96
    ds_read_b128 v[60:63], v20 offset:96
    ds_read_b64_tr_b16 v[120:121], v24 offset:55296
    ds_read_b64_tr_b16 v[122:123], v24 offset:55808
    s_add_u32 m0, s35, 92160
    s_add_u32 s59, s101, s7
    buffer_load_dwordx4 v9, s[40:43], s59 offen lds
    v_mfma_f32_32x32x16_bf16 v[156:171], v[108:111], v[48:51], 0
    buffer_load_dwordx4 v10, s[40:43], s59 offen offset:1024 lds
    s_add_u32 m0, s35, 100352
    s_add_u32 s59, s61, s7
    s_waitcnt lgkmcnt(8)
    v_mfma_f32_32x32x16_bf16 v[140:155], v[112:115], v[36:39], v[140:155]
    ds_read_b64_tr_b16 v[124:125], v25 offset:2048
    ds_read_b64_tr_b16 v[126:127], v25 offset:2560
    buffer_load_dwordx4 v9, s[40:43], s59 offen lds
    v_mfma_f32_32x32x16_bf16 v[156:171], v[112:115], v[52:55], v[156:171]
    s_waitcnt lgkmcnt(6)
    v_mfma_f32_32x32x16_bf16 v[140:155], v[116:119], v[40:43], v[140:155]
    ds_read_b64_tr_b16 v[128:129], v25 offset:6144
    ds_read_b64_tr_b16 v[130:131], v25 offset:6656
    buffer_load_dwordx4 v10, s[40:43], s59 offen offset:1024 lds
    v_mfma_f32_32x32x16_bf16 v[156:171], v[116:119], v[56:59], v[156:171]
    s_add_u32 m0, s35, 18432
    s_add_u32 s59, s62, s7
    s_waitcnt lgkmcnt(4)
    v_mfma_f32_32x32x16_bf16 v[140:155], v[120:123], v[44:47], v[140:155]
    ds_read_b64_tr_b16 v[132:133], v25 offset:10240
    ds_read_b64_tr_b16 v[134:135], v25 offset:10752
    buffer_load_dwordx4 v9, s[40:43], s59 offen lds
    v_mfma_f32_32x32x16_bf16 v[156:171], v[120:123], v[60:63], v[156:171]
    buffer_load_dwordx4 v10, s[40:43], s59 offen offset:1024 lds
    s_waitcnt lgkmcnt(4)
    v_mfma_f32_32x32x16_bf16 v[172:187], v[124:127], v[32:35], 0
    ds_read_b64_tr_b16 v[136:137], v25 offset:14336
    ds_read_b64_tr_b16 v[138:139], v25 offset:14848
    s_add_u32 m0, s35, 26624
    s_mul_i32 s19, s5, 448
    s_add_u32 s19, s19, s57
    s_add_u32 s59, s19, s10
    v_mfma_f32_32x32x16_bf16 v[188:203], v[124:127], v[48:51], 0
    buffer_load_dwordx4 v18, s[44:47], s59 offen lds
    s_waitcnt lgkmcnt(4)
    v_mfma_f32_32x32x16_bf16 v[172:187], v[128:131], v[36:39], v[172:187]
    s_barrier
    ds_read_b64_tr_b16 v[108:109], v25 offset:18432
    ds_read_b64_tr_b16 v[110:111], v25 offset:18944
    v_mfma_f32_32x32x16_bf16 v[188:203], v[128:131], v[52:55], v[188:203]
    buffer_load_dwordx4 v19, s[44:47], s59 offen offset:1024 lds
    s_waitcnt lgkmcnt(4)
    v_mfma_f32_32x32x16_bf16 v[172:187], v[132:135], v[40:43], v[172:187]
    ds_read_b64_tr_b16 v[112:113], v25 offset:22528
    ds_read_b64_tr_b16 v[114:115], v25 offset:23040
    s_add_u32 m0, s35, 34816
    s_add_u32 s59, s19, s11
    v_mfma_f32_32x32x16_bf16 v[188:203], v[132:135], v[56:59], v[188:203]
    buffer_load_dwordx4 v18, s[44:47], s59 offen lds
    s_waitcnt lgkmcnt(4)
    v_mfma_f32_32x32x16_bf16 v[172:187], v[136:139], v[44:47], v[172:187]
    ds_read_b64_tr_b16 v[116:117], v25 offset:26624
    ds_read_b64_tr_b16 v[118:119], v25 offset:27136
    v_mfma_f32_32x32x16_bf16 v[188:203], v[136:139], v[60:63], v[188:203]
    buffer_load_dwordx4 v19, s[44:47], s59 offen offset:1024 lds
    s_add_u32 m0, s35, 43008
    s_add_u32 s59, s19, s12
    s_waitcnt lgkmcnt(4)
    v_mfma_f32_32x32x16_bf16 v[204:219], v[108:111], v[32:35], 0
    ds_read_b64_tr_b16 v[120:121], v25 offset:30720
    ds_read_b64_tr_b16 v[122:123], v25 offset:31232
    buffer_load_dwordx4 v18, s[44:47], s59 offen lds
    v_mfma_f32_32x32x16_bf16 v[220:235], v[108:111], v[48:51], 0
    s_waitcnt lgkmcnt(4)
    v_mfma_f32_32x32x16_bf16 v[204:219], v[112:115], v[36:39], v[204:219]
    ds_read_b64_tr_b16 v[124:125], v14 offset:34816
    ds_read_b64_tr_b16 v[126:127], v14 offset:35328
    buffer_load_dwordx4 v19, s[44:47], s59 offen offset:1024 lds
    v_mfma_f32_32x32x16_bf16 v[220:235], v[112:115], v[52:55], v[220:235]
    ds_read_b64_tr_b16 v[128:129], v14 offset:36864
    ds_read_b64_tr_b16 v[130:131], v14 offset:37376
    s_add_u32 m0, s35, 108544
    s_add_u32 s59, s19, s13
    s_waitcnt lgkmcnt(6)
    v_mfma_f32_32x32x16_bf16 v[204:219], v[116:119], v[40:43], v[204:219]
    ds_read_b64_tr_b16 v[132:133], v14 offset:38912
    ds_read_b64_tr_b16 v[134:135], v14 offset:39424
    buffer_load_dwordx4 v18, s[44:47], s59 offen lds
    v_mfma_f32_32x32x16_bf16 v[220:235], v[116:119], v[56:59], v[220:235]
    ds_read_b64_tr_b16 v[136:137], v14 offset:40960
    ds_read_b64_tr_b16 v[138:139], v14 offset:41472
    s_waitcnt lgkmcnt(8)
    v_mfma_f32_32x32x16_bf16 v[204:219], v[120:123], v[44:47], v[204:219]
    buffer_load_dwordx4 v19, s[44:47], s59 offen offset:1024 lds
    v_mfma_f32_32x32x16_bf16 v[220:235], v[120:123], v[60:63], v[220:235]
    s_waitcnt vmcnt(14)
    s_barrier
    s_add_u32 m0, s35, 116736
    s_add_u32 s59, s19, s15
    s_waitcnt lgkmcnt(4)
    v_mfma_f32_32x32x16_bf16 v[236:251], v[124:127], v[32:35], 0
    buffer_load_dwordx4 v18, s[44:47], s59 offen lds
    v_mfma_f32_32x32x16_bf16 v[236:251], v[128:131], v[36:39], v[236:251]
    buffer_load_dwordx4 v19, s[44:47], s59 offen offset:1024 lds
    s_waitcnt lgkmcnt(0)
    v_mfma_f32_32x32x16_bf16 v[236:251], v[132:135], v[40:43], v[236:251]
    s_add_u32 m0, s35, 124928
    s_add_u32 s59, s19, s16
    v_mfma_f32_32x32x16_bf16 v[236:251], v[136:139], v[44:47], v[236:251]
    buffer_load_dwordx4 v18, s[44:47], s59 offen lds
    buffer_load_dwordx4 v19, s[44:47], s59 offen offset:1024 lds
    s_add_u32 m0, s35, 133120
    s_add_u32 s59, s19, s17
    buffer_load_dwordx4 v16, s[44:47], s59 offen lds
    buffer_load_dwordx4 v17, s[44:47], s59 offen offset:1024 lds
    s_add_u32 m0, s35, 141312
    s_add_u32 s59, s97, s8
    buffer_load_dwordx4 v9, s[40:43], s59 offen lds
    buffer_load_dwordx4 v10, s[40:43], s59 offen offset:1024 lds
    s_waitcnt vmcnt(16)
    s_barrier
    s_add_u32 m0, s35, 149504
    s_add_u32 s59, s98, s8
    buffer_load_dwordx4 v9, s[40:43], s59 offen lds
    buffer_load_dwordx4 v10, s[40:43], s59 offen offset:1024 lds
    s_add_u32 m0, s35, 59392
    s_add_u32 s59, s99, s8
    buffer_load_dwordx4 v9, s[40:43], s59 offen lds
    buffer_load_dwordx4 v10, s[40:43], s59 offen offset:1024 lds
    s_add_u32 m0, s35, 67584
    s_add_u32 s59, s100, s8
    buffer_load_dwordx4 v9, s[40:43], s59 offen lds
    buffer_load_dwordx4 v10, s[40:43], s59 offen offset:1024 lds
    s_add_u32 m0, s35, 75776
    s_add_u32 s59, s101, s8
    buffer_load_dwordx4 v9, s[40:43], s59 offen lds
    buffer_load_dwordx4 v10, s[40:43], s59 offen offset:1024 lds
    ds_read_b128 v[64:67], v11 offset:9216
    ds_read_b128 v[80:83], v20 offset:9216
    ds_read_b128 v[68:71], v11 offset:9248
    ds_read_b128 v[84:87], v20 offset:9248
    ds_read_b128 v[72:75], v11 offset:9280
    ds_read_b128 v[88:91], v20 offset:9280
    ds_read_b128 v[76:79], v11 offset:9312
    ds_read_b128 v[92:95], v20 offset:9312
    s_branch L_page5
.p2align 12
L_stub_B0:
    s_branch L_warm
    s_nop 0
L_page5:
    s_waitcnt vmcnt(18)
    s_barrier
    ds_read_b64_tr_b16 v[108:109], v23 offset:26624
    ds_read_b64_tr_b16 v[110:111], v23 offset:27136
    ds_read_b64_tr_b16 v[112:113], v23 offset:30720
    ds_read_b64_tr_b16 v[114:115], v23 offset:31232
    ds_read_b64_tr_b16 v[116:117], v23 offset:34816
    ds_read_b64_tr_b16 v[118:119], v23 offset:35328
    s_add_u32 m0, s35, 83968
    s_add_u32 s59, s61, s8
    buffer_load_dwordx4 v9, s[40:43], s59 offen lds
    s_waitcnt lgkmcnt(4)
    v_mfma_f32_32x32x16_bf16 v[140:155], v[108:111], v[64:67], v[140:155]
    ds_read_b64_tr_b16 v[120:121], v23 offset:38912
    ds_read_b64_tr_b16 v[122:123], v23 offset:39424
    buffer_load_dwordx4 v10, s[40:43], s59 offen offset:1024 lds
    s_add_u32 m0, s35, 92160
    s_add_u32 s59, s62, s8
    v_mfma_f32_32x32x16_bf16 v[156:171], v[108:111], v[80:83], v[156:171]
    buffer_load_dwordx4 v9, s[40:43], s59 offen lds
    s_waitcnt lgkmcnt(4)
    v_mfma_f32_32x32x16_bf16 v[140:155], v[112:115], v[68:71], v[140:155]
    ds_read_b64_tr_b16 v[124:125], v23 offset:43008
    ds_read_b64_tr_b16 v[126:127], v23 offset:43520
    buffer_load_dwordx4 v10, s[40:43], s59 offen offset:1024 lds
    v_mfma_f32_32x32x16_bf16 v[156:171], v[112:115], v[84:87], v[156:171]
    s_add_u32 m0, s35, 100352
    s_mul_i32 s18, s6, 448
    s_add_u32 s18, s18, s57
    s_add_u32 s59, s18, s10
    s_waitcnt lgkmcnt(4)
    v_mfma_f32_32x32x16_bf16 v[140:155], v[116:119], v[72:75], v[140:155]
    ds_read_b64_tr_b16 v[128:129], v23 offset:47104
    ds_read_b64_tr_b16 v[130:131], v23 offset:47616
    buffer_load_dwordx4 v18, s[44:47], s59 offen lds
    v_mfma_f32_32x32x16_bf16 v[156:171], v[116:119], v[88:91], v[156:171]
    s_waitcnt lgkmcnt(4)
    v_mfma_f32_32x32x16_bf16 v[140:155], v[120:123], v[76:79], v[140:155]
    s_waitcnt vmcnt(15)
    s_barrier
    ds_read_b64_tr_b16 v[132:133], v24 offset:51200
    ds_read_b64_tr_b16 v[134:135], v24 offset:51712
    buffer_load_dwordx4 v19, s[44:47], s59 offen offset:1024 lds
    v_mfma_f32_32x32x16_bf16 v[156:171], v[120:123], v[92:95], v[156:171]
    s_add_u32 m0, s35, 18432
    s_add_u32 s59, s18, s11
    s_waitcnt lgkmcnt(4)
    v_mfma_f32_32x32x16_bf16 v[172:187], v[124:127], v[64:67], v[172:187]
    ds_read_b64_tr_b16 v[136:137], v24 offset:55296
    ds_read_b64_tr_b16 v[138:139], v24 offset:55808
    buffer_load_dwordx4 v18, s[44:47], s59 offen lds
    v_mfma_f32_32x32x16_bf16 v[188:203], v[124:127], v[80:83], v[188:203]
    s_waitcnt lgkmcnt(4)
    v_mfma_f32_32x32x16_bf16 v[172:187], v[128:131], v[68:71], v[172:187]
    ds_read_b64_tr_b16 v[108:109], v25 offset:2048
    ds_read_b64_tr_b16 v[110:111], v25 offset:2560
    buffer_load_dwordx4 v19, s[44:47], s59 offen offset:1024 lds
    v_mfma_f32_32x32x16_bf16 v[188:203], v[128:131], v[84:87], v[188:203]
    s_add_u32 m0, s35, 26624
    s_add_u32 s59, s18, s12
    s_waitcnt lgkmcnt(4)
    v_mfma_f32_32x32x16_bf16 v[172:187], v[132:135], v[72:75], v[172:187]
    ds_read_b64_tr_b16 v[112:113], v25 offset:6144
    ds_read_b64_tr_b16 v[114:115], v25 offset:6656
    buffer_load_dwordx4 v18, s[44:47], s59 offen lds
    v_mfma_f32_32x32x16_bf16 v[188:203], v[132:135], v[88:91], v[188:203]
    s_waitcnt lgkmcnt(4)
    v_mfma_f32_32x32x16_bf16 v[172:187], v[136:139], v[76:79], v[172:187]
    ds_read_b64_tr_b16 v[116:117], v25 offset:10240
    ds_read_b64_tr_b16 v[118:119], v25 offset:10752
    v_mfma_f32_32x32x16_bf16 v[188:203], v[136:139], v[92:95], v[188:203]
    buffer_load_dwordx4 v19, s[44:47], s59 offen offset:1024 lds
    s_waitcnt lgkmcnt(4)
    v_mfma_f32_32x32x16_bf16 v[204:219], v[108:111], v[64:67], v[204:219]
    ds_read_b64_tr_b16 v[120:121], v25 offset:14336
    ds_read_b64_tr_b16 v[122:123], v25 offset:14848
    v_mfma_f32_32x32x16_bf16 v[220:235], v[108:111], v[80:83], v[220:235]
    s_waitcnt lgkmcnt(4)
    v_mfma_f32_32x32x16_bf16 v[204:219], v[112:115], v[68:71], v[204:219]
    ds_read_b64_tr_b16 v[124:125], v14 offset:18432
    ds_read_b64_tr_b16 v[126:127], v14 offset:18944
    v_mfma_f32_32x32x16_bf16 v[220:235], v[112:115], v[84:87], v[220:235]
    ds_read_b64_tr_b16 v[128:129], v14 offset:20480
    ds_read_b64_tr_b16 v[130:131], v14 offset:20992
    s_waitcnt lgkmcnt(6)
    v_mfma_f32_32x32x16_bf16 v[204:219], v[116:119], v[72:75], v[204:219]
    ds_read_b64_tr_b16 v[132:133], v14 offset:22528
    ds_read_b64_tr_b16 v[134:135], v14 offset:23040
    v_mfma_f32_32x32x16_bf16 v[220:235], v[116:119], v[88:91], v[220:235]
    ds_read_b64_tr_b16 v[136:137], v14 offset:24576
    ds_read_b64_tr_b16 v[138:139], v14 offset:25088
    s_waitcnt lgkmcnt(8)
    v_mfma_f32_32x32x16_bf16 v[204:219], v[120:123], v[76:79], v[204:219]
    s_add_u32 m0, s35, 34816
    s_add_u32 s59, s18, s13
    v_mfma_f32_32x32x16_bf16 v[220:235], v[120:123], v[92:95], v[220:235]
    s_waitcnt vmcnt(12)
    s_barrier
    buffer_load_dwordx4 v18, s[44:47], s59 offen lds
    s_waitcnt lgkmcnt(4)
    v_mfma_f32_32x32x16_bf16 v[236:251], v[124:127], v[64:67], v[236:251]
    v_mfma_f32_32x32x16_bf16 v[236:251], v[128:131], v[68:71], v[236:251]
    buffer_load_dwordx4 v19, s[44:47], s59 offen offset:1024 lds
    s_waitcnt lgkmcnt(0)
    v_mfma_f32_32x32x16_bf16 v[236:251], v[132:135], v[72:75], v[236:251]
    v_mfma_f32_32x32x16_bf16 v[236:251], v[136:139], v[76:79], v[236:251]
    s_waitcnt vmcnt(1)
    s_barrier
    ds_read_b32 v26, v11
    s_waitcnt lgkmcnt(0)
    s_add_u32 m0, s35, 43008
    s_add_u32 s59, s18, s15
    buffer_load_dwordx4 v18, s[44:47], s59 offen lds
    buffer_load_dwordx4 v19, s[44:47], s59 offen offset:1024 lds
    s_add_u32 m0, s35, 108544
    s_add_u32 s59, s18, s16
    buffer_load_dwordx4 v18, s[44:47], s59 offen lds
    buffer_load_dwordx4 v19, s[44:47], s59 offen offset:1024 lds
    s_add_u32 m0, s35, 116736
    s_add_u32 s59, s18, s17
    buffer_load_dwordx4 v16, s[44:47], s59 offen lds
    buffer_load_dwordx4 v17, s[44:47], s59 offen offset:1024 lds
    s_add_u32 m0, s35, 124928
    s_add_u32 s59, s97, s9
    buffer_load_dwordx4 v9, s[40:43], s59 offen lds
    buffer_load_dwordx4 v10, s[40:43], s59 offen offset:1024 lds
    s_add_u32 m0, s35, 133120
    s_add_u32 s59, s98, s9
    buffer_load_dwordx4 v9, s[40:43], s59 offen lds
    s_waitcnt vmcnt(9)
    s_barrier
    ds_read_b128 v[32:35], v11 offset:0
    ds_read_b128 v[48:51], v20 offset:0
    ds_read_b64_tr_b16 v[108:109], v24 offset:43008
    ds_read_b64_tr_b16 v[110:111], v24 offset:43520
    ds_read_b128 v[36:39], v11 offset:32
    ds_read_b128 v[52:55], v20 offset:32
    ds_read_b64_tr_b16 v[112:113], v24 offset:47104
    ds_read_b64_tr_b16 v[114:115], v24 offset:47616
    ds_read_b128 v[40:43], v11 offset:64
    ds_read_b128 v[56:59], v20 offset:64
    ds_read_b64_tr_b16 v[116:117], v23 offset:18432
    ds_read_b64_tr_b16 v[118:119], v23 offset:18944
    buffer_load_dwordx4 v10, s[40:43], s59 offen offset:1024 lds
    s_waitcnt lgkmcnt(8)
    v_mfma_f32_32x32x16_bf16 v[140:155], v[108:111], v[32:35], v[140:155]
    ds_read_b128 v[44:47], v11 offset:96
    ds_read_b128 v[60:63], v20 offset:96
    ds_read_b64_tr_b16 v[120:121], v23 offset:22528
    ds_read_b64_tr_b16 v[122:123], v23 offset:23040
    s_add_u32 m0, s35, 141312
    s_add_u32 s59, s99, s9
    buffer_load_dwordx4 v9, s[40:43], s59 offen lds
    v_mfma_f32_32x32x16_bf16 v[156:171], v[108:111], v[48:51], v[156:171]
    buffer_load_dwordx4 v10, s[40:43], s59 offen offset:1024 lds
    s_add_u32 m0, s35, 149504
    s_add_u32 s59, s100, s9
    s_waitcnt lgkmcnt(8)
    v_mfma_f32_32x32x16_bf16 v[140:155], v[112:115], v[36:39], v[140:155]
    ds_read_b64_tr_b16 v[124:125], v23 offset:26624
    ds_read_b64_tr_b16 v[126:127], v23 offset:27136
    buffer_load_dwordx4 v9, s[40:43], s59 offen lds
    v_mfma_f32_32x32x16_bf16 v[156:171], v[112:115], v[52:55], v[156:171]
    buffer_load_dwordx4 v10, s[40:43], s59 offen offset:1024 lds
    s_add_u32 m0, s35, 59392
    s_add_u32 s59, s101, s9
    s_waitcnt lgkmcnt(6)
    v_mfma_f32_32x32x16_bf16 v[140:155], v[116:119], v[40:43], v[140:155]
    ds_read_b64_tr_b16 v[128:129], v23 offset:30720
    ds_read_b64_tr_b16 v[130:131], v23 offset:31232
    buffer_load_dwordx4 v9, s[40:43], s59 offen lds
    v_mfma_f32_32x32x16_bf16 v[156:171], v[116:119], v[56:59], v[156:171]
    buffer_load_dwordx4 v10, s[40:43], s59 offen offset:1024 lds
    s_add_u32 m0, s35, 67584
    s_add_u32 s59, s61, s9
    s_waitcnt lgkmcnt(4)
    v_mfma_f32_32x32x16_bf16 v[140:155], v[120:123], v[44:47], v[140:155]
    ds_read_b64_tr_b16 v[132:133], v23 offset:34816
    ds_read_b64_tr_b16 v[134:135], v23 offset:35328
    buffer_load_dwordx4 v9, s[40:43], s59 offen lds
    v_mfma_f32_32x32x16_bf16 v[156:171], v[120:123], v[60:63], v[156:171]
    s_waitcnt lgkmcnt(4)
    v_mfma_f32_32x32x16_bf16 v[172:187], v[124:127], v[32:35], v[172:187]
    ds_read_b64_tr_b16 v[136:137], v23 offset:38912
    ds_read_b64_tr_b16 v[138:139], v23 offset:39424
    buffer_load_dwordx4 v10, s[40:43], s59 offen offset:1024 lds
    v_mfma_f32_32x32x16_bf16 v[188:203], v[124:127], v[48:51], v[188:203]
    s_add_u32 m0, s35, 75776
    s_add_u32 s59, s62, s9
    s_waitcnt lgkmcnt(4)
    v_mfma_f32_32x32x16_bf16 v[172:187], v[128:131], v[36:39], v[172:187]
    s_waitcnt vmcnt(12)
    s_barrier
    ds_read_b64_tr_b16 v[108:109], v23 offset:43008
    ds_read_b64_tr_b16 v[110:111], v23 offset:43520
    buffer_load_dwordx4 v9, s[40:43], s59 offen lds
    v_mfma_f32_32x32x16_bf16 v[188:203], v[128:131], v[52:55], v[188:203]
    s_waitcnt lgkmcnt(4)
    v_mfma_f32_32x32x16_bf16 v[172:187], v[132:135], v[40:43], v[172:187]
    ds_read_b64_tr_b16 v[112:113], v23 offset:47104
    ds_read_b64_tr_b16 v[114:115], v23 offset:47616
    buffer_load_dwordx4 v10, s[40:43], s59 offen offset:1024 lds
    v_mfma_f32_32x32x16_bf16 v[188:203], v[132:135], v[56:59], v[188:203]
    s_add_u32 m0, s35, 83968
    s_mul_i32 s19, s7, 448
    s_add_u32 s19, s19, s57
    s_add_u32 s59, s19, s10
    s_waitcnt lgkmcnt(4)
    v_mfma_f32_32x32x16_bf16 v[172:187], v[136:139], v[44:47], v[172:187]
    ds_read_b64_tr_b16 v[116:117], v24 offset:51200
    ds_read_b64_tr_b16 v[118:119], v24 offset:51712
    buffer_load_dwordx4 v18, s[44:47], s59 offen lds
    v_mfma_f32_32x32x16_bf16 v[188:203], v[136:139], v[60:63], v[188:203]
    s_waitcnt lgkmcnt(4)
    v_mfma_f32_32x32x16_bf16 v[204:219], v[108:111], v[32:35], v[204:219]
    ds_read_b64_tr_b16 v[120:121], v24 offset:55296
    ds_read_b64_tr_b16 v[122:123], v24 offset:55808
    buffer_load_dwordx4 v19, s[44:47], s59 offen offset:1024 lds
    v_mfma_f32_32x32x16_bf16 v[220:235], v[108:111], v[48:51], v[220:235]
    s_add_u32 m0, s35, 92160
    s_add_u32 s59, s19, s11
    s_waitcnt lgkmcnt(4)
    v_mfma_f32_32x32x16_bf16 v[204:219], v[112:115], v[36:39], v[204:219]
    ds_read_b64_tr_b16 v[124:125], v14 offset:2048
    ds_read_b64_tr_b16 v[126:127], v14 offset:2560
    buffer_load_dwordx4 v18, s[44:47], s59 offen lds
    v_mfma_f32_32x32x16_bf16 v[220:235], v[112:115], v[52:55], v[220:235]
    ds_read_b64_tr_b16 v[128:129], v14 offset:4096
    ds_read_b64_tr_b16 v[130:131], v14 offset:4608
    s_waitcnt lgkmcnt(6)
    v_mfma_f32_32x32x16_bf16 v[204:219], v[116:119], v[40:43], v[204:219]
    ds_read_b64_tr_b16 v[132:133], v14 offset:6144
    ds_read_b64_tr_b16 v[134:135], v14 offset:6656
    buffer_load_dwordx4 v19, s[44:47], s59 offen offset:1024 lds
    v_mfma_f32_32x32x16_bf16 v[220:235], v[116:119], v[56:59], v[220:235]
    ds_read_b64_tr_b16 v[136:137], v14 offset:8192
    ds_read_b64_tr_b16 v[138:139], v14 offset:8704
    s_add_u32 m0, s35, 100352
    s_add_u32 s59, s19, s12
    s_waitcnt lgkmcnt(8)
    v_mfma_f32_32x32x16_bf16 v[204:219], v[120:123], v[44:47], v[204:219]
    buffer_load_dwordx4 v18, s[44:47], s59 offen lds
    v_mfma_f32_32x32x16_bf16 v[220:235], v[120:123], v[60:63], v[220:235]
    s_waitcnt vmcnt(11)
    s_barrier
    s_waitcnt lgkmcnt(4)
    v_mfma_f32_32x32x16_bf16 v[236:251], v[124:127], v[32:35], v[236:251]
    buffer_load_dwordx4 v19, s[44:47], s59 offen offset:1024 lds
    s_add_u32 m0, s35, 18432
    s_add_u32 s59, s19, s13
    v_mfma_f32_32x32x16_bf16 v[236:251], v[128:131], v[36:39], v[236:251]
    buffer_load_dwordx4 v18, s[44:47], s59 offen lds
    s_waitcnt lgkmcnt(0)
    v_mfma_f32_32x32x16_bf16 v[236:251], v[132:135], v[40:43], v[236:251]
    v_mfma_f32_32x32x16_bf16 v[236:251], v[136:139], v[44:47], v[236:251]
    buffer_load_dwordx4 v19, s[44:47], s59 offen offset:1024 lds
    s_add_u32 m0, s35, 26624
    s_add_u32 s59, s19, s15
    buffer_load_dwordx4 v18, s[44:47], s59 offen lds
    buffer_load_dwordx4 v19, s[44:47], s59 offen offset:1024 lds
    s_add_u32 m0, s35, 34816
    s_add_u32 s59, s19, s16
    buffer_load_dwordx4 v18, s[44:47], s59 offen lds
    buffer_load_dwordx4 v19, s[44:47], s59 offen offset:1024 lds
    s_add_u32 m0, s35, 43008
    s_add_u32 s59, s19, s17
    buffer_load_dwordx4 v16, s[44:47], s59 offen lds
    s_waitcnt vmcnt(13)
    s_barrier
    s_mov_b32 s52, s22
    s_mov_b32 s53, s23
    s_mov_b32 s54, 256
    s_mov_b32 s55, 0x20000
    s_lshl_b32 s0, s27, 2
    v_mov_b32 v252, 0
    buffer_load_dword v253, v252, s[52:55], s0 offen sc1
    buffer_load_dwordx4 v17, s[44:47], s59 offen offset:1024 lds
    s_add_u32 m0, s35, 108544
    s_add_u32 s59, s97, s14
    buffer_load_dwordx4 v9, s[40:43], s59 offen lds
    buffer_load_dwordx4 v10, s[40:43], s59 offen offset:1024 lds
    s_add_u32 m0, s35, 116736
    s_add_u32 s59, s98, s14
    buffer_load_dwordx4 v9, s[40:43], s59 offen lds
    buffer_load_dwordx4 v10, s[40:43], s59 offen offset:1024 lds
    s_add_u32 m0, s35, 124928
    s_add_u32 s59, s99, s14
    buffer_load_dwordx4 v9, s[40:43], s59 offen lds
    ds_read_b128 v[64:67], v11 offset:9216
    ds_read_b128 v[80:83], v20 offset:9216
    ds_read_b128 v[68:71], v11 offset:9248
    ds_read_b128 v[84:87], v20 offset:9248
    ds_read_b128 v[72:75], v11 offset:9280
    ds_read_b128 v[88:91], v20 offset:9280
    ds_read_b128 v[76:79], v11 offset:9312
    ds_read_b128 v[92:95], v20 offset:9312
    s_waitcnt vmcnt(12)
    s_barrier
    ds_read_b64_tr_b16 v[108:109], v24 offset:26624
    ds_read_b64_tr_b16 v[110:111], v24 offset:27136
    ds_read_b64_tr_b16 v[112:113], v24 offset:30720
    ds_read_b64_tr_b16 v[114:115], v24 offset:31232
    ds_read_b64_tr_b16 v[116:117], v24 offset:34816
    ds_read_b64_tr_b16 v[118:119], v24 offset:35328
    buffer_load_dwordx4 v10, s[40:43], s59 offen offset:1024 lds
    s_waitcnt lgkmcnt(4)
    v_mfma_f32_32x32x16_bf16 v[140:155], v[108:111], v[64:67], v[140:155]
    ds_read_b64_tr_b16 v[120:121], v24 offset:38912
    ds_read_b64_tr_b16 v[122:123], v24 offset:39424
    s_add_u32 m0, s35, 133120
    s_add_u32 s59, s100, s14
    buffer_load_dwordx4 v9, s[40:43], s59 offen lds
    v_mfma_f32_32x32x16_bf16 v[156:171], v[108:111], v[80:83], v[156:171]
    buffer_load_dwordx4 v10, s[40:43], s59 offen offset:1024 lds
    s_add_u32 m0, s35, 141312
    s_add_u32 s59, s101, s14
    s_waitcnt lgkmcnt(4)
    v_mfma_f32_32x32x16_bf16 v[140:155], v[112:115], v[68:71], v[140:155]
    ds_read_b64_tr_b16 v[124:125], v24 offset:43008
    ds_read_b64_tr_b16 v[126:127], v24 offset:43520
    buffer_load_dwordx4 v9, s[40:43], s59 offen lds
    v_mfma_f32_32x32x16_bf16 v[156:171], v[112:115], v[84:87], v[156:171]
    s_waitcnt lgkmcnt(4)
    v_mfma_f32_32x32x16_bf16 v[140:155], v[116:119], v[72:75], v[140:155]
    ds_read_b64_tr_b16 v[128:129], v24 offset:47104
    ds_read_b64_tr_b16 v[130:131], v24 offset:47616
    buffer_load_dwordx4 v10, s[40:43], s59 offen offset:1024 lds
    v_mfma_f32_32x32x16_bf16 v[156:171], v[116:119], v[88:91], v[156:171]
    s_add_u32 m0, s35, 149504
    s_add_u32 s59, s61, s14
    s_waitcnt lgkmcnt(4)
    v_mfma_f32_32x32x16_bf16 v[140:155], v[120:123], v[76:79], v[140:155]
    ds_read_b64_tr_b16 v[132:133], v23 offset:18432
    ds_read_b64_tr_b16 v[134:135], v23 offset:18944
    buffer_load_dwordx4 v9, s[40:43], s59 offen lds
    v_mfma_f32_32x32x16_bf16 v[156:171], v[120:123], v[92:95], v[156:171]
    s_waitcnt lgkmcnt(4)
    v_mfma_f32_32x32x16_bf16 v[172:187], v[124:127], v[64:67], v[172:187]
    ds_read_b64_tr_b16 v[136:137], v23 offset:22528
    ds_read_b64_tr_b16 v[138:139], v23 offset:23040
    buffer_load_dwordx4 v10, s[40:43], s59 offen offset:1024 lds
    v_mfma_f32_32x32x16_bf16 v[188:203], v[124:127], v[80:83], v[188:203]
    s_add_u32 m0, s35, 59392
    s_add_u32 s59, s62, s14
    s_waitcnt lgkmcnt(4)
    v_mfma_f32_32x32x16_bf16 v[172:187], v[128:131], v[68:71], v[172:187]
    s_waitcnt vmcnt(12)
    s_barrier
    ds_read_b64_tr_b16 v[108:109], v23 offset:26624
    ds_read_b64_tr_b16 v[110:111], v23 offset:27136
    buffer_load_dwordx4 v9, s[40:43], s59 offen lds
    v_mfma_f32_32x32x16_bf16 v[188:203], v[128:131], v[84:87], v[188:203]
    s_waitcnt lgkmcnt(4)
    v_mfma_f32_32x32x16_bf16 v[172:187], v[132:135], v[72:75], v[172:187]
    ds_read_b64_tr_b16 v[112:113], v23 offset:30720
    ds_read_b64_tr_b16 v[114:115], v23 offset:31232
    buffer_load_dwordx4 v10, s[40:43], s59 offen offset:1024 lds
    v_mfma_f32_32x32x16_bf16 v[188:203], v[132:135], v[88:91], v[188:203]
    s_add_u32 m0, s35, 67584
    s_mul_i32 s18, s8, 448
    s_add_u32 s18, s18, s57
    s_add_u32 s59, s18, s10
    s_waitcnt lgkmcnt(4)
    v_mfma_f32_32x32x16_bf16 v[172:187], v[136:139], v[76:79], v[172:187]
    ds_read_b64_tr_b16 v[116:117], v23 offset:34816
    ds_read_b64_tr_b16 v[118:119], v23 offset:35328
    buffer_load_dwordx4 v18, s[44:47], s59 offen lds
    v_mfma_f32_32x32x16_bf16 v[188:203], v[136:139], v[92:95], v[188:203]
    s_waitcnt lgkmcnt(4)
    v_mfma_f32_32x32x16_bf16 v[204:219], v[108:111], v[64:67], v[204:219]
    ds_read_b64_tr_b16 v[120:121], v23 offset:38912
    ds_read_b64_tr_b16 v[122:123], v23 offset:39424
    buffer_load_dwordx4 v19, s[44:47], s59 offen offset:1024 lds
    v_mfma_f32_32x32x16_bf16 v[220:235], v[108:111], v[80:83], v[220:235]
    s_add_u32 m0, s35, 75776
    s_add_u32 s59, s18, s11
    s_waitcnt lgkmcnt(4)
    v_mfma_f32_32x32x16_bf16 v[204:219], v[112:115], v[68:71], v[204:219]
    ds_read_b64_tr_b16 v[124:125], v12 offset:43008
    ds_read_b64_tr_b16 v[126:127], v12 offset:43520
    buffer_load_dwordx4 v18, s[44:47], s59 offen lds
    v_mfma_f32_32x32x16_bf16 v[220:235], v[112:115], v[84:87], v[220:235]
    ds_read_b64_tr_b16 v[128:129], v12 offset:45056
    ds_read_b64_tr_b16 v[130:131], v12 offset:45568
    buffer_load_dwordx4 v19, s[44:47], s59 offen offset:1024 lds
    s_waitcnt lgkmcnt(6)
    v_mfma_f32_32x32x16_bf16 v[204:219], v[116:119], v[72:75], v[204:219]
    ds_read_b64_tr_b16 v[132:133], v12 offset:47104
    ds_read_b64_tr_b16 v[134:135], v12 offset:47616
    s_add_u32 m0, s35, 83968
    s_add_u32 s59, s18, s12
    v_mfma_f32_32x32x16_bf16 v[220:235], v[116:119], v[88:91], v[220:235]
    ds_read_b64_tr_b16 v[136:137], v12 offset:49152
    ds_read_b64_tr_b16 v[138:139], v12 offset:49664
    buffer_load_dwordx4 v18, s[44:47], s59 offen lds
    s_waitcnt lgkmcnt(8)
    v_mfma_f32_32x32x16_bf16 v[204:219], v[120:123], v[76:79], v[204:219]
    v_mfma_f32_32x32x16_bf16 v[220:235], v[120:123], v[92:95], v[220:235]
    s_waitcnt vmcnt(13)
    s_barrier
    buffer_load_dwordx4 v19, s[44:47], s59 offen offset:1024 lds
    s_waitcnt lgkmcnt(4)
    v_mfma_f32_32x32x16_bf16 v[236:251], v[124:127], v[64:67], v[236:251]
    v_mfma_f32_32x32x16_bf16 v[236:251], v[128:131], v[68:71], v[236:251]
    s_waitcnt lgkmcnt(0)
    v_mfma_f32_32x32x16_bf16 v[236:251], v[132:135], v[72:75], v[236:251]
    v_mfma_f32_32x32x16_bf16 v[236:251], v[136:139], v[76:79], v[236:251]
    s_waitcnt vmcnt(1)
    s_barrier
    v_readfirstlane_b32 s31, v253
    s_nop 0
    s_cmp_lg_u32 s31, 0
    s_cbranch_scc0 L_ack_b
L_ackd_b:
    s_and_b32 s31, s31, 2
    s_lshl_b32 s1, s31, 12
    s_add_u32 s96, s96, s1
    s_add_u32 s58, s58, s1
    ds_read_b32 v26, v11
    s_waitcnt lgkmcnt(0)
    s_add_u32 m0, s35, 92160
    s_add_u32 s59, s18, s13
    buffer_load_dwordx4 v18, s[44:47], s59 offen lds
    buffer_load_dwordx4 v19, s[44:47], s59 offen offset:1024 lds
    s_add_u32 m0, s35, 100352
    s_add_u32 s59, s18, s15
    buffer_load_dwordx4 v18, s[44:47], s59 offen lds
    buffer_load_dwordx4 v19, s[44:47], s59 offen offset:1024 lds
    s_add_u32 m0, s35, 18432
    s_add_u32 s59, s18, s16
    buffer_load_dwordx4 v18, s[44:47], s59 offen lds
    buffer_load_dwordx4 v19, s[44:47], s59 offen offset:1024 lds
    s_add_u32 m0, s35, 26624
    s_add_u32 s59, s18, s17
    buffer_load_dwordx4 v16, s[44:47], s59 offen lds
    buffer_load_dwordx4 v17, s[44:47], s59 offen offset:1024 lds
    s_add_u32 m0, s35, 34816
    s_mul_i32 s19, s9, 448
    s_add_u32 s19, s19, s57
    s_add_u32 s59, s19, s10
    buffer_load_dwordx4 v18, s[44:47], s59 offen lds
    buffer_load_dwordx4 v19, s[44:47], s59 offen offset:1024 lds
    s_add_u32 m0, s35, 43008
    s_add_u32 s59, s19, s11
    buffer_load_dwordx4 v18, s[44:47], s59 offen lds
    s_branch L_page6
.p2align 12
L_stub_B1:
    s_branch L_warm
    s_nop 0
L_page6:
    s_waitcnt vmcnt(9)
    s_barrier
    ds_read_b128 v[32:35], v11 offset:0
    ds_read_b128 v[48:51], v20 offset:0
    ds_read_b64_tr_b16 v[108:109], v24 offset:10240
    ds_read_b64_tr_b16 v[110:111], v24 offset:10752
    ds_read_b128 v[36:39], v11 offset:32
    ds_read_b128 v[52:55], v20 offset:32
    ds_read_b64_tr_b16 v[112:113], v24 offset:14336
    ds_read_b64_tr_b16 v[114:115], v24 offset:14848
    ds_read_b128 v[40:43], v11 offset:64
    ds_read_b128 v[56:59], v20 offset:64
    ds_read_b64_tr_b16 v[116:117], v24 offset:18432
    ds_read_b64_tr_b16 v[118:119], v24 offset:18944
    buffer_load_dwordx4 v19, s[44:47], s59 offen offset:1024 lds
    s_waitcnt lgkmcnt(8)
    v_mfma_f32_32x32x16_bf16 v[140:155], v[108:111], v[32:35], v[140:155]
    ds_read_b128 v[44:47], v11 offset:96
    ds_read_b128 v[60:63], v20 offset:96
    ds_read_b64_tr_b16 v[120:121], v24 offset:22528
    ds_read_b64_tr_b16 v[122:123], v24 offset:23040
    s_add_u32 m0, s35, 108544
    s_mul_i32 s18, s14, 448
    s_add_u32 s18, s18, s57
    s_add_u32 s59, s18, s10
    buffer_load_dwordx4 v18, s[44:47], s59 offen lds
    v_mfma_f32_32x32x16_bf16 v[156:171], v[108:111], v[48:51], v[156:171]
    buffer_load_dwordx4 v19, s[44:47], s59 offen offset:1024 lds
    s_add_u32 m0, s35, 116736
    s_add_u32 s59, s18, s11
    s_waitcnt lgkmcnt(8)
    v_mfma_f32_32x32x16_bf16 v[140:155], v[112:115], v[36:39], v[140:155]
    ds_read_b64_tr_b16 v[124:125], v24 offset:26624
    ds_read_b64_tr_b16 v[126:127], v24 offset:27136
    buffer_load_dwordx4 v18, s[44:47], s59 offen lds
    v_mfma_f32_32x32x16_bf16 v[156:171], v[112:115], v[52:55], v[156:171]
    buffer_load_dwordx4 v19, s[44:47], s59 offen offset:1024 lds
    s_add_u32 m0, s35, 124928
    s_add_u32 s59, s19, s12
    s_waitcnt lgkmcnt(6)
    v_mfma_f32_32x32x16_bf16 v[140:155], v[116:119], v[40:43], v[140:155]
    ds_read_b64_tr_b16 v[128:129], v24 offset:30720
    ds_read_b64_tr_b16 v[130:131], v24 offset:31232
    buffer_load_dwordx4 v18, s[44:47], s59 offen lds
    v_mfma_f32_32x32x16_bf16 v[156:171], v[116:119], v[56:59], v[156:171]
    buffer_load_dwordx4 v19, s[44:47], s59 offen offset:1024 lds
    s_add_u32 m0, s35, 133120
    s_add_u32 s59, s19, s13
    s_waitcnt lgkmcnt(4)
    v_mfma_f32_32x32x16_bf16 v[140:155], v[120:123], v[44:47], v[140:155]
    ds_read_b64_tr_b16 v[132:133], v24 offset:34816
    ds_read_b64_tr_b16 v[134:135], v24 offset:35328
    buffer_load_dwordx4 v18, s[44:47], s59 offen lds
    v_mfma_f32_32x32x16_bf16 v[156:171], v[120:123], v[60:63], v[156:171]
    s_waitcnt lgkmcnt(4)
    v_mfma_f32_32x32x16_bf16 v[172:187], v[124:127], v[32:35], v[172:187]
    ds_read_b64_tr_b16 v[136:137], v24 offset:38912
    ds_read_b64_tr_b16 v[138:139], v24 offset:39424
    buffer_load_dwordx4 v19, s[44:47], s59 offen offset:1024 lds
    s_add_u32 m0, s35, 141312
    s_add_u32 s59, s18, s12
    v_mfma_f32_32x32x16_bf16 v[188:203], v[124:127], v[48:51], v[188:203]
    buffer_load_dwordx4 v18, s[44:47], s59 offen lds
    s_waitcnt lgkmcnt(4)
    v_mfma_f32_32x32x16_bf16 v[172:187], v[128:131], v[36:39], v[172:187]
    s_waitcnt vmcnt(13)
    s_barrier
    ds_read_b64_tr_b16 v[108:109], v24 offset:43008
    ds_read_b64_tr_b16 v[110:111], v24 offset:43520
    v_mfma_f32_32x32x16_bf16 v[188:203], v[128:131], v[52:55], v[188:203]
    s_waitcnt lgkmcnt(4)
    v_mfma_f32_32x32x16_bf16 v[172:187], v[132:135], v[40:43], v[172:187]
    ds_read_b64_tr_b16 v[112:113], v24 offset:47104
    ds_read_b64_tr_b16 v[114:115], v24 offset:47616
    v_mfma_f32_32x32x16_bf16 v[188:203], v[132:135], v[56:59], v[188:203]
    s_waitcnt lgkmcnt(4)
    v_mfma_f32_32x32x16_bf16 v[172:187], v[136:139], v[44:47], v[172:187]
    ds_read_b64_tr_b16 v[116:117], v23 offset:18432
    ds_read_b64_tr_b16 v[118:119], v23 offset:18944
    v_mfma_f32_32x32x16_bf16 v[188:203], v[136:139], v[60:63], v[188:203]
    s_waitcnt lgkmcnt(4)
    v_mfma_f32_32x32x16_bf16 v[204:219], v[108:111], v[32:35], v[204:219]
    ds_read_b64_tr_b16 v[120:121], v23 offset:22528
    ds_read_b64_tr_b16 v[122:123], v23 offset:23040
    v_mfma_f32_32x32x16_bf16 v[220:235], v[108:111], v[48:51], v[220:235]
    s_waitcnt lgkmcnt(4)
    v_mfma_f32_32x32x16_bf16 v[204:219], v[112:115], v[36:39], v[204:219]
    ds_read_b64_tr_b16 v[124:125], v12 offset:26624
    ds_read_b64_tr_b16 v[126:127], v12 offset:27136
    v_mfma_f32_32x32x16_bf16 v[220:235], v[112:115], v[52:55], v[220:235]
    ds_read_b64_tr_b16 v[128:129], v12 offset:28672
    ds_read_b64_tr_b16 v[130:131], v12 offset:29184
    s_waitcnt lgkmcnt(6)
    v_mfma_f32_32x32x16_bf16 v[204:219], v[116:119], v[40:43], v[204:219]
    ds_read_b64_tr_b16 v[132:133], v12 offset:30720
    ds_read_b64_tr_b16 v[134:135], v12 offset:31232
    v_mfma_f32_32x32x16_bf16 v[220:235], v[116:119], v[56:59], v[220:235]
    ds_read_b64_tr_b16 v[136:137], v12 offset:32768
    ds_read_b64_tr_b16 v[138:139], v12 offset:33280
    s_waitcnt lgkmcnt(8)
    v_mfma_f32_32x32x16_bf16 v[204:219], v[120:123], v[44:47], v[204:219]
    s_waitcnt vmcnt(9)
    s_barrier
    ds_read_b128 v[64:67], v11 offset:9216
    ds_read_b128 v[80:83], v20 offset:9216
    ds_read_b64_tr_b16 v[108:109], v23 offset:34816
    ds_read_b64_tr_b16 v[110:111], v23 offset:35328
    v_mfma_f32_32x32x16_bf16 v[220:235], v[120:123], v[60:63], v[220:235]
    s_waitcnt lgkmcnt(8)
    v_mfma_f32_32x32x16_bf16 v[236:251], v[124:127], v[32:35], v[236:251]
    ds_read_b128 v[68:71], v11 offset:9248
    ds_read_b128 v[84:87], v20 offset:9248
    ds_read_b64_tr_b16 v[112:113], v23 offset:38912
    ds_read_b64_tr_b16 v[114:115], v23 offset:39424
    v_mfma_f32_32x32x16_bf16 v[236:251], v[128:131], v[36:39], v[236:251]
    s_waitcnt lgkmcnt(8)
    v_mfma_f32_32x32x16_bf16 v[236:251], v[132:135], v[40:43], v[236:251]
    ds_read_b128 v[72:75], v11 offset:9280
    ds_read_b128 v[88:91], v20 offset:9280
    ds_read_b64_tr_b16 v[116:117], v23 offset:43008
    ds_read_b64_tr_b16 v[118:119], v23 offset:43520
    v_mfma_f32_32x32x16_bf16 v[236:251], v[136:139], v[44:47], v[236:251]
    s_waitcnt lgkmcnt(8)
    v_mfma_f32_32x32x16_bf16 v[140:155], v[108:111], v[64:67], v[140:155]
    ds_read_b128 v[76:79], v11 offset:9312
    ds_read_b128 v[92:95], v20 offset:9312
    ds_read_b64_tr_b16 v[120:121], v23 offset:47104
    ds_read_b64_tr_b16 v[122:123], v23 offset:47616
    buffer_load_dwordx4 v19, s[44:47], s59 offen offset:1024 lds
    s_add_u32 m0, s35, 149504
    s_add_u32 s59, s18, s13
    v_mfma_f32_32x32x16_bf16 v[156:171], v[108:111], v[80:83], v[156:171]
    buffer_load_dwordx4 v18, s[44:47], s59 offen lds
    s_waitcnt lgkmcnt(8)
    v_mfma_f32_32x32x16_bf16 v[140:155], v[112:115], v[68:71], v[140:155]
    s_waitcnt vmcnt(3)
    s_barrier
    ds_read_b128 v[32:35], v11 offset:0
    ds_read_b128 v[48:51], v20 offset:0
    ds_read_b64_tr_b16 v[124:125], v24 offset:51200
    ds_read_b64_tr_b16 v[126:127], v24 offset:51712
    v_mfma_f32_32x32x16_bf16 v[156:171], v[112:115], v[84:87], v[156:171]
    buffer_load_dwordx4 v19, s[44:47], s59 offen offset:1024 lds
    s_add_u32 m0, s35, 59392
    s_add_u32 s59, s19, s15
    s_waitcnt lgkmcnt(8)
    v_mfma_f32_32x32x16_bf16 v[140:155], v[116:119], v[72:75], v[140:155]
    ds_read_b128 v[36:39], v11 offset:32
    ds_read_b128 v[52:55], v20 offset:32
    ds_read_b64_tr_b16 v[128:129], v24 offset:55296
    ds_read_b64_tr_b16 v[130:131], v24 offset:55808
    buffer_load_dwordx4 v18, s[44:47], s59 offen lds
    v_mfma_f32_32x32x16_bf16 v[156:171], v[116:119], v[88:91], v[156:171]
    s_waitcnt lgkmcnt(8)
    v_mfma_f32_32x32x16_bf16 v[140:155], v[120:123], v[76:79], v[140:155]
    ds_read_b128 v[40:43], v11 offset:64
    ds_read_b128 v[56:59], v20 offset:64
    ds_read_b64_tr_b16 v[132:133], v25 offset:2048
    ds_read_b64_tr_b16 v[134:135], v25 offset:2560
    buffer_load_dwordx4 v19, s[44:47], s59 offen offset:1024 lds
    s_add_u32 m0, s35, 67584
    s_add_u32 s59, s19, s16
    v_mfma_f32_32x32x16_bf16 v[156:171], v[120:123], v[92:95], v[156:171]
    buffer_load_dwordx4 v18, s[44:47], s59 offen lds
    s_waitcnt lgkmcnt(8)
    v_mfma_f32_32x32x16_bf16 v[140:155], v[124:127], v[32:35], v[140:155]
    ds_read_b128 v[44:47], v11 offset:96
    ds_read_b128 v[60:63], v20 offset:96
    ds_read_b64_tr_b16 v[136:137], v25 offset:6144
    ds_read_b64_tr_b16 v[138:139], v25 offset:6656
    v_mfma_f32_32x32x16_bf16 v[156:171], v[124:127], v[48:51], v[156:171]
    buffer_load_dwordx4 v19, s[44:47], s59 offen offset:1024 lds
    s_add_u32 m0, s35, 75776
    s_add_u32 s59, s18, s15
    s_waitcnt lgkmcnt(8)
    v_mfma_f32_32x32x16_bf16 v[140:155], v[128:131], v[36:39], v[140:155]
    ds_read_b64_tr_b16 v[108:109], v25 offset:10240
    ds_read_b64_tr_b16 v[110:111], v25 offset:10752
    buffer_load_dwordx4 v18, s[44:47], s59 offen lds
    v_mfma_f32_32x32x16_bf16 v[156:171], v[128:131], v[52:55], v[156:171]
    s_waitcnt lgkmcnt(6)
    v_mfma_f32_32x32x16_bf16 v[140:155], v[132:135], v[40:43], v[140:155]
    ds_read_b64_tr_b16 v[112:113], v25 offset:14336
    ds_read_b64_tr_b16 v[114:115], v25 offset:14848
    buffer_load_dwordx4 v19, s[44:47], s59 offen offset:1024 lds
    s_add_u32 m0, s35, 83968
    s_add_u32 s59, s18, s16
    v_mfma_f32_32x32x16_bf16 v[156:171], v[132:135], v[56:59], v[156:171]
    buffer_load_dwordx4 v18, s[44:47], s59 offen lds
    s_waitcnt lgkmcnt(4)
    v_mfma_f32_32x32x16_bf16 v[140:155], v[136:139], v[44:47], v[140:155]
    ds_read_b64_tr_b16 v[116:117], v25 offset:18432
    ds_read_b64_tr_b16 v[118:119], v25 offset:18944
    v_mfma_f32_32x32x16_bf16 v[156:171], v[136:139], v[60:63], v[156:171]
    buffer_load_dwordx4 v19, s[44:47], s59 offen offset:1024 lds
    s_waitcnt lgkmcnt(4)
    v_mfma_f32_32x32x16_bf16 v[172:187], v[108:111], v[64:67], v[172:187]
    ds_read_b64_tr_b16 v[120:121], v25 offset:22528
    ds_read_b64_tr_b16 v[122:123], v25 offset:23040
    v_mfma_f32_32x32x16_bf16 v[188:203], v[108:111], v[80:83], v[188:203]
    s_lshl_b32 s31, s10, 7
    s_add_u32 s31, s31, s58
    s_nop 0
    v_cvt_pk_bf16_f32 v140, v140, v141
    v_cvt_pk_bf16_f32 v141, v142, v143
    v_cvt_pk_bf16_f32 v142, v144, v145
    v_cvt_pk_bf16_f32 v143, v146, v147
    v_cvt_pk_bf16_f32 v144, v148, v149
    v_cvt_pk_bf16_f32 v145, v150, v151
    v_cvt_pk_bf16_f32 v146, v152, v153
    v_cvt_pk_bf16_f32 v147, v154, v155
    buffer_store_dwordx4 v[140:143], v8, s[48:51], s31 offen sc1
    buffer_store_dwordx4 v[144:147], v8, s[48:51], s31 offen offset:1024 sc1
    s_waitcnt lgkmcnt(4)
    v_mfma_f32_32x32x16_bf16 v[172:187], v[112:115], v[68:71], v[172:187]
    s_waitcnt vmcnt(12)
    s_barrier
    ds_read_b64_tr_b16 v[124:125], v25 offset:26624
    ds_read_b64_tr_b16 v[126:127], v25 offset:27136
    v_mfma_f32_32x32x16_bf16 v[188:203], v[112:115], v[84:87], v[188:203]
    s_waitcnt lgkmcnt(4)
    v_mfma_f32_32x32x16_bf16 v[172:187], v[116:119], v[72:75], v[172:187]
    ds_read_b64_tr_b16 v[128:129], v25 offset:30720
    ds_read_b64_tr_b16 v[130:131], v25 offset:31232
    v_mfma_f32_32x32x16_bf16 v[188:203], v[116:119], v[88:91], v[188:203]
    s_waitcnt lgkmcnt(4)
    v_mfma_f32_32x32x16_bf16 v[172:187], v[120:123], v[76:79], v[172:187]
    s_waitcnt vmcnt(4)
    s_barrier
    ds_read_b64_tr_b16 v[132:133], v25 offset:34816
    ds_read_b64_tr_b16 v[134:135], v25 offset:35328
    v_mfma_f32_32x32x16_bf16 v[188:203], v[120:123], v[92:95], v[188:203]
    s_lshl_b32 s31, s10, 7
    s_add_u32 s31, s31, s58
    v_cvt_pk_bf16_f32 v156, v156, v157
    v_cvt_pk_bf16_f32 v157, v158, v159
    v_cvt_pk_bf16_f32 v158, v160, v161
    v_cvt_pk_bf16_f32 v159, v162, v163
    v_cvt_pk_bf16_f32 v160, v164, v165
    v_cvt_pk_bf16_f32 v161, v166, v167
    v_cvt_pk_bf16_f32 v162, v168, v169
    v_cvt_pk_bf16_f32 v163, v170, v171
    buffer_store_dwordx4 v[156:159], v22, s[48:51], s31 offen sc1
    buffer_store_dwordx4 v[160:163], v22, s[48:51], s31 offen offset:1024 sc1
    s_waitcnt lgkmcnt(4)
    v_mfma_f32_32x32x16_bf16 v[172:187], v[124:127], v[32:35], v[172:187]
    ds_read_b64_tr_b16 v[136:137], v25 offset:38912
    ds_read_b64_tr_b16 v[138:139], v25 offset:39424
    v_mfma_f32_32x32x16_bf16 v[188:203], v[124:127], v[48:51], v[188:203]
    s_waitcnt lgkmcnt(4)
    v_mfma_f32_32x32x16_bf16 v[172:187], v[128:131], v[36:39], v[172:187]
    ds_read_b64_tr_b16 v[108:109], v24 offset:2048
    ds_read_b64_tr_b16 v[110:111], v24 offset:2560
    v_mfma_f32_32x32x16_bf16 v[188:203], v[128:131], v[52:55], v[188:203]
    s_waitcnt lgkmcnt(4)
    v_mfma_f32_32x32x16_bf16 v[172:187], v[132:135], v[40:43], v[172:187]
    ds_read_b64_tr_b16 v[112:113], v24 offset:6144
    ds_read_b64_tr_b16 v[114:115], v24 offset:6656
    v_mfma_f32_32x32x16_bf16 v[188:203], v[132:135], v[56:59], v[188:203]
    s_waitcnt lgkmcnt(4)
    v_mfma_f32_32x32x16_bf16 v[172:187], v[136:139], v[44:47], v[172:187]
    ds_read_b64_tr_b16 v[116:117], v24 offset:10240
    ds_read_b64_tr_b16 v[118:119], v24 offset:10752
    v_mfma_f32_32x32x16_bf16 v[188:203], v[136:139], v[60:63], v[188:203]
    s_waitcnt lgkmcnt(4)
    v_mfma_f32_32x32x16_bf16 v[204:219], v[108:111], v[64:67], v[204:219]
    ds_read_b64_tr_b16 v[120:121], v24 offset:14336
    ds_read_b64_tr_b16 v[122:123], v24 offset:14848
    v_mfma_f32_32x32x16_bf16 v[220:235], v[108:111], v[80:83], v[220:235]
    s_lshl_b32 s31, s12, 7
    s_add_u32 s31, s31, s58
    s_nop 1
    v_cvt_pk_bf16_f32 v172, v172, v173
    v_cvt_pk_bf16_f32 v173, v174, v175
    v_cvt_pk_bf16_f32 v174, v176, v177
    v_cvt_pk_bf16_f32 v175, v178, v179
    v_cvt_pk_bf16_f32 v176, v180, v181
    v_cvt_pk_bf16_f32 v177, v182, v183
    v_cvt_pk_bf16_f32 v178, v184, v185
    v_cvt_pk_bf16_f32 v179, v186, v187
    buffer_store_dwordx4 v[172:175], v8, s[48:51], s31 offen sc1
    buffer_store_dwordx4 v[176:179], v8, s[48:51], s31 offen offset:1024 sc1
    s_waitcnt lgkmcnt(4)
    v_mfma_f32_32x32x16_bf16 v[204:219], v[112:115], v[68:71], v[204:219]
    ds_read_b64_tr_b16 v[124:125], v24 offset:18432
    ds_read_b64_tr_b16 v[126:127], v24 offset:18944
    v_mfma_f32_32x32x16_bf16 v[220:235], v[112:115], v[84:87], v[220:235]
    s_waitcnt lgkmcnt(4)
    v_mfma_f32_32x32x16_bf16 v[204:219], v[116:119], v[72:75], v[204:219]
    ds_read_b64_tr_b16 v[128:129], v24 offset:22528
    ds_read_b64_tr_b16 v[130:131], v24 offset:23040
    v_mfma_f32_32x32x16_bf16 v[220:235], v[116:119], v[88:91], v[220:235]
    s_waitcnt lgkmcnt(4)
    v_mfma_f32_32x32x16_bf16 v[204:219], v[120:123], v[76:79], v[204:219]
    s_waitcnt vmcnt(6)
    s_barrier
    ds_read_b64_tr_b16 v[132:133], v24 offset:26624
    ds_read_b64_tr_b16 v[134:135], v24 offset:27136
    v_mfma_f32_32x32x16_bf16 v[220:235], v[120:123], v[92:95], v[220:235]
    s_lshl_b32 s31, s12, 7
    s_add_u32 s31, s31, s58
    v_cvt_pk_bf16_f32 v188, v188, v189
    v_cvt_pk_bf16_f32 v189, v190, v191
    v_cvt_pk_bf16_f32 v190, v192, v193
    v_cvt_pk_bf16_f32 v191, v194, v195
    v_cvt_pk_bf16_f32 v192, v196, v197
    v_cvt_pk_bf16_f32 v193, v198, v199
    v_cvt_pk_bf16_f32 v194, v200, v201
    v_cvt_pk_bf16_f32 v195, v202, v203
    buffer_store_dwordx4 v[188:191], v22, s[48:51], s31 offen sc1
    buffer_store_dwordx4 v[192:195], v22, s[48:51], s31 offen offset:1024 sc1
    s_waitcnt lgkmcnt(4)
    v_mfma_f32_32x32x16_bf16 v[204:219], v[124:127], v[32:35], v[204:219]
    ds_read_b64_tr_b16 v[136:137], v24 offset:30720
    ds_read_b64_tr_b16 v[138:139], v24 offset:31232
    v_mfma_f32_32x32x16_bf16 v[220:235], v[124:127], v[48:51], v[220:235]
    s_waitcnt lgkmcnt(4)
    v_mfma_f32_32x32x16_bf16 v[204:219], v[128:131], v[36:39], v[204:219]
    v_mfma_f32_32x32x16_bf16 v[220:235], v[128:131], v[52:55], v[220:235]
    s_waitcnt lgkmcnt(2)
    v_mfma_f32_32x32x16_bf16 v[204:219], v[132:135], v[40:43], v[204:219]
    v_mfma_f32_32x32x16_bf16 v[220:235], v[132:135], v[56:59], v[220:235]
    s_waitcnt lgkmcnt(0)
    v_mfma_f32_32x32x16_bf16 v[204:219], v[136:139], v[44:47], v[204:219]
    v_mfma_f32_32x32x16_bf16 v[220:235], v[136:139], v[60:63], v[220:235]
    s_lshl_b32 s31, s15, 7
    s_add_u32 s31, s31, s58
    s_nop 8
    v_cvt_pk_bf16_f32 v204, v204, v205
    v_cvt_pk_bf16_f32 v205, v206, v207
    v_cvt_pk_bf16_f32 v206, v208, v209
    v_cvt_pk_bf16_f32 v207, v210, v211
    v_cvt_pk_bf16_f32 v208, v212, v213
    v_cvt_pk_bf16_f32 v209, v214, v215
    v_cvt_pk_bf16_f32 v210, v216, v217
    v_cvt_pk_bf16_f32 v211, v218, v219
    buffer_store_dwordx4 v[204:207], v8, s[48:51], s31 offen sc1
    buffer_store_dwordx4 v[208:211], v8, s[48:51], s31 offen offset:1024 sc1
    s_lshl_b32 s31, s15, 7
    s_add_u32 s31, s31, s58
    v_cvt_pk_bf16_f32 v220, v220, v221
    v_cvt_pk_bf16_f32 v221, v222, v223
    v_cvt_pk_bf16_f32 v222, v224, v225
    v_cvt_pk_bf16_f32 v223, v226, v227
    v_cvt_pk_bf16_f32 v224, v228, v229
    v_cvt_pk_bf16_f32 v225, v230, v231
    v_cvt_pk_bf16_f32 v226, v232, v233
    v_cvt_pk_bf16_f32 v227, v234, v235
    buffer_store_dwordx4 v[220:223], v22, s[48:51], s31 offen sc1
    buffer_store_dwordx4 v[224:227], v22, s[48:51], s31 offen offset:1024 sc1
    s_waitcnt vmcnt(4)
    s_barrier
    s_waitcnt vmcnt(0)
    s_barrier
    s_add_u32 s6, s26, 36
    s_lshl_b32 s6, s6, 14
    s_lshl_b32 s31, s32, 11
    s_add_u32 s6, s6, s31
    s_add_u32 s6, s6, s1
    s_lshl_b32 s4, s17, 7
    s_add_u32 s4, s4, s1
    s_add_u32 s7, s26, 1
    s_and_b32 s7, s7, 3
    s_mul_i32 s7, s7, 114688
    s_add_u32 s7, s7, s4
    s_add_u32 s8, s26, 2
    s_and_b32 s8, s8, 3
    s_mul_i32 s8, s8, 114688
    s_add_u32 s8, s8, s4
    s_add_u32 s9, s26, 3
    s_and_b32 s9, s9, 3
    s_mul_i32 s9, s9, 114688
    s_add_u32 s9, s9, s4
    s_lshl_b32 s5, s27, 1
    s_add_u32 s5, s5, s33
    s_mul_i32 s5, s5, 28672
    s_add_u32 s5, s5, s17
    s_lshl_b32 s31, s34, 6
    s_add_u32 s5, s5, s31
    s_mov_b32 s100, 0x3f80
    s_mov_b32 s101, 0x3f800000
    s_add_u32 m0, s35, 92160
    s_add_u32 s59, s19, s17
    buffer_load_dwordx4 v16, s[44:47], s59 offen lds
    buffer_load_dwordx4 v17, s[44:47], s59 offen offset:1024 lds
    s_add_u32 m0, s35, 100352
    s_add_u32 s59, s18, s17
    buffer_load_dwordx4 v16, s[44:47], s59 offen lds
    buffer_load_dwordx4 v17, s[44:47], s59 offen offset:1024 lds
    s_waitcnt vmcnt(0)
    s_barrier
    buffer_load_dwordx4 v[140:143], v21, s[48:51], s6 offen offset:0 sc1
    buffer_load_dwordx4 v[144:147], v21, s[48:51], s6 offen offset:1024 sc1
    buffer_load_dwordx4 v[156:159], v8, s[48:51], s7 offen offset:0 sc1
    buffer_load_dwordx4 v[160:163], v8, s[48:51], s7 offen offset:1024 sc1
    buffer_load_dwordx4 v[164:167], v8, s[48:51], s8 offen offset:0 sc1
    buffer_load_dwordx4 v[168:171], v8, s[48:51], s8 offen offset:1024 sc1
    buffer_load_dwordx4 v[172:175], v8, s[48:51], s9 offen offset:0 sc1
    buffer_load_dwordx4 v[176:179], v8, s[48:51], s9 offen offset:1024 sc1
    ds_read_b64_tr_b16 v[108:109], v13 offset:34816
    ds_read_b64_tr_b16 v[110:111], v13 offset:35328
    ds_read_b64_tr_b16 v[112:113], v13 offset:36864
    ds_read_b64_tr_b16 v[114:115], v13 offset:37376
    ds_read_b64_tr_b16 v[116:117], v13 offset:38912
    ds_read_b64_tr_b16 v[118:119], v13 offset:39424
    ds_read_b64_tr_b16 v[120:121], v13 offset:40960
    ds_read_b64_tr_b16 v[122:123], v13 offset:41472
    ds_read_b64_tr_b16 v[124:125], v13 offset:43008
    ds_read_b64_tr_b16 v[126:127], v13 offset:43520
    ds_read_b64_tr_b16 v[128:129], v13 offset:45056
    ds_read_b64_tr_b16 v[130:131], v13 offset:45568
    ds_read_b64_tr_b16 v[132:133], v13 offset:47104
    ds_read_b64_tr_b16 v[134:135], v13 offset:47616
    ds_read_b64_tr_b16 v[136:137], v13 offset:49152
    ds_read_b64_tr_b16 v[138:139], v13 offset:49664
    s_waitcnt lgkmcnt(14)
    v_mfma_f32_32x32x16_bf16 v[236:251], v[108:111], v[64:67], v[236:251]
    s_waitcnt lgkmcnt(12)
    v_mfma_f32_32x32x16_bf16 v[236:251], v[112:115], v[68:71], v[236:251]
    s_waitcnt lgkmcnt(10)
    v_mfma_f32_32x32x16_bf16 v[236:251], v[116:119], v[72:75], v[236:251]
    s_waitcnt lgkmcnt(8)
    v_mfma_f32_32x32x16_bf16 v[236:251], v[120:123], v[76:79], v[236:251]
    s_waitcnt lgkmcnt(6)
    v_mfma_f32_32x32x16_bf16 v[236:251], v[124:127], v[32:35], v[236:251]
    s_waitcnt lgkmcnt(4)
    v_mfma_f32_32x32x16_bf16 v[236:251], v[128:131], v[36:39], v[236:251]
    s_waitcnt lgkmcnt(2)
    v_mfma_f32_32x32x16_bf16 v[236:251], v[132:135], v[40:43], v[236:251]
    s_waitcnt lgkmcnt(0)
    v_mfma_f32_32x32x16_bf16 v[236:251], v[136:139], v[44:47], v[236:251]
    s_waitcnt vmcnt(6)
    s_nop 10
    v_dot2c_f32_bf16 v236, s100, v140
    v_dot2c_f32_bf16 v237, s101, v140
    v_dot2c_f32_bf16 v238, s100, v141
    v_dot2c_f32_bf16 v239, s101, v141
    v_dot2c_f32_bf16 v240, s100, v142
    v_dot2c_f32_bf16 v241, s101, v142
    v_dot2c_f32_bf16 v242, s100, v143
    v_dot2c_f32_bf16 v243, s101, v143
    v_dot2c_f32_bf16 v244, s100, v144
    v_dot2c_f32_bf16 v245, s101, v144
    v_dot2c_f32_bf16 v246, s100, v145
    v_dot2c_f32_bf16 v247, s101, v145
    v_dot2c_f32_bf16 v248, s100, v146
    v_dot2c_f32_bf16 v249, s101, v146
    v_dot2c_f32_bf16 v250, s100, v147
    v_dot2c_f32_bf16 v251, s101, v147
    s_waitcnt vmcnt(5)
    v_dot2c_f32_bf16 v236, s100, v156
    v_dot2c_f32_bf16 v237, s101, v156
    v_dot2c_f32_bf16 v238, s100, v157
    v_dot2c_f32_bf16 v239, s101, v157
    v_dot2c_f32_bf16 v240, s100, v158
    v_dot2c_f32_bf16 v241, s101, v158
    v_dot2c_f32_bf16 v242, s100, v159
    v_dot2c_f32_bf16 v243, s101, v159
    s_waitcnt vmcnt(4)
    v_dot2c_f32_bf16 v244, s100, v160
    v_dot2c_f32_bf16 v245, s101, v160
    v_dot2c_f32_bf16 v246, s100, v161
    v_dot2c_f32_bf16 v247, s101, v161
    v_dot2c_f32_bf16 v248, s100, v162
    v_dot2c_f32_bf16 v249, s101, v162
    v_dot2c_f32_bf16 v250, s100, v163
    v_dot2c_f32_bf16 v251, s101, v163
    s_waitcnt vmcnt(3)
    v_dot2c_f32_bf16 v236, s100, v164
    v_dot2c_f32_bf16 v237, s101, v164
    v_dot2c_f32_bf16 v238, s100, v165
    v_dot2c_f32_bf16 v239, s101, v165
    v_dot2c_f32_bf16 v240, s100, v166
    v_dot2c_f32_bf16 v241, s101, v166
    v_dot2c_f32_bf16 v242, s100, v167
    v_dot2c_f32_bf16 v243, s101, v167
    s_waitcnt vmcnt(2)
    v_dot2c_f32_bf16 v244, s100, v168
    v_dot2c_f32_bf16 v245, s101, v168
    v_dot2c_f32_bf16 v246, s100, v169
    v_dot2c_f32_bf16 v247, s101, v169
    v_dot2c_f32_bf16 v248, s100, v170
    v_dot2c_f32_bf16 v249, s101, v170
    v_dot2c_f32_bf16 v250, s100, v171
    v_dot2c_f32_bf16 v251, s101, v171
    s_waitcnt vmcnt(1)
    v_dot2c_f32_bf16 v236, s100, v172
    v_dot2c_f32_bf16 v237, s101, v172
    v_dot2c_f32_bf16 v238, s100, v173
    v_dot2c_f32_bf16 v239, s101, v173
    v_dot2c_f32_bf16 v240, s100, v174
    v_dot2c_f32_bf16 v241, s101, v174
    v_dot2c_f32_bf16 v242, s100, v175
    v_dot2c_f32_bf16 v243, s101, v175
    s_waitcnt vmcnt(0)
    v_dot2c_f32_bf16 v244, s100, v176
    v_dot2c_f32_bf16 v245, s101, v176
    v_dot2c_f32_bf16 v246, s100, v177
    v_dot2c_f32_bf16 v247, s101, v177
    v_dot2c_f32_bf16 v248, s100, v178
    v_dot2c_f32_bf16 v249, s101, v178
    v_dot2c_f32_bf16 v250, s100, v179
    v_dot2c_f32_bf16 v251, s101, v179
    v_cvt_pk_bf16_f32 v140, v236, v237
    v_cvt_pk_bf16_f32 v141, v238, v239
    v_cvt_pk_bf16_f32 v142, v240, v241
    v_cvt_pk_bf16_f32 v143, v242, v243
    v_cvt_pk_bf16_f32 v144, v244, v245
    v_cvt_pk_bf16_f32 v145, v246, v247
    v_cvt_pk_bf16_f32 v146, v248, v249
    v_cvt_pk_bf16_f32 v147, v250, v251
    buffer_store_dwordx4 v[140:143], v27, s[36:39], s5 offen offset:0
    buffer_store_dwordx4 v[144:147], v27, s[36:39], s5 offen offset:16
    s_endpgm
.p2align 12
L_att:
    s_mov_b32 s40, s6
    s_mov_b32 s41, s7
    s_mov_b32 s42, 1204224
    s_mov_b32 s43, 0x20000
    s_mov_b32 s44, s8
    s_mov_b32 s45, s9
    s_mov_b32 s46, 401408
    s_mov_b32 s47, 0x20000
    s_and_b32 s32, s3, 3
    s_and_b32 s33, s32, 1
    s_lshr_b32 s34, s32, 1
    s_mul_i32 s56, s26, 224
    s_mul_i32 s4, s97, 1344
    s_add_u32 s4, s4, s56
    s_mul_i32 s5, s98, 1344
    s_add_u32 s5, s5, s56
    s_mul_i32 s6, s99, 1344
    s_add_u32 s6, s6, s56
    s_mul_i32 s7, s100, 1344
    s_add_u32 s7, s7, s56
    s_mul_i32 s12, s101, 1344
    s_add_u32 s12, s12, s56
    s_mul_i32 s13, s61, 1344
    s_add_u32 s13, s13, s56
    s_mul_i32 s14, s62, 1344
    s_add_u32 s14, s14, s56
    v_and_b32 v16, 31, v0
    v_lshrrev_b32 v17, 5, v0
    v_mul_u32_u24 v6, 240, v16
    v_lshl_add_u32 v6, v17, 4, v6
    s_lshl_b32 s31, s32, 6
    v_add_u32 v6, s31, v6
    v_lshlrev_b32 v5, 4, v0
    v_lshrrev_b32 v16, 5, v0
    v_bfe_u32 v17, v0, 2, 2
    v_lshl_add_u32 v16, v16, 3, v17
    v_lshlrev_b32 v8, 7, v16
    v_and_b32 v16, 1, v0
    v_bfe_u32 v18, v0, 4, 1
    v_lshl_add_u32 v16, v16, 1, v18
    v_lshrrev_b32 v17, 1, v17
    v_xor_b32 v17, s34, v17
    v_lshl_add_u32 v16, v17, 2, v16
    v_lshl_add_u32 v8, v16, 4, v8
    v_bfe_u32 v16, v0, 1, 1
    v_lshl_add_u32 v8, v16, 3, v8
    s_lshr_b32 s31, s3, 2
    s_lshl_b32 s31, s31, 13
    s_add_u32 s31, s31, 16384
    v_add_u32 v8, s31, v8
    v_add_u32 v7, 74240, v8
    s_cmp_ge_u32 s3, 4
    s_cbranch_scc1 L_att_ld
    v_and_b32 v28, 15, v0
    v_lshrrev_b32 v29, 4, v0
    s_and_b32 s31, s3, 1
    s_lshl_b32 s35, s31, 12
    s_lshl_b32 s31, s31, 4
    v_add_u32 v30, s31, v29
    v_mul_u32_u24 v30, 2688, v30
    v_lshlrev_b32 v31, 1, v29
    v_sub_u32 v31, v0, v31
    v_add_u32 v60, 0, v31
    v_and_b32 v60, 15, v60
    v_min_u32 v60, 13, v60
    v_lshl_add_u32 v60, v60, 4, v30
    v_add_u32 v92, 0, v60
    v_add_u32 v93, 9728, v92
    v_add_u32 v60, 8, v31
    v_and_b32 v60, 15, v60
    v_min_u32 v60, 13, v60
    v_lshl_add_u32 v60, v60, 4, v30
    v_add_u32 v94, 19456, v60
    v_add_u32 v95, 9728, v94
    v_mul_u32_u24 v9, 928, v28
    v_lshl_add_u32 v9, v29, 4, v9
    v_bfe_u32 v30, v0, 2, 2
    v_lshl_add_u32 v31, v29, 3, v30
    v_lshlrev_b32 v31, 8, v31
    v_add_u32 v31, 74240, v31
    v_and_b32 v60, 1, v29
    v_lshl_add_u32 v60, v60, 2, v30
    v_lshlrev_b32 v60, 5, v60
    v_and_b32 v61, 3, v0
    v_lshl_add_u32 v60, v61, 3, v60
    s_mul_i32 s31, s3, 56
    v_add_u32 v60, s31, v60
    v_add_u32 v61, 0, v60
    v_and_b32 v61, 255, v61
    v_add_u32 v10, v61, v31
    v_add_u32 v11, 40960, v10
    v_add_u32 v61, 32, v60
    v_and_b32 v61, 255, v61
    v_add_u32 v12, v61, v31
    v_add_u32 v13, 40960, v12
    v_mul_u32_u24 v14, 240, v28
    v_add_u32 v61, 224, v14
    v_lshl_add_u32 v14, v29, 3, v14
    v_add_u32 v14, s31, v14
    v_add_u32 v15, 32, v14
    v_cmp_eq_u32 vcc, 3, v29
    s_nop 1
    v_cndmask_b32 v15, v15, v61, vcc
    v_mov_b32 v63, 0
    v_cndmask_b32 v244, -1, v63, vcc
    v_mov_b32 v62, 0xf149f2ca
    v_lshlrev_b32 v60, 2, v29
    v_sub_u32 v60, v28, v60
    v_add_u32 v61, 0, v60
    v_and_b32 v61, 0xfffffff1, v61
    v_cmp_eq_u32 vcc, 0, v61
    s_nop 1
    v_cndmask_b32 v228, v62, v61, vcc
    v_add_u32 v61, 16, v60
    v_and_b32 v61, 0xfffffff1, v61
    v_cmp_eq_u32 vcc, 0, v61
    s_nop 1
    v_cndmask_b32 v232, v62, v61, vcc
    v_add_u32 v61, -1, v60
    v_and_b32 v61, 0xfffffff1, v61
    v_cmp_eq_u32 vcc, 0, v61
    s_nop 1
    v_cndmask_b32 v229, v62, v61, vcc
    v_add_u32 v61, 15, v60
    v_and_b32 v61, 0xfffffff1, v61
    v_cmp_eq_u32 vcc, 0, v61
    s_nop 1
    v_cndmask_b32 v233, v62, v61, vcc
    v_add_u32 v61, -2, v60
    v_and_b32 v61, 0xfffffff1, v61
    v_cmp_eq_u32 vcc, 0, v61
    s_nop 1
    v_cndmask_b32 v230, v62, v61, vcc
    v_add_u32 v61, 14, v60
    v_and_b32 v61, 0xfffffff1, v61
    v_cmp_eq_u32 vcc, 0, v61
    s_nop 1
    v_cndmask_b32 v234, v62, v61, vcc
    v_add_u32 v61, -3, v60
    v_and_b32 v61, 0xfffffff1, v61
    v_cmp_eq_u32 vcc, 0, v61
    s_nop 1
    v_cndmask_b32 v231, v62, v61, vcc
    v_add_u32 v61, 13, v60
    v_and_b32 v61, 0xfffffff1, v61
    v_cmp_eq_u32 vcc, 0, v61
    s_nop 1
    v_cndmask_b32 v235, v62, v61, vcc
    s_cmp_eq_u32 s27, 0
    s_cselect_b64 vcc, -1, 0
    v_cndmask_b32 v236, v232, v62, vcc
    v_cndmask_b32 v237, v233, v62, vcc
    v_cndmask_b32 v238, v234, v62, vcc
    v_cndmask_b32 v239, v235, v62, vcc
    v_and_b32 v61, 1, v28
    v_lshlrev_b32 v61, 4, v61
    v_mov_b32 v30, 0xffff
    v_lshlrev_b32 v61, v61, v30
    v_cmp_le_i32 vcc, 0, v60
    s_nop 1
    v_cndmask_b32 v240, v61, v63, vcc
    v_cndmask_b32 v242, v63, v61, vcc
    v_cmp_le_i32 vcc, 2, v60
    s_nop 1
    v_cndmask_b32 v241, v61, v63, vcc
    v_cndmask_b32 v243, v63, v61, vcc
    v_mov_b32 v16, 0
    v_mov_b32 v17, 0
    s_waitcnt vmcnt(6)
    v_dot2c_f32_bf16 v16, s29, v32
    v_dot2c_f32_bf16 v17, v32, v32
    v_dot2c_f32_bf16 v16, s29, v33
    v_dot2c_f32_bf16 v17, v33, v33
    v_dot2c_f32_bf16 v16, s29, v34
    v_dot2c_f32_bf16 v17, v34, v34
    v_dot2c_f32_bf16 v16, s29, v35
    v_dot2c_f32_bf16 v17, v35, v35
    s_waitcnt vmcnt(5)
    v_dot2c_f32_bf16 v16, s29, v36
    v_dot2c_f32_bf16 v17, v36, v36
    v_dot2c_f32_bf16 v16, s29, v37
    v_dot2c_f32_bf16 v17, v37, v37
    v_dot2c_f32_bf16 v16, s29, v38
    v_dot2c_f32_bf16 v17, v38, v38
    v_dot2c_f32_bf16 v16, s29, v39
    v_dot2c_f32_bf16 v17, v39, v39
    s_waitcnt vmcnt(4)
    v_dot2c_f32_bf16 v16, s29, v40
    v_dot2c_f32_bf16 v17, v40, v40
    v_dot2c_f32_bf16 v16, s29, v41
    v_dot2c_f32_bf16 v17, v41, v41
    v_dot2c_f32_bf16 v16, s29, v42
    v_dot2c_f32_bf16 v17, v42, v42
    v_dot2c_f32_bf16 v16, s29, v43
    v_dot2c_f32_bf16 v17, v43, v43
    s_waitcnt vmcnt(3)
    v_dot2c_f32_bf16 v16, s29, v44
    v_dot2c_f32_bf16 v17, v44, v44
    v_dot2c_f32_bf16 v16, s29, v45
    v_dot2c_f32_bf16 v17, v45, v45
    v_dot2c_f32_bf16 v16, s29, v46
    v_dot2c_f32_bf16 v17, v46, v46
    v_dot2c_f32_bf16 v16, s29, v47
    v_dot2c_f32_bf16 v17, v47, v47
    s_waitcnt vmcnt(2)
    v_dot2c_f32_bf16 v16, s29, v48
    v_dot2c_f32_bf16 v17, v48, v48
    v_dot2c_f32_bf16 v16, s29, v49
    v_dot2c_f32_bf16 v17, v49, v49
    v_dot2c_f32_bf16 v16, s29, v50
    v_dot2c_f32_bf16 v17, v50, v50
    v_dot2c_f32_bf16 v16, s29, v51
    v_dot2c_f32_bf16 v17, v51, v51
    s_waitcnt vmcnt(1)
    v_dot2c_f32_bf16 v16, s29, v52
    v_dot2c_f32_bf16 v17, v52, v52
    v_dot2c_f32_bf16 v16, s29, v53
    v_dot2c_f32_bf16 v17, v53, v53
    v_dot2c_f32_bf16 v16, s29, v54
    v_dot2c_f32_bf16 v17, v54, v54
    v_dot2c_f32_bf16 v16, s29, v55
    v_dot2c_f32_bf16 v17, v55, v55
    s_waitcnt vmcnt(0)
    v_dot2c_f32_bf16 v16, s29, v56
    v_dot2c_f32_bf16 v17, v56, v56
    v_dot2c_f32_bf16 v16, s29, v57
    v_dot2c_f32_bf16 v17, v57, v57
    v_dot2c_f32_bf16 v16, s29, v58
    v_dot2c_f32_bf16 v17, v58, v58
    v_dot2c_f32_bf16 v16, s29, v59
    v_dot2c_f32_bf16 v17, v59, v59
    s_nop 1
    v_add_f32_dpp v16, v16, v16 quad_perm:[1,0,3,2] row_mask:0xf bank_mask:0xf
    v_add_f32_dpp v17, v17, v17 quad_perm:[1,0,3,2] row_mask:0xf bank_mask:0xf
    s_nop 0
    v_add_f32_dpp v16, v16, v16 quad_perm:[2,3,0,1] row_mask:0xf bank_mask:0xf
    v_add_f32_dpp v17, v17, v17 quad_perm:[2,3,0,1] row_mask:0xf bank_mask:0xf
    s_nop 0
    v_add_f32_dpp v16, v16, v16 row_half_mirror row_mask:0xf bank_mask:0xf
    v_add_f32_dpp v17, v17, v17 row_half_mirror row_mask:0xf bank_mask:0xf
    v_mul_f32 v16, 0x3b124925, v16
    v_mul_f32 v17, 0x3b124925, v17
    v_fma_f32 v17, -v16, v16, v17
    v_max_f32 v17, 0, v17
    v_add_f32 v17, 0x3727c5ac, v17
    v_rsq_f32 v18, v17
    s_nop 0
    v_mul_f32 v20, v16, v18
    v_sub_f32 v20, 0, v20
    s_cmp_ge_u32 s3, 2
    s_cbranch_scc1 L_nohl
    s_sub_u32 s31, s59, 14336
    s_cselect_b32 s31, 0x7f000000, s31
    buffer_load_dwordx4 v[64:67], v3, s[36:39], s31 offen offset:0
    buffer_load_dwordx4 v[68:71], v3, s[36:39], s31 offen offset:128
    buffer_load_dwordx4 v[72:75], v3, s[36:39], s31 offen offset:256
    buffer_load_dwordx4 v[76:79], v3, s[36:39], s31 offen offset:384
    buffer_load_dwordx4 v[80:83], v3, s[36:39], s31 offen offset:512
    buffer_load_dwordx4 v[84:87], v3, s[36:39], s31 offen offset:640
    buffer_load_dwordx4 v[88:91], v3, s[36:39], s31 offen offset:768
    v_lshlrev_b32 v22, 16, v32
    v_and_b32 v23, s30, v32
    v_lshlrev_b32 v24, 16, v33
    v_and_b32 v25, s30, v33
    v_lshlrev_b32 v26, 16, v34
    v_and_b32 v27, s30, v34
    v_lshlrev_b32 v28, 16, v35
    v_and_b32 v29, s30, v35
    v_pk_fma_f32 v[22:23], v[22:23], v[18:19], v[20:21] op_sel_hi:[1,0,0]
    v_pk_fma_f32 v[24:25], v[24:25], v[18:19], v[20:21] op_sel_hi:[1,0,0]
    v_pk_fma_f32 v[26:27], v[26:27], v[18:19], v[20:21] op_sel_hi:[1,0,0]
    v_pk_fma_f32 v[28:29], v[28:29], v[18:19], v[20:21] op_sel_hi:[1,0,0]
    v_cvt_pk_bf16_f32 v32, v22, v23
    v_cvt_pk_bf16_f32 v33, v24, v25
    v_cvt_pk_bf16_f32 v34, v26, v27
    v_cvt_pk_bf16_f32 v35, v28, v29
    ds_write_b128 v100, v[32:35] offset:14848
    v_lshlrev_b32 v22, 16, v36
    v_and_b32 v23, s30, v36
    v_lshlrev_b32 v24, 16, v37
    v_and_b32 v25, s30, v37
    v_lshlrev_b32 v26, 16, v38
    v_and_b32 v27, s30, v38
    v_lshlrev_b32 v28, 16, v39
    v_and_b32 v29, s30, v39
    v_pk_fma_f32 v[22:23], v[22:23], v[18:19], v[20:21] op_sel_hi:[1,0,0]
    v_pk_fma_f32 v[24:25], v[24:25], v[18:19], v[20:21] op_sel_hi:[1,0,0]
    v_pk_fma_f32 v[26:27], v[26:27], v[18:19], v[20:21] op_sel_hi:[1,0,0]
    v_pk_fma_f32 v[28:29], v[28:29], v[18:19], v[20:21] op_sel_hi:[1,0,0]
    v_cvt_pk_bf16_f32 v36, v22, v23
    v_cvt_pk_bf16_f32 v37, v24, v25
    v_cvt_pk_bf16_f32 v38, v26, v27
    v_cvt_pk_bf16_f32 v39, v28, v29
    ds_write_b128 v101, v[36:39] offset:14848
    v_lshlrev_b32 v22, 16, v40
    v_and_b32 v23, s30, v40
    v_lshlrev_b32 v24, 16, v41
    v_and_b32 v25, s30, v41
    v_lshlrev_b32 v26, 16, v42
    v_and_b32 v27, s30, v42
    v_lshlrev_b32 v28, 16, v43
    v_and_b32 v29, s30, v43
    v_pk_fma_f32 v[22:23], v[22:23], v[18:19], v[20:21] op_sel_hi:[1,0,0]
    v_pk_fma_f32 v[24:25], v[24:25], v[18:19], v[20:21] op_sel_hi:[1,0,0]
    v_pk_fma_f32 v[26:27], v[26:27], v[18:19], v[20:21] op_sel_hi:[1,0,0]
    v_pk_fma_f32 v[28:29], v[28:29], v[18:19], v[20:21] op_sel_hi:[1,0,0]
    v_cvt_pk_bf16_f32 v40, v22, v23
    v_cvt_pk_bf16_f32 v41, v24, v25
    v_cvt_pk_bf16_f32 v42, v26, v27
    v_cvt_pk_bf16_f32 v43, v28, v29
    ds_write_b128 v102, v[40:43] offset:14848
    v_lshlrev_b32 v22, 16, v44
    v_and_b32 v23, s30, v44
    v_lshlrev_b32 v24, 16, v45
    v_and_b32 v25, s30, v45
    v_lshlrev_b32 v26, 16, v46
    v_and_b32 v27, s30, v46
    v_lshlrev_b32 v28, 16, v47
    v_and_b32 v29, s30, v47
    v_pk_fma_f32 v[22:23], v[22:23], v[18:19], v[20:21] op_sel_hi:[1,0,0]
    v_pk_fma_f32 v[24:25], v[24:25], v[18:19], v[20:21] op_sel_hi:[1,0,0]
    v_pk_fma_f32 v[26:27], v[26:27], v[18:19], v[20:21] op_sel_hi:[1,0,0]
    v_pk_fma_f32 v[28:29], v[28:29], v[18:19], v[20:21] op_sel_hi:[1,0,0]
    v_cvt_pk_bf16_f32 v44, v22, v23
    v_cvt_pk_bf16_f32 v45, v24, v25
    v_cvt_pk_bf16_f32 v46, v26, v27
    v_cvt_pk_bf16_f32 v47, v28, v29
    ds_write_b128 v103, v[44:47] offset:14848
    v_lshlrev_b32 v22, 16, v48
    v_and_b32 v23, s30, v48
    v_lshlrev_b32 v24, 16, v49
    v_and_b32 v25, s30, v49
    v_lshlrev_b32 v26, 16, v50
    v_and_b32 v27, s30, v50
    v_lshlrev_b32 v28, 16, v51
    v_and_b32 v29, s30, v51
    v_pk_fma_f32 v[22:23], v[22:23], v[18:19], v[20:21] op_sel_hi:[1,0,0]
    v_pk_fma_f32 v[24:25], v[24:25], v[18:19], v[20:21] op_sel_hi:[1,0,0]
    v_pk_fma_f32 v[26:27], v[26:27], v[18:19], v[20:21] op_sel_hi:[1,0,0]
    v_pk_fma_f32 v[28:29], v[28:29], v[18:19], v[20:21] op_sel_hi:[1,0,0]
    v_cvt_pk_bf16_f32 v48, v22, v23
    v_cvt_pk_bf16_f32 v49, v24, v25
    v_cvt_pk_bf16_f32 v50, v26, v27
    v_cvt_pk_bf16_f32 v51, v28, v29
    ds_write_b128 v104, v[48:51] offset:14848
    v_lshlrev_b32 v22, 16, v52
    v_and_b32 v23, s30, v52
    v_lshlrev_b32 v24, 16, v53
    v_and_b32 v25, s30, v53
    v_lshlrev_b32 v26, 16, v54
    v_and_b32 v27, s30, v54
    v_lshlrev_b32 v28, 16, v55
    v_and_b32 v29, s30, v55
    v_pk_fma_f32 v[22:23], v[22:23], v[18:19], v[20:21] op_sel_hi:[1,0,0]
    v_pk_fma_f32 v[24:25], v[24:25], v[18:19], v[20:21] op_sel_hi:[1,0,0]
    v_pk_fma_f32 v[26:27], v[26:27], v[18:19], v[20:21] op_sel_hi:[1,0,0]
    v_pk_fma_f32 v[28:29], v[28:29], v[18:19], v[20:21] op_sel_hi:[1,0,0]
    v_cvt_pk_bf16_f32 v52, v22, v23
    v_cvt_pk_bf16_f32 v53, v24, v25
    v_cvt_pk_bf16_f32 v54, v26, v27
    v_cvt_pk_bf16_f32 v55, v28, v29
    ds_write_b128 v105, v[52:55] offset:14848
    v_lshlrev_b32 v22, 16, v56
    v_and_b32 v23, s30, v56
    v_lshlrev_b32 v24, 16, v57
    v_and_b32 v25, s30, v57
    v_lshlrev_b32 v26, 16, v58
    v_and_b32 v27, s30, v58
    v_lshlrev_b32 v28, 16, v59
    v_and_b32 v29, s30, v59
    v_pk_fma_f32 v[22:23], v[22:23], v[18:19], v[20:21] op_sel_hi:[1,0,0]
    v_pk_fma_f32 v[24:25], v[24:25], v[18:19], v[20:21] op_sel_hi:[1,0,0]
    v_pk_fma_f32 v[26:27], v[26:27], v[18:19], v[20:21] op_sel_hi:[1,0,0]
    v_pk_fma_f32 v[28:29], v[28:29], v[18:19], v[20:21] op_sel_hi:[1,0,0]
    v_cvt_pk_bf16_f32 v56, v22, v23
    v_cvt_pk_bf16_f32 v57, v24, v25
    v_cvt_pk_bf16_f32 v58, v26, v27
    v_cvt_pk_bf16_f32 v59, v28, v29
    ds_write_b128 v106, v[56:59] offset:14848
    v_mov_b32 v16, 0
    v_mov_b32 v17, 0
    s_waitcnt vmcnt(6)
    v_dot2c_f32_bf16 v16, s29, v64
    v_dot2c_f32_bf16 v17, v64, v64
    v_dot2c_f32_bf16 v16, s29, v65
    v_dot2c_f32_bf16 v17, v65, v65
    v_dot2c_f32_bf16 v16, s29, v66
    v_dot2c_f32_bf16 v17, v66, v66
    v_dot2c_f32_bf16 v16, s29, v67
    v_dot2c_f32_bf16 v17, v67, v67
    s_waitcnt vmcnt(5)
    v_dot2c_f32_bf16 v16, s29, v68
    v_dot2c_f32_bf16 v17, v68, v68
    v_dot2c_f32_bf16 v16, s29, v69
    v_dot2c_f32_bf16 v17, v69, v69
    v_dot2c_f32_bf16 v16, s29, v70
    v_dot2c_f32_bf16 v17, v70, v70
    v_dot2c_f32_bf16 v16, s29, v71
    v_dot2c_f32_bf16 v17, v71, v71
    s_waitcnt vmcnt(4)
    v_dot2c_f32_bf16 v16, s29, v72
    v_dot2c_f32_bf16 v17, v72, v72
    v_dot2c_f32_bf16 v16, s29, v73
    v_dot2c_f32_bf16 v17, v73, v73
    v_dot2c_f32_bf16 v16, s29, v74
    v_dot2c_f32_bf16 v17, v74, v74
    v_dot2c_f32_bf16 v16, s29, v75
    v_dot2c_f32_bf16 v17, v75, v75
    s_waitcnt vmcnt(3)
    v_dot2c_f32_bf16 v16, s29, v76
    v_dot2c_f32_bf16 v17, v76, v76
    v_dot2c_f32_bf16 v16, s29, v77
    v_dot2c_f32_bf16 v17, v77, v77
    v_dot2c_f32_bf16 v16, s29, v78
    v_dot2c_f32_bf16 v17, v78, v78
    v_dot2c_f32_bf16 v16, s29, v79
    v_dot2c_f32_bf16 v17, v79, v79
    s_waitcnt vmcnt(2)
    v_dot2c_f32_bf16 v16, s29, v80
    v_dot2c_f32_bf16 v17, v80, v80
    v_dot2c_f32_bf16 v16, s29, v81
    v_dot2c_f32_bf16 v17, v81, v81
    v_dot2c_f32_bf16 v16, s29, v82
    v_dot2c_f32_bf16 v17, v82, v82
    v_dot2c_f32_bf16 v16, s29, v83
    v_dot2c_f32_bf16 v17, v83, v83
    s_waitcnt vmcnt(1)
    v_dot2c_f32_bf16 v16, s29, v84
    v_dot2c_f32_bf16 v17, v84, v84
    v_dot2c_f32_bf16 v16, s29, v85
    v_dot2c_f32_bf16 v17, v85, v85
    v_dot2c_f32_bf16 v16, s29, v86
    v_dot2c_f32_bf16 v17, v86, v86
    v_dot2c_f32_bf16 v16, s29, v87
    v_dot2c_f32_bf16 v17, v87, v87
    s_waitcnt vmcnt(0)
    v_dot2c_f32_bf16 v16, s29, v88
    v_dot2c_f32_bf16 v17, v88, v88
    v_dot2c_f32_bf16 v16, s29, v89
    v_dot2c_f32_bf16 v17, v89, v89
    v_dot2c_f32_bf16 v16, s29, v90
    v_dot2c_f32_bf16 v17, v90, v90
    v_dot2c_f32_bf16 v16, s29, v91
    v_dot2c_f32_bf16 v17, v91, v91
    s_nop 1
    v_add_f32_dpp v16, v16, v16 quad_perm:[1,0,3,2] row_mask:0xf bank_mask:0xf
    v_add_f32_dpp v17, v17, v17 quad_perm:[1,0,3,2] row_mask:0xf bank_mask:0xf
    s_nop 0
    v_add_f32_dpp v16, v16, v16 quad_perm:[2,3,0,1] row_mask:0xf bank_mask:0xf
    v_add_f32_dpp v17, v17, v17 quad_perm:[2,3,0,1] row_mask:0xf bank_mask:0xf
    s_nop 0
    v_add_f32_dpp v16, v16, v16 row_half_mirror row_mask:0xf bank_mask:0xf
    v_add_f32_dpp v17, v17, v17 row_half_mirror row_mask:0xf bank_mask:0xf
    v_mul_f32 v16, 0x3b124925, v16
    v_mul_f32 v17, 0x3b124925, v17
    v_fma_f32 v17, -v16, v16, v17
    v_max_f32 v17, 0, v17
    v_add_f32 v17, 0x3727c5ac, v17
    v_rsq_f32 v18, v17
    s_nop 0
    v_mul_f32 v20, v16, v18
    v_sub_f32 v20, 0, v20
    v_lshlrev_b32 v22, 16, v64
    v_and_b32 v23, s30, v64
    v_lshlrev_b32 v24, 16, v65
    v_and_b32 v25, s30, v65
    v_lshlrev_b32 v26, 16, v66
    v_and_b32 v27, s30, v66
    v_lshlrev_b32 v28, 16, v67
    v_and_b32 v29, s30, v67
    v_pk_fma_f32 v[22:23], v[22:23], v[18:19], v[20:21] op_sel_hi:[1,0,0]
    v_pk_fma_f32 v[24:25], v[24:25], v[18:19], v[20:21] op_sel_hi:[1,0,0]
    v_pk_fma_f32 v[26:27], v[26:27], v[18:19], v[20:21] op_sel_hi:[1,0,0]
    v_pk_fma_f32 v[28:29], v[28:29], v[18:19], v[20:21] op_sel_hi:[1,0,0]
    v_cvt_pk_bf16_f32 v64, v22, v23
    v_cvt_pk_bf16_f32 v65, v24, v25
    v_cvt_pk_bf16_f32 v66, v26, v27
    v_cvt_pk_bf16_f32 v67, v28, v29
    ds_write_b128 v100, v[64:67] offset:0
    v_lshlrev_b32 v22, 16, v68
    v_and_b32 v23, s30, v68
    v_lshlrev_b32 v24, 16, v69
    v_and_b32 v25, s30, v69
    v_lshlrev_b32 v26, 16, v70
    v_and_b32 v27, s30, v70
    v_lshlrev_b32 v28, 16, v71
    v_and_b32 v29, s30, v71
    v_pk_fma_f32 v[22:23], v[22:23], v[18:19], v[20:21] op_sel_hi:[1,0,0]
    v_pk_fma_f32 v[24:25], v[24:25], v[18:19], v[20:21] op_sel_hi:[1,0,0]
    v_pk_fma_f32 v[26:27], v[26:27], v[18:19], v[20:21] op_sel_hi:[1,0,0]
    v_pk_fma_f32 v[28:29], v[28:29], v[18:19], v[20:21] op_sel_hi:[1,0,0]
    v_cvt_pk_bf16_f32 v68, v22, v23
    v_cvt_pk_bf16_f32 v69, v24, v25
    v_cvt_pk_bf16_f32 v70, v26, v27
    v_cvt_pk_bf16_f32 v71, v28, v29
    ds_write_b128 v101, v[68:71] offset:0
    v_lshlrev_b32 v22, 16, v72
    v_and_b32 v23, s30, v72
    v_lshlrev_b32 v24, 16, v73
    v_and_b32 v25, s30, v73
    v_lshlrev_b32 v26, 16, v74
    v_and_b32 v27, s30, v74
    v_lshlrev_b32 v28, 16, v75
    v_and_b32 v29, s30, v75
    v_pk_fma_f32 v[22:23], v[22:23], v[18:19], v[20:21] op_sel_hi:[1,0,0]
    v_pk_fma_f32 v[24:25], v[24:25], v[18:19], v[20:21] op_sel_hi:[1,0,0]
    v_pk_fma_f32 v[26:27], v[26:27], v[18:19], v[20:21] op_sel_hi:[1,0,0]
    v_pk_fma_f32 v[28:29], v[28:29], v[18:19], v[20:21] op_sel_hi:[1,0,0]
    v_cvt_pk_bf16_f32 v72, v22, v23
    v_cvt_pk_bf16_f32 v73, v24, v25
    v_cvt_pk_bf16_f32 v74, v26, v27
    v_cvt_pk_bf16_f32 v75, v28, v29
    ds_write_b128 v102, v[72:75] offset:0
    v_lshlrev_b32 v22, 16, v76
    v_and_b32 v23, s30, v76
    v_lshlrev_b32 v24, 16, v77
    v_and_b32 v25, s30, v77
    v_lshlrev_b32 v26, 16, v78
    v_and_b32 v27, s30, v78
    v_lshlrev_b32 v28, 16, v79
    v_and_b32 v29, s30, v79
    v_pk_fma_f32 v[22:23], v[22:23], v[18:19], v[20:21] op_sel_hi:[1,0,0]
    v_pk_fma_f32 v[24:25], v[24:25], v[18:19], v[20:21] op_sel_hi:[1,0,0]
    v_pk_fma_f32 v[26:27], v[26:27], v[18:19], v[20:21] op_sel_hi:[1,0,0]
    v_pk_fma_f32 v[28:29], v[28:29], v[18:19], v[20:21] op_sel_hi:[1,0,0]
    v_cvt_pk_bf16_f32 v76, v22, v23
    v_cvt_pk_bf16_f32 v77, v24, v25
    v_cvt_pk_bf16_f32 v78, v26, v27
    v_cvt_pk_bf16_f32 v79, v28, v29
    ds_write_b128 v103, v[76:79] offset:0
    v_lshlrev_b32 v22, 16, v80
    v_and_b32 v23, s30, v80
    v_lshlrev_b32 v24, 16, v81
    v_and_b32 v25, s30, v81
    v_lshlrev_b32 v26, 16, v82
    v_and_b32 v27, s30, v82
    v_lshlrev_b32 v28, 16, v83
    v_and_b32 v29, s30, v83
    v_pk_fma_f32 v[22:23], v[22:23], v[18:19], v[20:21] op_sel_hi:[1,0,0]
    v_pk_fma_f32 v[24:25], v[24:25], v[18:19], v[20:21] op_sel_hi:[1,0,0]
    v_pk_fma_f32 v[26:27], v[26:27], v[18:19], v[20:21] op_sel_hi:[1,0,0]
    v_pk_fma_f32 v[28:29], v[28:29], v[18:19], v[20:21] op_sel_hi:[1,0,0]
    v_cvt_pk_bf16_f32 v80, v22, v23
    v_cvt_pk_bf16_f32 v81, v24, v25
    v_cvt_pk_bf16_f32 v82, v26, v27
    v_cvt_pk_bf16_f32 v83, v28, v29
    ds_write_b128 v104, v[80:83] offset:0
    v_lshlrev_b32 v22, 16, v84
    v_and_b32 v23, s30, v84
    v_lshlrev_b32 v24, 16, v85
    v_and_b32 v25, s30, v85
    v_lshlrev_b32 v26, 16, v86
    v_and_b32 v27, s30, v86
    v_lshlrev_b32 v28, 16, v87
    v_and_b32 v29, s30, v87
    v_pk_fma_f32 v[22:23], v[22:23], v[18:19], v[20:21] op_sel_hi:[1,0,0]
    v_pk_fma_f32 v[24:25], v[24:25], v[18:19], v[20:21] op_sel_hi:[1,0,0]
    v_pk_fma_f32 v[26:27], v[26:27], v[18:19], v[20:21] op_sel_hi:[1,0,0]
    v_pk_fma_f32 v[28:29], v[28:29], v[18:19], v[20:21] op_sel_hi:[1,0,0]
    v_cvt_pk_bf16_f32 v84, v22, v23
    v_cvt_pk_bf16_f32 v85, v24, v25
    v_cvt_pk_bf16_f32 v86, v26, v27
    v_cvt_pk_bf16_f32 v87, v28, v29
    ds_write_b128 v105, v[84:87] offset:0
    v_lshlrev_b32 v22, 16, v88
    v_and_b32 v23, s30, v88
    v_lshlrev_b32 v24, 16, v89
    v_and_b32 v25, s30, v89
    v_lshlrev_b32 v26, 16, v90
    v_and_b32 v27, s30, v90
    v_lshlrev_b32 v28, 16, v91
    v_and_b32 v29, s30, v91
    v_pk_fma_f32 v[22:23], v[22:23], v[18:19], v[20:21] op_sel_hi:[1,0,0]
    v_pk_fma_f32 v[24:25], v[24:25], v[18:19], v[20:21] op_sel_hi:[1,0,0]
    v_pk_fma_f32 v[26:27], v[26:27], v[18:19], v[20:21] op_sel_hi:[1,0,0]
    v_pk_fma_f32 v[28:29], v[28:29], v[18:19], v[20:21] op_sel_hi:[1,0,0]
    v_cvt_pk_bf16_f32 v88, v22, v23
    v_cvt_pk_bf16_f32 v89, v24, v25
    v_cvt_pk_bf16_f32 v90, v26, v27
    v_cvt_pk_bf16_f32 v91, v28, v29
    ds_write_b128 v106, v[88:91] offset:0
    s_branch L_stub_K0
.p2align 12
L_nohl:
    v_lshlrev_b32 v22, 16, v32
    v_and_b32 v23, s30, v32
    v_lshlrev_b32 v24, 16, v33
    v_and_b32 v25, s30, v33
    v_lshlrev_b32 v26, 16, v34
    v_and_b32 v27, s30, v34
    v_lshlrev_b32 v28, 16, v35
    v_and_b32 v29, s30, v35
    v_pk_fma_f32 v[22:23], v[22:23], v[18:19], v[20:21] op_sel_hi:[1,0,0]
    v_pk_fma_f32 v[24:25], v[24:25], v[18:19], v[20:21] op_sel_hi:[1,0,0]
    v_pk_fma_f32 v[26:27], v[26:27], v[18:19], v[20:21] op_sel_hi:[1,0,0]
    v_pk_fma_f32 v[28:29], v[28:29], v[18:19], v[20:21] op_sel_hi:[1,0,0]
    v_cvt_pk_bf16_f32 v32, v22, v23
    v_cvt_pk_bf16_f32 v33, v24, v25
    v_cvt_pk_bf16_f32 v34, v26, v27
    v_cvt_pk_bf16_f32 v35, v28, v29
    ds_write_b128 v100, v[32:35] offset:14848
    s_add_u32 m0, s35, 74240
    s_add_u32 s59, s4, 0
    buffer_load_dwordx4 v92, s[40:43], s59 offen offset:0 lds
    v_lshlrev_b32 v22, 16, v36
    v_and_b32 v23, s30, v36
    v_lshlrev_b32 v24, 16, v37
    v_and_b32 v25, s30, v37
    v_lshlrev_b32 v26, 16, v38
    v_and_b32 v27, s30, v38
    v_lshlrev_b32 v28, 16, v39
    v_and_b32 v29, s30, v39
    v_pk_fma_f32 v[22:23], v[22:23], v[18:19], v[20:21] op_sel_hi:[1,0,0]
    v_pk_fma_f32 v[24:25], v[24:25], v[18:19], v[20:21] op_sel_hi:[1,0,0]
    v_pk_fma_f32 v[26:27], v[26:27], v[18:19], v[20:21] op_sel_hi:[1,0,0]
    v_pk_fma_f32 v[28:29], v[28:29], v[18:19], v[20:21] op_sel_hi:[1,0,0]
    v_cvt_pk_bf16_f32 v36, v22, v23
    v_cvt_pk_bf16_f32 v37, v24, v25
    v_cvt_pk_bf16_f32 v38, v26, v27
    v_cvt_pk_bf16_f32 v39, v28, v29
    ds_write_b128 v101, v[36:39] offset:14848
    buffer_load_dwordx4 v93, s[40:43], s59 offen offset:1024 lds
    v_lshlrev_b32 v22, 16, v40
    v_and_b32 v23, s30, v40
    v_lshlrev_b32 v24, 16, v41
    v_and_b32 v25, s30, v41
    v_lshlrev_b32 v26, 16, v42
    v_and_b32 v27, s30, v42
    v_lshlrev_b32 v28, 16, v43
    v_and_b32 v29, s30, v43
    v_pk_fma_f32 v[22:23], v[22:23], v[18:19], v[20:21] op_sel_hi:[1,0,0]
    v_pk_fma_f32 v[24:25], v[24:25], v[18:19], v[20:21] op_sel_hi:[1,0,0]
    v_pk_fma_f32 v[26:27], v[26:27], v[18:19], v[20:21] op_sel_hi:[1,0,0]
    v_pk_fma_f32 v[28:29], v[28:29], v[18:19], v[20:21] op_sel_hi:[1,0,0]
    v_cvt_pk_bf16_f32 v40, v22, v23
    v_cvt_pk_bf16_f32 v41, v24, v25
    v_cvt_pk_bf16_f32 v42, v26, v27
    v_cvt_pk_bf16_f32 v43, v28, v29
    ds_write_b128 v102, v[40:43] offset:14848
    buffer_load_dwordx4 v94, s[40:43], s59 offen offset:2048 lds
    v_lshlrev_b32 v22, 16, v44
    v_and_b32 v23, s30, v44
    v_lshlrev_b32 v24, 16, v45
    v_and_b32 v25, s30, v45
    v_lshlrev_b32 v26, 16, v46
    v_and_b32 v27, s30, v46
    v_lshlrev_b32 v28, 16, v47
    v_and_b32 v29, s30, v47
    v_pk_fma_f32 v[22:23], v[22:23], v[18:19], v[20:21] op_sel_hi:[1,0,0]
    v_pk_fma_f32 v[24:25], v[24:25], v[18:19], v[20:21] op_sel_hi:[1,0,0]
    v_pk_fma_f32 v[26:27], v[26:27], v[18:19], v[20:21] op_sel_hi:[1,0,0]
    v_pk_fma_f32 v[28:29], v[28:29], v[18:19], v[20:21] op_sel_hi:[1,0,0]
    v_cvt_pk_bf16_f32 v44, v22, v23
    v_cvt_pk_bf16_f32 v45, v24, v25
    v_cvt_pk_bf16_f32 v46, v26, v27
    v_cvt_pk_bf16_f32 v47, v28, v29
    ds_write_b128 v103, v[44:47] offset:14848
    buffer_load_dwordx4 v95, s[40:43], s59 offen offset:3072 lds
    v_lshlrev_b32 v22, 16, v48
    v_and_b32 v23, s30, v48
    v_lshlrev_b32 v24, 16, v49
    v_and_b32 v25, s30, v49
    v_lshlrev_b32 v26, 16, v50
    v_and_b32 v27, s30, v50
    v_lshlrev_b32 v28, 16, v51
    v_and_b32 v29, s30, v51
    v_pk_fma_f32 v[22:23], v[22:23], v[18:19], v[20:21] op_sel_hi:[1,0,0]
    v_pk_fma_f32 v[24:25], v[24:25], v[18:19], v[20:21] op_sel_hi:[1,0,0]
    v_pk_fma_f32 v[26:27], v[26:27], v[18:19], v[20:21] op_sel_hi:[1,0,0]
    v_pk_fma_f32 v[28:29], v[28:29], v[18:19], v[20:21] op_sel_hi:[1,0,0]
    v_cvt_pk_bf16_f32 v48, v22, v23
    v_cvt_pk_bf16_f32 v49, v24, v25
    v_cvt_pk_bf16_f32 v50, v26, v27
    v_cvt_pk_bf16_f32 v51, v28, v29
    ds_write_b128 v104, v[48:51] offset:14848
    s_add_u32 m0, s35, 82432
    s_add_u32 s59, s4, 896
    buffer_load_dwordx4 v92, s[40:43], s59 offen offset:0 lds
    v_lshlrev_b32 v22, 16, v52
    v_and_b32 v23, s30, v52
    v_lshlrev_b32 v24, 16, v53
    v_and_b32 v25, s30, v53
    v_lshlrev_b32 v26, 16, v54
    v_and_b32 v27, s30, v54
    v_lshlrev_b32 v28, 16, v55
    v_and_b32 v29, s30, v55
    v_pk_fma_f32 v[22:23], v[22:23], v[18:19], v[20:21] op_sel_hi:[1,0,0]
    v_pk_fma_f32 v[24:25], v[24:25], v[18:19], v[20:21] op_sel_hi:[1,0,0]
    v_pk_fma_f32 v[26:27], v[26:27], v[18:19], v[20:21] op_sel_hi:[1,0,0]
    v_pk_fma_f32 v[28:29], v[28:29], v[18:19], v[20:21] op_sel_hi:[1,0,0]
    v_cvt_pk_bf16_f32 v52, v22, v23
    v_cvt_pk_bf16_f32 v53, v24, v25
    v_cvt_pk_bf16_f32 v54, v26, v27
    v_cvt_pk_bf16_f32 v55, v28, v29
    ds_write_b128 v105, v[52:55] offset:14848
    buffer_load_dwordx4 v93, s[40:43], s59 offen offset:1024 lds
    v_lshlrev_b32 v22, 16, v56
    v_and_b32 v23, s30, v56
    v_lshlrev_b32 v24, 16, v57
    v_and_b32 v25, s30, v57
    v_lshlrev_b32 v26, 16, v58
    v_and_b32 v27, s30, v58
    v_lshlrev_b32 v28, 16, v59
    v_and_b32 v29, s30, v59
    v_pk_fma_f32 v[22:23], v[22:23], v[18:19], v[20:21] op_sel_hi:[1,0,0]
    v_pk_fma_f32 v[24:25], v[24:25], v[18:19], v[20:21] op_sel_hi:[1,0,0]
    v_pk_fma_f32 v[26:27], v[26:27], v[18:19], v[20:21] op_sel_hi:[1,0,0]
    v_pk_fma_f32 v[28:29], v[28:29], v[18:19], v[20:21] op_sel_hi:[1,0,0]
    v_cvt_pk_bf16_f32 v56, v22, v23
    v_cvt_pk_bf16_f32 v57, v24, v25
    v_cvt_pk_bf16_f32 v58, v26, v27
    v_cvt_pk_bf16_f32 v59, v28, v29
    ds_write_b128 v106, v[56:59] offset:14848
    buffer_load_dwordx4 v94, s[40:43], s59 offen offset:2048 lds
    buffer_load_dwordx4 v95, s[40:43], s59 offen offset:3072 lds
    s_add_u32 m0, s35, 90624
    s_add_u32 s59, s4, 1792
    buffer_load_dwordx4 v92, s[40:43], s59 offen offset:0 lds
    buffer_load_dwordx4 v93, s[40:43], s59 offen offset:1024 lds
    buffer_load_dwordx4 v94, s[40:43], s59 offen offset:2048 lds
    buffer_load_dwordx4 v95, s[40:43], s59 offen offset:3072 lds
    s_add_u32 m0, s35, 98816
    s_add_u32 s59, s4, 86016
    buffer_load_dwordx4 v92, s[40:43], s59 offen offset:0 lds
    buffer_load_dwordx4 v93, s[40:43], s59 offen offset:1024 lds
    buffer_load_dwordx4 v94, s[40:43], s59 offen offset:2048 lds
    buffer_load_dwordx4 v95, s[40:43], s59 offen offset:3072 lds
    s_add_u32 m0, s35, 107008
    s_add_u32 s59, s4, 86912
    buffer_load_dwordx4 v92, s[40:43], s59 offen offset:0 lds
    buffer_load_dwordx4 v93, s[40:43], s59 offen offset:1024 lds
    buffer_load_dwordx4 v94, s[40:43], s59 offen offset:2048 lds
    buffer_load_dwordx4 v95, s[40:43], s59 offen offset:3072 lds
    s_add_u32 m0, s35, 115200
    s_add_u32 s59, s4, 87808
    buffer_load_dwordx4 v92, s[40:43], s59 offen offset:0 lds
    buffer_load_dwordx4 v93, s[40:43], s59 offen offset:1024 lds
    buffer_load_dwordx4 v94, s[40:43], s59 offen offset:2048 lds
    buffer_load_dwordx4 v95, s[40:43], s59 offen offset:3072 lds
L_nohalo:
    s_waitcnt lgkmcnt(0)
    s_waitcnt vmcnt(12)
    s_barrier
    ds_read_b128 v[28:31], v9 offset:0
    ds_read_b128 v[32:35], v9 offset:14848
    ds_read_b128 v[36:39], v9 offset:29696
    ds_read_b128 v[40:43], v9 offset:44544
    ds_read_b128 v[44:47], v9 offset:59392
    ds_read_b64_tr_b16 v[76:77], v10 offset:8192
    ds_read_b64_tr_b16 v[78:79], v10 offset:9216
    ds_read_b64_tr_b16 v[80:81], v12 offset:8192
    ds_read_b64_tr_b16 v[82:83], v12 offset:9216
    ds_read_b64_tr_b16 v[68:69], v10 offset:0
    ds_read_b64_tr_b16 v[70:71], v10 offset:1024
    ds_read_b64_tr_b16 v[72:73], v12 offset:0
    ds_read_b64_tr_b16 v[74:75], v12 offset:1024
    ds_read_b64_tr_b16 v[84:85], v10 offset:16384
    ds_read_b64_tr_b16 v[86:87], v10 offset:17408
    ds_read_b64_tr_b16 v[88:89], v12 offset:16384
    ds_read_b64_tr_b16 v[90:91], v12 offset:17408
    s_waitcnt lgkmcnt(0)
    s_waitcnt vmcnt(0)
    s_barrier
    v_mfma_f32_16x16x32_bf16 v[148:151], v[76:79], v[28:31], 0
    ds_read_b128 v[48:51], v9 offset:64
    v_mfma_f32_16x16x32_bf16 v[168:171], v[80:83], v[28:31], 0
    ds_read_b128 v[52:55], v9 offset:14912
    v_mfma_f32_16x16x32_bf16 v[152:155], v[76:79], v[32:35], 0
    ds_read_b128 v[56:59], v9 offset:29760
    v_mfma_f32_16x16x32_bf16 v[172:175], v[80:83], v[32:35], 0
    v_mfma_f32_16x16x32_bf16 v[156:159], v[76:79], v[36:39], 0
    ds_read_b128 v[60:63], v9 offset:44608
    v_mfma_f32_16x16x32_bf16 v[176:179], v[80:83], v[36:39], 0
    ds_read_b128 v[64:67], v9 offset:59456
    v_mfma_f32_16x16x32_bf16 v[160:163], v[76:79], v[40:43], 0
    ds_read_b64_tr_b16 v[100:101], v10 offset:32768
    v_mfma_f32_16x16x32_bf16 v[180:183], v[80:83], v[40:43], 0
    ds_read_b64_tr_b16 v[102:103], v10 offset:33792
    v_mfma_f32_16x16x32_bf16 v[164:167], v[76:79], v[44:47], 0
    v_mfma_f32_16x16x32_bf16 v[184:187], v[80:83], v[44:47], 0
    ds_read_b64_tr_b16 v[104:105], v12 offset:32768
    v_mfma_f32_16x16x32_bf16 v[116:119], v[68:71], v[32:35], 0
    ds_read_b64_tr_b16 v[106:107], v12 offset:33792
    v_mfma_f32_16x16x32_bf16 v[132:135], v[72:75], v[32:35], 0
    ds_read_b64_tr_b16 v[92:93], v10 offset:24576
    v_mfma_f32_16x16x32_bf16 v[120:123], v[68:71], v[36:39], 0
    v_mfma_f32_16x16x32_bf16 v[136:139], v[72:75], v[36:39], 0
    ds_read_b64_tr_b16 v[94:95], v10 offset:25600
    v_mfma_f32_16x16x32_bf16 v[124:127], v[68:71], v[40:43], 0
    ds_read_b64_tr_b16 v[96:97], v12 offset:24576
    v_mfma_f32_16x16x32_bf16 v[140:143], v[72:75], v[40:43], 0
    ds_read_b64_tr_b16 v[98:99], v12 offset:25600
    v_mfma_f32_16x16x32_bf16 v[128:131], v[68:71], v[44:47], 0
    ds_read_b64_tr_b16 v[108:109], v11 offset:0
    v_mfma_f32_16x16x32_bf16 v[144:147], v[72:75], v[44:47], 0
    v_mfma_f32_16x16x32_bf16 v[188:191], v[28:31], v[84:87], 0
    ds_read_b64_tr_b16 v[110:111], v11 offset:1024
    v_mfma_f32_16x16x32_bf16 v[208:211], v[28:31], v[88:91], 0
    ds_read_b64_tr_b16 v[112:113], v13 offset:0
    v_mfma_f32_16x16x32_bf16 v[192:195], v[32:35], v[84:87], 0
    ds_read_b64_tr_b16 v[114:115], v13 offset:1024
    v_mfma_f32_16x16x32_bf16 v[212:215], v[32:35], v[88:91], 0
    v_mfma_f32_16x16x32_bf16 v[196:199], v[36:39], v[84:87], 0
    v_mfma_f32_16x16x32_bf16 v[216:219], v[36:39], v[88:91], 0
    v_mfma_f32_16x16x32_bf16 v[200:203], v[40:43], v[84:87], 0
    v_mfma_f32_16x16x32_bf16 v[220:223], v[40:43], v[88:91], 0
    v_mfma_f32_16x16x32_bf16 v[204:207], v[44:47], v[84:87], 0
    v_mfma_f32_16x16x32_bf16 v[224:227], v[44:47], v[88:91], 0
    s_waitcnt lgkmcnt(0)
    s_barrier
    v_mfma_f32_16x16x32_bf16 v[148:151], v[100:103], v[48:51], v[148:151]
    ds_read_b128 v[28:31], v9 offset:128
    v_mfma_f32_16x16x32_bf16 v[168:171], v[104:107], v[48:51], v[168:171]
    ds_read_b128 v[32:35], v9 offset:14976
    v_mfma_f32_16x16x32_bf16 v[152:155], v[100:103], v[52:55], v[152:155]
    ds_read_b128 v[36:39], v9 offset:29824
    v_mfma_f32_16x16x32_bf16 v[172:175], v[104:107], v[52:55], v[172:175]
    v_mfma_f32_16x16x32_bf16 v[156:159], v[100:103], v[56:59], v[156:159]
    ds_read_b128 v[40:43], v9 offset:44672
    v_mfma_f32_16x16x32_bf16 v[176:179], v[104:107], v[56:59], v[176:179]
    ds_read_b128 v[44:47], v9 offset:59520
    v_mfma_f32_16x16x32_bf16 v[160:163], v[100:103], v[60:63], v[160:163]
    ds_read_b64_tr_b16 v[76:77], v11 offset:16384
    v_mfma_f32_16x16x32_bf16 v[180:183], v[104:107], v[60:63], v[180:183]
    ds_read_b64_tr_b16 v[78:79], v11 offset:17408
    v_mfma_f32_16x16x32_bf16 v[164:167], v[100:103], v[64:67], v[164:167]
    v_mfma_f32_16x16x32_bf16 v[184:187], v[104:107], v[64:67], v[184:187]
    ds_read_b64_tr_b16 v[80:81], v13 offset:16384
    v_mfma_f32_16x16x32_bf16 v[116:119], v[92:95], v[52:55], v[116:119]
    ds_read_b64_tr_b16 v[82:83], v13 offset:17408
    v_mfma_f32_16x16x32_bf16 v[132:135], v[96:99], v[52:55], v[132:135]
    ds_read_b64_tr_b16 v[68:69], v11 offset:8192
    v_mfma_f32_16x16x32_bf16 v[120:123], v[92:95], v[56:59], v[120:123]
    v_mfma_f32_16x16x32_bf16 v[136:139], v[96:99], v[56:59], v[136:139]
    ds_read_b64_tr_b16 v[70:71], v11 offset:9216
    v_mfma_f32_16x16x32_bf16 v[124:127], v[92:95], v[60:63], v[124:127]
    ds_read_b64_tr_b16 v[72:73], v13 offset:8192
    v_mfma_f32_16x16x32_bf16 v[140:143], v[96:99], v[60:63], v[140:143]
    ds_read_b64_tr_b16 v[74:75], v13 offset:9216
    v_mfma_f32_16x16x32_bf16 v[128:131], v[92:95], v[64:67], v[128:131]
    ds_read_b64_tr_b16 v[84:85], v11 offset:24576
    v_mfma_f32_16x16x32_bf16 v[144:147], v[96:99], v[64:67], v[144:147]
    v_mfma_f32_16x16x32_bf16 v[188:191], v[48:51], v[108:111], v[188:191]
    ds_read_b64_tr_b16 v[86:87], v11 offset:25600
    v_mfma_f32_16x16x32_bf16 v[208:211], v[48:51], v[112:115], v[208:211]
    ds_read_b64_tr_b16 v[88:89], v13 offset:24576
    v_mfma_f32_16x16x32_bf16 v[192:195], v[52:55], v[108:111], v[192:195]
    ds_read_b64_tr_b16 v[90:91], v13 offset:25600
    v_mfma_f32_16x16x32_bf16 v[212:215], v[52:55], v[112:115], v[212:215]
    v_mfma_f32_16x16x32_bf16 v[196:199], v[56:59], v[108:111], v[196:199]
    v_mfma_f32_16x16x32_bf16 v[216:219], v[56:59], v[112:115], v[216:219]
    v_mfma_f32_16x16x32_bf16 v[200:203], v[60:63], v[108:111], v[200:203]
    v_mfma_f32_16x16x32_bf16 v[220:223], v[60:63], v[112:115], v[220:223]
    v_mfma_f32_16x16x32_bf16 v[204:207], v[64:67], v[108:111], v[204:207]
    v_mfma_f32_16x16x32_bf16 v[224:227], v[64:67], v[112:115], v[224:227]
    s_waitcnt lgkmcnt(0)
    s_barrier
    v_mfma_f32_16x16x32_bf16 v[148:151], v[76:79], v[28:31], v[148:151]
    ds_read_b128 v[48:51], v9 offset:192
    v_mfma_f32_16x16x32_bf16 v[168:171], v[80:83], v[28:31], v[168:171]
    ds_read_b128 v[52:55], v9 offset:15040
    v_mfma_f32_16x16x32_bf16 v[152:155], v[76:79], v[32:35], v[152:155]
    ds_read_b128 v[56:59], v9 offset:29888
    v_mfma_f32_16x16x32_bf16 v[172:175], v[80:83], v[32:35], v[172:175]
    v_mfma_f32_16x16x32_bf16 v[156:159], v[76:79], v[36:39], v[156:159]
    ds_read_b128 v[60:63], v9 offset:44736
    v_mfma_f32_16x16x32_bf16 v[176:179], v[80:83], v[36:39], v[176:179]
    ds_read_b128 v[64:67], v9 offset:59584
    v_mfma_f32_16x16x32_bf16 v[160:163], v[76:79], v[40:43], v[160:163]
    ds_read_b64_tr_b16 v[100:101], v10 offset:0
    v_mfma_f32_16x16x32_bf16 v[180:183], v[80:83], v[40:43], v[180:183]
    ds_read_b64_tr_b16 v[102:103], v10 offset:1024
    v_mfma_f32_16x16x32_bf16 v[164:167], v[76:79], v[44:47], v[164:167]
    v_mfma_f32_16x16x32_bf16 v[184:187], v[80:83], v[44:47], v[184:187]
    ds_read_b64_tr_b16 v[104:105], v12 offset:0
    v_mfma_f32_16x16x32_bf16 v[116:119], v[68:71], v[32:35], v[116:119]
    ds_read_b64_tr_b16 v[106:107], v12 offset:1024
    v_mfma_f32_16x16x32_bf16 v[132:135], v[72:75], v[32:35], v[132:135]
    ds_read_b64_tr_b16 v[92:93], v11 offset:32768
    v_mfma_f32_16x16x32_bf16 v[120:123], v[68:71], v[36:39], v[120:123]
    v_mfma_f32_16x16x32_bf16 v[136:139], v[72:75], v[36:39], v[136:139]
    ds_read_b64_tr_b16 v[94:95], v11 offset:33792
    v_mfma_f32_16x16x32_bf16 v[124:127], v[68:71], v[40:43], v[124:127]
    ds_read_b64_tr_b16 v[96:97], v13 offset:32768
    v_mfma_f32_16x16x32_bf16 v[140:143], v[72:75], v[40:43], v[140:143]
    ds_read_b64_tr_b16 v[98:99], v13 offset:33792
    v_mfma_f32_16x16x32_bf16 v[128:131], v[68:71], v[44:47], v[128:131]
    ds_read_b64_tr_b16 v[108:109], v10 offset:8192
    v_mfma_f32_16x16x32_bf16 v[144:147], v[72:75], v[44:47], v[144:147]
    v_mfma_f32_16x16x32_bf16 v[188:191], v[28:31], v[84:87], v[188:191]
    ds_read_b64_tr_b16 v[110:111], v10 offset:9216
    v_mfma_f32_16x16x32_bf16 v[208:211], v[28:31], v[88:91], v[208:211]
    ds_read_b64_tr_b16 v[112:113], v12 offset:8192
    v_mfma_f32_16x16x32_bf16 v[192:195], v[32:35], v[84:87], v[192:195]
    ds_read_b64_tr_b16 v[114:115], v12 offset:9216
    v_mfma_f32_16x16x32_bf16 v[212:215], v[32:35], v[88:91], v[212:215]
    v_mfma_f32_16x16x32_bf16 v[196:199], v[36:39], v[84:87], v[196:199]
    v_mfma_f32_16x16x32_bf16 v[216:219], v[36:39], v[88:91], v[216:219]
    v_mfma_f32_16x16x32_bf16 v[200:203], v[40:43], v[84:87], v[200:203]
    v_mfma_f32_16x16x32_bf16 v[220:223], v[40:43], v[88:91], v[220:223]
    v_mfma_f32_16x16x32_bf16 v[204:207], v[44:47], v[84:87], v[204:207]
    v_mfma_f32_16x16x32_bf16 v[224:227], v[44:47], v[88:91], v[224:227]
    s_waitcnt lgkmcnt(0)
    s_barrier
    v_mfma_f32_16x16x32_bf16 v[148:151], v[100:103], v[48:51], v[148:151]
    ds_read_b128 v[28:31], v9 offset:256
    v_mfma_f32_16x16x32_bf16 v[168:171], v[104:107], v[48:51], v[168:171]
    ds_read_b128 v[32:35], v9 offset:15104
    v_mfma_f32_16x16x32_bf16 v[152:155], v[100:103], v[52:55], v[152:155]
    ds_read_b128 v[36:39], v9 offset:29952
    v_mfma_f32_16x16x32_bf16 v[172:175], v[104:107], v[52:55], v[172:175]
    v_mfma_f32_16x16x32_bf16 v[156:159], v[100:103], v[56:59], v[156:159]
    ds_read_b128 v[40:43], v9 offset:44800
    v_mfma_f32_16x16x32_bf16 v[176:179], v[104:107], v[56:59], v[176:179]
    ds_read_b128 v[44:47], v9 offset:59648
    v_mfma_f32_16x16x32_bf16 v[160:163], v[100:103], v[60:63], v[160:163]
    ds_read_b64_tr_b16 v[76:77], v10 offset:24576
    v_mfma_f32_16x16x32_bf16 v[180:183], v[104:107], v[60:63], v[180:183]
    ds_read_b64_tr_b16 v[78:79], v10 offset:25600
    v_mfma_f32_16x16x32_bf16 v[164:167], v[100:103], v[64:67], v[164:167]
    v_mfma_f32_16x16x32_bf16 v[184:187], v[104:107], v[64:67], v[184:187]
    ds_read_b64_tr_b16 v[80:81], v12 offset:24576
    v_mfma_f32_16x16x32_bf16 v[116:119], v[92:95], v[52:55], v[116:119]
    ds_read_b64_tr_b16 v[82:83], v12 offset:25600
    v_mfma_f32_16x16x32_bf16 v[132:135], v[96:99], v[52:55], v[132:135]
    ds_read_b64_tr_b16 v[68:69], v10 offset:16384
    v_mfma_f32_16x16x32_bf16 v[120:123], v[92:95], v[56:59], v[120:123]
    v_mfma_f32_16x16x32_bf16 v[136:139], v[96:99], v[56:59], v[136:139]
    ds_read_b64_tr_b16 v[70:71], v10 offset:17408
    v_mfma_f32_16x16x32_bf16 v[124:127], v[92:95], v[60:63], v[124:127]
    ds_read_b64_tr_b16 v[72:73], v12 offset:16384
    v_mfma_f32_16x16x32_bf16 v[140:143], v[96:99], v[60:63], v[140:143]
    ds_read_b64_tr_b16 v[74:75], v12 offset:17408
    v_mfma_f32_16x16x32_bf16 v[128:131], v[92:95], v[64:67], v[128:131]
    ds_read_b64_tr_b16 v[84:85], v10 offset:32768
    v_mfma_f32_16x16x32_bf16 v[144:147], v[96:99], v[64:67], v[144:147]
    v_mfma_f32_16x16x32_bf16 v[188:191], v[48:51], v[108:111], v[188:191]
    ds_read_b64_tr_b16 v[86:87], v10 offset:33792
    v_mfma_f32_16x16x32_bf16 v[208:211], v[48:51], v[112:115], v[208:211]
    ds_read_b64_tr_b16 v[88:89], v12 offset:32768
    v_mfma_f32_16x16x32_bf16 v[192:195], v[52:55], v[108:111], v[192:195]
    ds_read_b64_tr_b16 v[90:91], v12 offset:33792
    v_mfma_f32_16x16x32_bf16 v[212:215], v[52:55], v[112:115], v[212:215]
    v_mfma_f32_16x16x32_bf16 v[196:199], v[56:59], v[108:111], v[196:199]
    v_mfma_f32_16x16x32_bf16 v[216:219], v[56:59], v[112:115], v[216:219]
    v_mfma_f32_16x16x32_bf16 v[200:203], v[60:63], v[108:111], v[200:203]
    v_mfma_f32_16x16x32_bf16 v[220:223], v[60:63], v[112:115], v[220:223]
    v_mfma_f32_16x16x32_bf16 v[204:207], v[64:67], v[108:111], v[204:207]
    v_mfma_f32_16x16x32_bf16 v[224:227], v[64:67], v[112:115], v[224:227]
    s_waitcnt lgkmcnt(0)
    s_barrier
    v_mfma_f32_16x16x32_bf16 v[148:151], v[76:79], v[28:31], v[148:151]
    ds_read_b128 v[48:51], v9 offset:320
    v_mfma_f32_16x16x32_bf16 v[168:171], v[80:83], v[28:31], v[168:171]
    ds_read_b128 v[52:55], v9 offset:15168
    v_mfma_f32_16x16x32_bf16 v[152:155], v[76:79], v[32:35], v[152:155]
    ds_read_b128 v[56:59], v9 offset:30016
    v_mfma_f32_16x16x32_bf16 v[172:175], v[80:83], v[32:35], v[172:175]
    v_mfma_f32_16x16x32_bf16 v[156:159], v[76:79], v[36:39], v[156:159]
    ds_read_b128 v[60:63], v9 offset:44864
    v_mfma_f32_16x16x32_bf16 v[176:179], v[80:83], v[36:39], v[176:179]
    ds_read_b128 v[64:67], v9 offset:59712
    v_mfma_f32_16x16x32_bf16 v[160:163], v[76:79], v[40:43], v[160:163]
    ds_read_b64_tr_b16 v[100:101], v11 offset:8192
    v_mfma_f32_16x16x32_bf16 v[180:183], v[80:83], v[40:43], v[180:183]
    ds_read_b64_tr_b16 v[102:103], v11 offset:9216
    v_mfma_f32_16x16x32_bf16 v[164:167], v[76:79], v[44:47], v[164:167]
    v_mfma_f32_16x16x32_bf16 v[184:187], v[80:83], v[44:47], v[184:187]
    ds_read_b64_tr_b16 v[104:105], v13 offset:8192
    v_mfma_f32_16x16x32_bf16 v[116:119], v[68:71], v[32:35], v[116:119]
    ds_read_b64_tr_b16 v[106:107], v13 offset:9216
    v_mfma_f32_16x16x32_bf16 v[132:135], v[72:75], v[32:35], v[132:135]
    ds_read_b64_tr_b16 v[92:93], v11 offset:0
    v_mfma_f32_16x16x32_bf16 v[120:123], v[68:71], v[36:39], v[120:123]
    v_mfma_f32_16x16x32_bf16 v[136:139], v[72:75], v[36:39], v[136:139]
    ds_read_b64_tr_b16 v[94:95], v11 offset:1024
    v_mfma_f32_16x16x32_bf16 v[124:127], v[68:71], v[40:43], v[124:127]
    ds_read_b64_tr_b16 v[96:97], v13 offset:0
    v_mfma_f32_16x16x32_bf16 v[140:143], v[72:75], v[40:43], v[140:143]
    ds_read_b64_tr_b16 v[98:99], v13 offset:1024
    v_mfma_f32_16x16x32_bf16 v[128:131], v[68:71], v[44:47], v[128:131]
    ds_read_b64_tr_b16 v[108:109], v11 offset:16384
    v_mfma_f32_16x16x32_bf16 v[144:147], v[72:75], v[44:47], v[144:147]
    v_mfma_f32_16x16x32_bf16 v[188:191], v[28:31], v[84:87], v[188:191]
    ds_read_b64_tr_b16 v[110:111], v11 offset:17408
    v_mfma_f32_16x16x32_bf16 v[208:211], v[28:31], v[88:91], v[208:211]
    ds_read_b64_tr_b16 v[112:113], v13 offset:16384
    v_mfma_f32_16x16x32_bf16 v[192:195], v[32:35], v[84:87], v[192:195]
    ds_read_b64_tr_b16 v[114:115], v13 offset:17408
    v_mfma_f32_16x16x32_bf16 v[212:215], v[32:35], v[88:91], v[212:215]
    v_mfma_f32_16x16x32_bf16 v[196:199], v[36:39], v[84:87], v[196:199]
    v_mfma_f32_16x16x32_bf16 v[216:219], v[36:39], v[88:91], v[216:219]
    v_mfma_f32_16x16x32_bf16 v[200:203], v[40:43], v[84:87], v[200:203]
    v_mfma_f32_16x16x32_bf16 v[220:223], v[40:43], v[88:91], v[220:223]
    v_mfma_f32_16x16x32_bf16 v[204:207], v[44:47], v[84:87], v[204:207]
    v_mfma_f32_16x16x32_bf16 v[224:227], v[44:47], v[88:91], v[224:227]
    s_waitcnt lgkmcnt(0)
    s_barrier
    v_mfma_f32_16x16x32_bf16 v[148:151], v[100:103], v[48:51], v[148:151]
    ds_read_b128 v[28:31], v9 offset:384
    v_mfma_f32_16x16x32_bf16 v[168:171], v[104:107], v[48:51], v[168:171]
    ds_read_b128 v[32:35], v9 offset:15232
    v_mfma_f32_16x16x32_bf16 v[152:155], v[100:103], v[52:55], v[152:155]
    ds_read_b128 v[36:39], v9 offset:30080
    v_mfma_f32_16x16x32_bf16 v[172:175], v[104:107], v[52:55], v[172:175]
    v_mfma_f32_16x16x32_bf16 v[156:159], v[100:103], v[56:59], v[156:159]
    ds_read_b128 v[40:43], v9 offset:44928
    v_mfma_f32_16x16x32_bf16 v[176:179], v[104:107], v[56:59], v[176:179]
    ds_read_b128 v[44:47], v9 offset:59776
    v_mfma_f32_16x16x32_bf16 v[160:163], v[100:103], v[60:63], v[160:163]
    ds_read_b64_tr_b16 v[76:77], v11 offset:32768
    v_mfma_f32_16x16x32_bf16 v[180:183], v[104:107], v[60:63], v[180:183]
    ds_read_b64_tr_b16 v[78:79], v11 offset:33792
    v_mfma_f32_16x16x32_bf16 v[164:167], v[100:103], v[64:67], v[164:167]
    v_mfma_f32_16x16x32_bf16 v[184:187], v[104:107], v[64:67], v[184:187]
    ds_read_b64_tr_b16 v[80:81], v13 offset:32768
    v_mfma_f32_16x16x32_bf16 v[116:119], v[92:95], v[52:55], v[116:119]
    ds_read_b64_tr_b16 v[82:83], v13 offset:33792
    v_mfma_f32_16x16x32_bf16 v[132:135], v[96:99], v[52:55], v[132:135]
    ds_read_b64_tr_b16 v[68:69], v11 offset:24576
    v_mfma_f32_16x16x32_bf16 v[120:123], v[92:95], v[56:59], v[120:123]
    v_mfma_f32_16x16x32_bf16 v[136:139], v[96:99], v[56:59], v[136:139]
    ds_read_b64_tr_b16 v[70:71], v11 offset:25600
    v_mfma_f32_16x16x32_bf16 v[124:127], v[92:95], v[60:63], v[124:127]
    ds_read_b64_tr_b16 v[72:73], v13 offset:24576
    v_mfma_f32_16x16x32_bf16 v[140:143], v[96:99], v[60:63], v[140:143]
    ds_read_b64_tr_b16 v[74:75], v13 offset:25600
    v_mfma_f32_16x16x32_bf16 v[128:131], v[92:95], v[64:67], v[128:131]
    ds_read_b64_tr_b16 v[84:85], v10 offset:0
    v_mfma_f32_16x16x32_bf16 v[144:147], v[96:99], v[64:67], v[144:147]
    v_mfma_f32_16x16x32_bf16 v[188:191], v[48:51], v[108:111], v[188:191]
    ds_read_b64_tr_b16 v[86:87], v10 offset:1024
    v_mfma_f32_16x16x32_bf16 v[208:211], v[48:51], v[112:115], v[208:211]
    ds_read_b64_tr_b16 v[88:89], v12 offset:0
    v_mfma_f32_16x16x32_bf16 v[192:195], v[52:55], v[108:111], v[192:195]
    ds_read_b64_tr_b16 v[90:91], v12 offset:1024
    v_mfma_f32_16x16x32_bf16 v[212:215], v[52:55], v[112:115], v[212:215]
    v_mfma_f32_16x16x32_bf16 v[196:199], v[56:59], v[108:111], v[196:199]
    v_mfma_f32_16x16x32_bf16 v[216:219], v[56:59], v[112:115], v[216:219]
    v_mfma_f32_16x16x32_bf16 v[200:203], v[60:63], v[108:111], v[200:203]
    v_mfma_f32_16x16x32_bf16 v[220:223], v[60:63], v[112:115], v[220:223]
    v_mfma_f32_16x16x32_bf16 v[204:207], v[64:67], v[108:111], v[204:207]
    v_mfma_f32_16x16x32_bf16 v[224:227], v[64:67], v[112:115], v[224:227]
    s_waitcnt lgkmcnt(0)
    s_barrier
    v_mfma_f32_16x16x32_bf16 v[148:151], v[76:79], v[28:31], v[148:151]
    ds_read_b128 v[48:51], v9 offset:448
    v_mfma_f32_16x16x32_bf16 v[168:171], v[80:83], v[28:31], v[168:171]
    ds_read_b128 v[52:55], v9 offset:15296
    v_mfma_f32_16x16x32_bf16 v[152:155], v[76:79], v[32:35], v[152:155]
    ds_read_b128 v[56:59], v9 offset:30144
    v_mfma_f32_16x16x32_bf16 v[172:175], v[80:83], v[32:35], v[172:175]
    v_mfma_f32_16x16x32_bf16 v[156:159], v[76:79], v[36:39], v[156:159]
    ds_read_b128 v[60:63], v9 offset:44992
    v_mfma_f32_16x16x32_bf16 v[176:179], v[80:83], v[36:39], v[176:179]
    ds_read_b128 v[64:67], v9 offset:59840
    v_mfma_f32_16x16x32_bf16 v[160:163], v[76:79], v[40:43], v[160:163]
    ds_read_b64_tr_b16 v[100:101], v10 offset:16384
    v_mfma_f32_16x16x32_bf16 v[180:183], v[80:83], v[40:43], v[180:183]
    ds_read_b64_tr_b16 v[102:103], v10 offset:17408
    v_mfma_f32_16x16x32_bf16 v[164:167], v[76:79], v[44:47], v[164:167]
    v_mfma_f32_16x16x32_bf16 v[184:187], v[80:83], v[44:47], v[184:187]
    ds_read_b64_tr_b16 v[104:105], v12 offset:16384
    v_mfma_f32_16x16x32_bf16 v[116:119], v[68:71], v[32:35], v[116:119]
    ds_read_b64_tr_b16 v[106:107], v12 offset:17408
    v_mfma_f32_16x16x32_bf16 v[132:135], v[72:75], v[32:35], v[132:135]
    ds_read_b64_tr_b16 v[92:93], v10 offset:8192
    v_mfma_f32_16x16x32_bf16 v[120:123], v[68:71], v[36:39], v[120:123]
    v_mfma_f32_16x16x32_bf16 v[136:139], v[72:75], v[36:39], v[136:139]
    ds_read_b64_tr_b16 v[94:95], v10 offset:9216
    v_mfma_f32_16x16x32_bf16 v[124:127], v[68:71], v[40:43], v[124:127]
    ds_read_b64_tr_b16 v[96:97], v12 offset:8192
    v_mfma_f32_16x16x32_bf16 v[140:143], v[72:75], v[40:43], v[140:143]
    ds_read_b64_tr_b16 v[98:99], v12 offset:9216
    v_mfma_f32_16x16x32_bf16 v[128:131], v[68:71], v[44:47], v[128:131]
    ds_read_b64_tr_b16 v[108:109], v10 offset:24576
    v_mfma_f32_16x16x32_bf16 v[144:147], v[72:75], v[44:47], v[144:147]
    v_mfma_f32_16x16x32_bf16 v[188:191], v[28:31], v[84:87], v[188:191]
    ds_read_b64_tr_b16 v[110:111], v10 offset:25600
    v_mfma_f32_16x16x32_bf16 v[208:211], v[28:31], v[88:91], v[208:211]
    ds_read_b64_tr_b16 v[112:113], v12 offset:24576
    v_mfma_f32_16x16x32_bf16 v[192:195], v[32:35], v[84:87], v[192:195]
    ds_read_b64_tr_b16 v[114:115], v12 offset:25600
    v_mfma_f32_16x16x32_bf16 v[212:215], v[32:35], v[88:91], v[212:215]
    v_mfma_f32_16x16x32_bf16 v[196:199], v[36:39], v[84:87], v[196:199]
    v_mfma_f32_16x16x32_bf16 v[216:219], v[36:39], v[88:91], v[216:219]
    v_mfma_f32_16x16x32_bf16 v[200:203], v[40:43], v[84:87], v[200:203]
    v_mfma_f32_16x16x32_bf16 v[220:223], v[40:43], v[88:91], v[220:223]
    v_mfma_f32_16x16x32_bf16 v[204:207], v[44:47], v[84:87], v[204:207]
    v_mfma_f32_16x16x32_bf16 v[224:227], v[44:47], v[88:91], v[224:227]
    s_branch L_page9
.p2align 12
L_stub_K0:
    s_branch L_nohalo
    s_nop 0
L_page9:
    s_waitcnt lgkmcnt(0)
    s_barrier
    v_mfma_f32_16x16x32_bf16 v[148:151], v[100:103], v[48:51], v[148:151]
    ds_read_b128 v[28:31], v9 offset:512
    v_mfma_f32_16x16x32_bf16 v[168:171], v[104:107], v[48:51], v[168:171]
    ds_read_b128 v[32:35], v9 offset:15360
    v_mfma_f32_16x16x32_bf16 v[152:155], v[100:103], v[52:55], v[152:155]
    ds_read_b128 v[36:39], v9 offset:30208
    v_mfma_f32_16x16x32_bf16 v[172:175], v[104:107], v[52:55], v[172:175]
    v_mfma_f32_16x16x32_bf16 v[156:159], v[100:103], v[56:59], v[156:159]
    ds_read_b128 v[40:43], v9 offset:45056
    v_mfma_f32_16x16x32_bf16 v[176:179], v[104:107], v[56:59], v[176:179]
    ds_read_b128 v[44:47], v9 offset:59904
    v_mfma_f32_16x16x32_bf16 v[160:163], v[100:103], v[60:63], v[160:163]
    ds_read_b64_tr_b16 v[76:77], v11 offset:0
    v_mfma_f32_16x16x32_bf16 v[180:183], v[104:107], v[60:63], v[180:183]
    ds_read_b64_tr_b16 v[78:79], v11 offset:1024
    v_mfma_f32_16x16x32_bf16 v[164:167], v[100:103], v[64:67], v[164:167]
    v_mfma_f32_16x16x32_bf16 v[184:187], v[104:107], v[64:67], v[184:187]
    ds_read_b64_tr_b16 v[80:81], v13 offset:0
    v_mfma_f32_16x16x32_bf16 v[116:119], v[92:95], v[52:55], v[116:119]
    ds_read_b64_tr_b16 v[82:83], v13 offset:1024
    v_mfma_f32_16x16x32_bf16 v[132:135], v[96:99], v[52:55], v[132:135]
    ds_read_b64_tr_b16 v[68:69], v10 offset:32768
    v_mfma_f32_16x16x32_bf16 v[120:123], v[92:95], v[56:59], v[120:123]
    v_mfma_f32_16x16x32_bf16 v[136:139], v[96:99], v[56:59], v[136:139]
    ds_read_b64_tr_b16 v[70:71], v10 offset:33792
    v_mfma_f32_16x16x32_bf16 v[124:127], v[92:95], v[60:63], v[124:127]
    ds_read_b64_tr_b16 v[72:73], v12 offset:32768
    v_mfma_f32_16x16x32_bf16 v[140:143], v[96:99], v[60:63], v[140:143]
    ds_read_b64_tr_b16 v[74:75], v12 offset:33792
    v_mfma_f32_16x16x32_bf16 v[128:131], v[92:95], v[64:67], v[128:131]
    ds_read_b64_tr_b16 v[84:85], v11 offset:8192
    v_mfma_f32_16x16x32_bf16 v[144:147], v[96:99], v[64:67], v[144:147]
    v_mfma_f32_16x16x32_bf16 v[188:191], v[48:51], v[108:111], v[188:191]
    ds_read_b64_tr_b16 v[86:87], v11 offset:9216
    v_mfma_f32_16x16x32_bf16 v[208:211], v[48:51], v[112:115], v[208:211]
    ds_read_b64_tr_b16 v[88:89], v13 offset:8192
    v_mfma_f32_16x16x32_bf16 v[192:195], v[52:55], v[108:111], v[192:195]
    ds_read_b64_tr_b16 v[90:91], v13 offset:9216
    v_mfma_f32_16x16x32_bf16 v[212:215], v[52:55], v[112:115], v[212:215]
    v_mfma_f32_16x16x32_bf16 v[196:199], v[56:59], v[108:111], v[196:199]
    v_mfma_f32_16x16x32_bf16 v[216:219], v[56:59], v[112:115], v[216:219]
    v_mfma_f32_16x16x32_bf16 v[200:203], v[60:63], v[108:111], v[200:203]
    v_mfma_f32_16x16x32_bf16 v[220:223], v[60:63], v[112:115], v[220:223]
    v_mfma_f32_16x16x32_bf16 v[204:207], v[64:67], v[108:111], v[204:207]
    v_mfma_f32_16x16x32_bf16 v[224:227], v[64:67], v[112:115], v[224:227]
    s_waitcnt lgkmcnt(0)
    s_barrier
    v_mfma_f32_16x16x32_bf16 v[148:151], v[76:79], v[28:31], v[148:151]
    ds_read_b128 v[48:51], v9 offset:576
    v_mfma_f32_16x16x32_bf16 v[168:171], v[80:83], v[28:31], v[168:171]
    ds_read_b128 v[52:55], v9 offset:15424
    v_mfma_f32_16x16x32_bf16 v[152:155], v[76:79], v[32:35], v[152:155]
    ds_read_b128 v[56:59], v9 offset:30272
    v_mfma_f32_16x16x32_bf16 v[172:175], v[80:83], v[32:35], v[172:175]
    v_mfma_f32_16x16x32_bf16 v[156:159], v[76:79], v[36:39], v[156:159]
    ds_read_b128 v[60:63], v9 offset:45120
    v_mfma_f32_16x16x32_bf16 v[176:179], v[80:83], v[36:39], v[176:179]
    ds_read_b128 v[64:67], v9 offset:59968
    v_mfma_f32_16x16x32_bf16 v[160:163], v[76:79], v[40:43], v[160:163]
    ds_read_b64_tr_b16 v[100:101], v11 offset:24576
    v_mfma_f32_16x16x32_bf16 v[180:183], v[80:83], v[40:43], v[180:183]
    ds_read_b64_tr_b16 v[102:103], v11 offset:25600
    v_mfma_f32_16x16x32_bf16 v[164:167], v[76:79], v[44:47], v[164:167]
    v_mfma_f32_16x16x32_bf16 v[184:187], v[80:83], v[44:47], v[184:187]
    ds_read_b64_tr_b16 v[104:105], v13 offset:24576
    v_mfma_f32_16x16x32_bf16 v[116:119], v[68:71], v[32:35], v[116:119]
    ds_read_b64_tr_b16 v[106:107], v13 offset:25600
    v_mfma_f32_16x16x32_bf16 v[132:135], v[72:75], v[32:35], v[132:135]
    ds_read_b64_tr_b16 v[92:93], v11 offset:16384
    v_mfma_f32_16x16x32_bf16 v[120:123], v[68:71], v[36:39], v[120:123]
    v_mfma_f32_16x16x32_bf16 v[136:139], v[72:75], v[36:39], v[136:139]
    ds_read_b64_tr_b16 v[94:95], v11 offset:17408
    v_mfma_f32_16x16x32_bf16 v[124:127], v[68:71], v[40:43], v[124:127]
    ds_read_b64_tr_b16 v[96:97], v13 offset:16384
    v_mfma_f32_16x16x32_bf16 v[140:143], v[72:75], v[40:43], v[140:143]
    ds_read_b64_tr_b16 v[98:99], v13 offset:17408
    v_mfma_f32_16x16x32_bf16 v[128:131], v[68:71], v[44:47], v[128:131]
    ds_read_b64_tr_b16 v[108:109], v11 offset:32768
    v_mfma_f32_16x16x32_bf16 v[144:147], v[72:75], v[44:47], v[144:147]
    v_mfma_f32_16x16x32_bf16 v[188:191], v[28:31], v[84:87], v[188:191]
    ds_read_b64_tr_b16 v[110:111], v11 offset:33792
    v_mfma_f32_16x16x32_bf16 v[208:211], v[28:31], v[88:91], v[208:211]
    ds_read_b64_tr_b16 v[112:113], v13 offset:32768
    v_mfma_f32_16x16x32_bf16 v[192:195], v[32:35], v[84:87], v[192:195]
    ds_read_b64_tr_b16 v[114:115], v13 offset:33792
    v_mfma_f32_16x16x32_bf16 v[212:215], v[32:35], v[88:91], v[212:215]
    v_mfma_f32_16x16x32_bf16 v[196:199], v[36:39], v[84:87], v[196:199]
    v_mfma_f32_16x16x32_bf16 v[216:219], v[36:39], v[88:91], v[216:219]
    v_mfma_f32_16x16x32_bf16 v[200:203], v[40:43], v[84:87], v[200:203]
    v_mfma_f32_16x16x32_bf16 v[220:223], v[40:43], v[88:91], v[220:223]
    v_mfma_f32_16x16x32_bf16 v[204:207], v[44:47], v[84:87], v[204:207]
    v_mfma_f32_16x16x32_bf16 v[224:227], v[44:47], v[88:91], v[224:227]
    s_waitcnt lgkmcnt(0)
    s_barrier
    v_mfma_f32_16x16x32_bf16 v[148:151], v[100:103], v[48:51], v[148:151]
    ds_read_b128 v[28:31], v9 offset:640
    v_mfma_f32_16x16x32_bf16 v[168:171], v[104:107], v[48:51], v[168:171]
    ds_read_b128 v[32:35], v9 offset:15488
    v_mfma_f32_16x16x32_bf16 v[152:155], v[100:103], v[52:55], v[152:155]
    ds_read_b128 v[36:39], v9 offset:30336
    v_mfma_f32_16x16x32_bf16 v[172:175], v[104:107], v[52:55], v[172:175]
    v_mfma_f32_16x16x32_bf16 v[156:159], v[100:103], v[56:59], v[156:159]
    ds_read_b128 v[40:43], v9 offset:45184
    v_mfma_f32_16x16x32_bf16 v[176:179], v[104:107], v[56:59], v[176:179]
    ds_read_b128 v[44:47], v9 offset:60032
    v_mfma_f32_16x16x32_bf16 v[160:163], v[100:103], v[60:63], v[160:163]
    ds_read_b64_tr_b16 v[76:77], v10 offset:8192
    v_mfma_f32_16x16x32_bf16 v[180:183], v[104:107], v[60:63], v[180:183]
    ds_read_b64_tr_b16 v[78:79], v10 offset:9216
    v_mfma_f32_16x16x32_bf16 v[164:167], v[100:103], v[64:67], v[164:167]
    v_mfma_f32_16x16x32_bf16 v[184:187], v[104:107], v[64:67], v[184:187]
    ds_read_b64_tr_b16 v[80:81], v12 offset:8192
    v_mfma_f32_16x16x32_bf16 v[116:119], v[92:95], v[52:55], v[116:119]
    ds_read_b64_tr_b16 v[82:83], v12 offset:9216
    v_mfma_f32_16x16x32_bf16 v[132:135], v[96:99], v[52:55], v[132:135]
    ds_read_b64_tr_b16 v[68:69], v10 offset:0
    v_mfma_f32_16x16x32_bf16 v[120:123], v[92:95], v[56:59], v[120:123]
    v_mfma_f32_16x16x32_bf16 v[136:139], v[96:99], v[56:59], v[136:139]
    ds_read_b64_tr_b16 v[70:71], v10 offset:1024
    v_mfma_f32_16x16x32_bf16 v[124:127], v[92:95], v[60:63], v[124:127]
    ds_read_b64_tr_b16 v[72:73], v12 offset:0
    v_mfma_f32_16x16x32_bf16 v[140:143], v[96:99], v[60:63], v[140:143]
    ds_read_b64_tr_b16 v[74:75], v12 offset:1024
    v_mfma_f32_16x16x32_bf16 v[128:131], v[92:95], v[64:67], v[128:131]
    ds_read_b64_tr_b16 v[84:85], v10 offset:16384
    v_mfma_f32_16x16x32_bf16 v[144:147], v[96:99], v[64:67], v[144:147]
    v_mfma_f32_16x16x32_bf16 v[188:191], v[48:51], v[108:111], v[188:191]
    ds_read_b64_tr_b16 v[86:87], v10 offset:17408
    v_mfma_f32_16x16x32_bf16 v[208:211], v[48:51], v[112:115], v[208:211]
    ds_read_b64_tr_b16 v[88:89], v12 offset:16384
    v_mfma_f32_16x16x32_bf16 v[192:195], v[52:55], v[108:111], v[192:195]
    ds_read_b64_tr_b16 v[90:91], v12 offset:17408
    v_mfma_f32_16x16x32_bf16 v[212:215], v[52:55], v[112:115], v[212:215]
    v_mfma_f32_16x16x32_bf16 v[196:199], v[56:59], v[108:111], v[196:199]
    v_mfma_f32_16x16x32_bf16 v[216:219], v[56:59], v[112:115], v[216:219]
    v_mfma_f32_16x16x32_bf16 v[200:203], v[60:63], v[108:111], v[200:203]
    v_mfma_f32_16x16x32_bf16 v[220:223], v[60:63], v[112:115], v[220:223]
    v_mfma_f32_16x16x32_bf16 v[204:207], v[64:67], v[108:111], v[204:207]
    v_mfma_f32_16x16x32_bf16 v[224:227], v[64:67], v[112:115], v[224:227]
    s_waitcnt lgkmcnt(0)
    s_barrier
    v_mfma_f32_16x16x32_bf16 v[148:151], v[76:79], v[28:31], v[148:151]
    ds_read_b128 v[48:51], v9 offset:704
    v_mfma_f32_16x16x32_bf16 v[168:171], v[80:83], v[28:31], v[168:171]
    ds_read_b128 v[52:55], v9 offset:15552
    v_mfma_f32_16x16x32_bf16 v[152:155], v[76:79], v[32:35], v[152:155]
    ds_read_b128 v[56:59], v9 offset:30400
    v_mfma_f32_16x16x32_bf16 v[172:175], v[80:83], v[32:35], v[172:175]
    v_mfma_f32_16x16x32_bf16 v[156:159], v[76:79], v[36:39], v[156:159]
    ds_read_b128 v[60:63], v9 offset:45248
    v_mfma_f32_16x16x32_bf16 v[176:179], v[80:83], v[36:39], v[176:179]
    ds_read_b128 v[64:67], v9 offset:60096
    v_mfma_f32_16x16x32_bf16 v[160:163], v[76:79], v[40:43], v[160:163]
    ds_read_b64_tr_b16 v[100:101], v10 offset:32768
    v_mfma_f32_16x16x32_bf16 v[180:183], v[80:83], v[40:43], v[180:183]
    ds_read_b64_tr_b16 v[102:103], v10 offset:33792
    v_mfma_f32_16x16x32_bf16 v[164:167], v[76:79], v[44:47], v[164:167]
    v_mfma_f32_16x16x32_bf16 v[184:187], v[80:83], v[44:47], v[184:187]
    ds_read_b64_tr_b16 v[104:105], v12 offset:32768
    v_mfma_f32_16x16x32_bf16 v[116:119], v[68:71], v[32:35], v[116:119]
    ds_read_b64_tr_b16 v[106:107], v12 offset:33792
    v_mfma_f32_16x16x32_bf16 v[132:135], v[72:75], v[32:35], v[132:135]
    ds_read_b64_tr_b16 v[92:93], v10 offset:24576
    v_mfma_f32_16x16x32_bf16 v[120:123], v[68:71], v[36:39], v[120:123]
    v_mfma_f32_16x16x32_bf16 v[136:139], v[72:75], v[36:39], v[136:139]
    ds_read_b64_tr_b16 v[94:95], v10 offset:25600
    v_mfma_f32_16x16x32_bf16 v[124:127], v[68:71], v[40:43], v[124:127]
    ds_read_b64_tr_b16 v[96:97], v12 offset:24576
    v_mfma_f32_16x16x32_bf16 v[140:143], v[72:75], v[40:43], v[140:143]
    ds_read_b64_tr_b16 v[98:99], v12 offset:25600
    v_mfma_f32_16x16x32_bf16 v[128:131], v[68:71], v[44:47], v[128:131]
    ds_read_b64_tr_b16 v[108:109], v11 offset:0
    v_mfma_f32_16x16x32_bf16 v[144:147], v[72:75], v[44:47], v[144:147]
    v_mfma_f32_16x16x32_bf16 v[188:191], v[28:31], v[84:87], v[188:191]
    ds_read_b64_tr_b16 v[110:111], v11 offset:1024
    v_mfma_f32_16x16x32_bf16 v[208:211], v[28:31], v[88:91], v[208:211]
    ds_read_b64_tr_b16 v[112:113], v13 offset:0
    v_mfma_f32_16x16x32_bf16 v[192:195], v[32:35], v[84:87], v[192:195]
    ds_read_b64_tr_b16 v[114:115], v13 offset:1024
    v_mfma_f32_16x16x32_bf16 v[212:215], v[32:35], v[88:91], v[212:215]
    v_mfma_f32_16x16x32_bf16 v[196:199], v[36:39], v[84:87], v[196:199]
    v_mfma_f32_16x16x32_bf16 v[216:219], v[36:39], v[88:91], v[216:219]
    v_mfma_f32_16x16x32_bf16 v[200:203], v[40:43], v[84:87], v[200:203]
    v_mfma_f32_16x16x32_bf16 v[220:223], v[40:43], v[88:91], v[220:223]
    v_mfma_f32_16x16x32_bf16 v[204:207], v[44:47], v[84:87], v[204:207]
    v_mfma_f32_16x16x32_bf16 v[224:227], v[44:47], v[88:91], v[224:227]
    s_waitcnt lgkmcnt(0)
    s_barrier
    v_mfma_f32_16x16x32_bf16 v[148:151], v[100:103], v[48:51], v[148:151]
    ds_read_b128 v[28:31], v9 offset:768
    v_mfma_f32_16x16x32_bf16 v[168:171], v[104:107], v[48:51], v[168:171]
    ds_read_b128 v[32:35], v9 offset:15616
    v_mfma_f32_16x16x32_bf16 v[152:155], v[100:103], v[52:55], v[152:155]
    ds_read_b128 v[36:39], v9 offset:30464
    v_mfma_f32_16x16x32_bf16 v[172:175], v[104:107], v[52:55], v[172:175]
    v_mfma_f32_16x16x32_bf16 v[156:159], v[100:103], v[56:59], v[156:159]
    ds_read_b128 v[40:43], v9 offset:45312
    v_mfma_f32_16x16x32_bf16 v[176:179], v[104:107], v[56:59], v[176:179]
    ds_read_b128 v[44:47], v9 offset:60160
    v_mfma_f32_16x16x32_bf16 v[160:163], v[100:103], v[60:63], v[160:163]
    ds_read_b64_tr_b16 v[76:77], v11 offset:16384
    v_mfma_f32_16x16x32_bf16 v[180:183], v[104:107], v[60:63], v[180:183]
    ds_read_b64_tr_b16 v[78:79], v11 offset:17408
    v_mfma_f32_16x16x32_bf16 v[164:167], v[100:103], v[64:67], v[164:167]
    v_mfma_f32_16x16x32_bf16 v[184:187], v[104:107], v[64:67], v[184:187]
    ds_read_b64_tr_b16 v[80:81], v13 offset:16384
    v_mfma_f32_16x16x32_bf16 v[116:119], v[92:95], v[52:55], v[116:119]
    ds_read_b64_tr_b16 v[82:83], v13 offset:17408
    v_mfma_f32_16x16x32_bf16 v[132:135], v[96:99], v[52:55], v[132:135]
    ds_read_b64_tr_b16 v[68:69], v11 offset:8192
    v_mfma_f32_16x16x32_bf16 v[120:123], v[92:95], v[56:59], v[120:123]
    v_mfma_f32_16x16x32_bf16 v[136:139], v[96:99], v[56:59], v[136:139]
    ds_read_b64_tr_b16 v[70:71], v11 offset:9216
    v_mfma_f32_16x16x32_bf16 v[124:127], v[92:95], v[60:63], v[124:127]
    ds_read_b64_tr_b16 v[72:73], v13 offset:8192
    v_mfma_f32_16x16x32_bf16 v[140:143], v[96:99], v[60:63], v[140:143]
    ds_read_b64_tr_b16 v[74:75], v13 offset:9216
    v_mfma_f32_16x16x32_bf16 v[128:131], v[92:95], v[64:67], v[128:131]
    ds_read_b64_tr_b16 v[84:85], v11 offset:24576
    v_mfma_f32_16x16x32_bf16 v[144:147], v[96:99], v[64:67], v[144:147]
    v_mfma_f32_16x16x32_bf16 v[188:191], v[48:51], v[108:111], v[188:191]
    ds_read_b64_tr_b16 v[86:87], v11 offset:25600
    v_mfma_f32_16x16x32_bf16 v[208:211], v[48:51], v[112:115], v[208:211]
    ds_read_b64_tr_b16 v[88:89], v13 offset:24576
    v_mfma_f32_16x16x32_bf16 v[192:195], v[52:55], v[108:111], v[192:195]
    ds_read_b64_tr_b16 v[90:91], v13 offset:25600
    v_mfma_f32_16x16x32_bf16 v[212:215], v[52:55], v[112:115], v[212:215]
    v_mfma_f32_16x16x32_bf16 v[196:199], v[56:59], v[108:111], v[196:199]
    v_mfma_f32_16x16x32_bf16 v[216:219], v[56:59], v[112:115], v[216:219]
    v_mfma_f32_16x16x32_bf16 v[200:203], v[60:63], v[108:111], v[200:203]
    v_mfma_f32_16x16x32_bf16 v[220:223], v[60:63], v[112:115], v[220:223]
    v_mfma_f32_16x16x32_bf16 v[204:207], v[64:67], v[108:111], v[204:207]
    v_mfma_f32_16x16x32_bf16 v[224:227], v[64:67], v[112:115], v[224:227]
    s_waitcnt lgkmcnt(0)
    s_barrier
    v_mfma_f32_16x16x32_bf16 v[148:151], v[76:79], v[28:31], v[148:151]
    ds_read_b128 v[48:51], v9 offset:832
    v_mfma_f32_16x16x32_bf16 v[168:171], v[80:83], v[28:31], v[168:171]
    ds_read_b128 v[52:55], v9 offset:15680
    v_mfma_f32_16x16x32_bf16 v[152:155], v[76:79], v[32:35], v[152:155]
    ds_read_b128 v[56:59], v9 offset:30528
    v_mfma_f32_16x16x32_bf16 v[172:175], v[80:83], v[32:35], v[172:175]
    v_mfma_f32_16x16x32_bf16 v[156:159], v[76:79], v[36:39], v[156:159]
    ds_read_b128 v[60:63], v9 offset:45376
    v_mfma_f32_16x16x32_bf16 v[176:179], v[80:83], v[36:39], v[176:179]
    ds_read_b128 v[64:67], v9 offset:60224
    v_mfma_f32_16x16x32_bf16 v[160:163], v[76:79], v[40:43], v[160:163]
    ds_read_b64_tr_b16 v[100:101], v10 offset:0
    v_mfma_f32_16x16x32_bf16 v[180:183], v[80:83], v[40:43], v[180:183]
    ds_read_b64_tr_b16 v[102:103], v10 offset:1024
    v_mfma_f32_16x16x32_bf16 v[164:167], v[76:79], v[44:47], v[164:167]
    v_mfma_f32_16x16x32_bf16 v[184:187], v[80:83], v[44:47], v[184:187]
    ds_read_b64_tr_b16 v[104:105], v12 offset:0
    v_mfma_f32_16x16x32_bf16 v[116:119], v[68:71], v[32:35], v[116:119]
    ds_read_b64_tr_b16 v[106:107], v12 offset:1024
    v_mfma_f32_16x16x32_bf16 v[132:135], v[72:75], v[32:35], v[132:135]
    ds_read_b64_tr_b16 v[92:93], v11 offset:32768
    v_mfma_f32_16x16x32_bf16 v[120:123], v[68:71], v[36:39], v[120:123]
    v_mfma_f32_16x16x32_bf16 v[136:139], v[72:75], v[36:39], v[136:139]
    ds_read_b64_tr_b16 v[94:95], v11 offset:33792
    v_mfma_f32_16x16x32_bf16 v[124:127], v[68:71], v[40:43], v[124:127]
    ds_read_b64_tr_b16 v[96:97], v13 offset:32768
    v_mfma_f32_16x16x32_bf16 v[140:143], v[72:75], v[40:43], v[140:143]
    ds_read_b64_tr_b16 v[98:99], v13 offset:33792
    v_mfma_f32_16x16x32_bf16 v[128:131], v[68:71], v[44:47], v[128:131]
    ds_read_b64_tr_b16 v[108:109], v10 offset:8192
    v_mfma_f32_16x16x32_bf16 v[144:147], v[72:75], v[44:47], v[144:147]
    v_mfma_f32_16x16x32_bf16 v[188:191], v[28:31], v[84:87], v[188:191]
    ds_read_b64_tr_b16 v[110:111], v10 offset:9216
    v_mfma_f32_16x16x32_bf16 v[208:211], v[28:31], v[88:91], v[208:211]
    ds_read_b64_tr_b16 v[112:113], v12 offset:8192
    v_mfma_f32_16x16x32_bf16 v[192:195], v[32:35], v[84:87], v[192:195]
    ds_read_b64_tr_b16 v[114:115], v12 offset:9216
    v_mfma_f32_16x16x32_bf16 v[212:215], v[32:35], v[88:91], v[212:215]
    v_mfma_f32_16x16x32_bf16 v[196:199], v[36:39], v[84:87], v[196:199]
    v_mfma_f32_16x16x32_bf16 v[216:219], v[36:39], v[88:91], v[216:219]
    v_mfma_f32_16x16x32_bf16 v[200:203], v[40:43], v[84:87], v[200:203]
    v_mfma_f32_16x16x32_bf16 v[220:223], v[40:43], v[88:91], v[220:223]
    v_mfma_f32_16x16x32_bf16 v[204:207], v[44:47], v[84:87], v[204:207]
    v_mfma_f32_16x16x32_bf16 v[224:227], v[44:47], v[88:91], v[224:227]
    s_waitcnt lgkmcnt(0)
    s_barrier
    s_mov_b32 s52, s22
    s_mov_b32 s53, s23
    s_mov_b32 s54, 256
    s_mov_b32 s55, 0x20000
    s_lshl_b32 s0, s27, 2
    v_mov_b32 v252, 0
    buffer_load_dword v253, v252, s[52:55], s0 offen sc1
    v_mfma_f32_16x16x32_bf16 v[148:151], v[100:103], v[48:51], v[148:151]
    v_mfma_f32_16x16x32_bf16 v[168:171], v[104:107], v[48:51], v[168:171]
    v_mfma_f32_16x16x32_bf16 v[152:155], v[100:103], v[52:55], v[152:155]
    v_mfma_f32_16x16x32_bf16 v[172:175], v[104:107], v[52:55], v[172:175]
    v_mfma_f32_16x16x32_bf16 v[156:159], v[100:103], v[56:59], v[156:159]
    v_mfma_f32_16x16x32_bf16 v[176:179], v[104:107], v[56:59], v[176:179]
    v_mfma_f32_16x16x32_bf16 v[160:163], v[100:103], v[60:63], v[160:163]
    v_mfma_f32_16x16x32_bf16 v[180:183], v[104:107], v[60:63], v[180:183]
    v_mfma_f32_16x16x32_bf16 v[164:167], v[100:103], v[64:67], v[164:167]
    v_mfma_f32_16x16x32_bf16 v[184:187], v[104:107], v[64:67], v[184:187]
    v_mfma_f32_16x16x32_bf16 v[116:119], v[92:95], v[52:55], v[116:119]
    v_cvt_pk_bf16_f32 v28, v148, v149
    v_cvt_pk_bf16_f32 v29, v150, v151
    v_mfma_f32_16x16x32_bf16 v[132:135], v[96:99], v[52:55], v[132:135]
    v_cvt_pk_bf16_f32 v30, v168, v169
    v_cvt_pk_bf16_f32 v31, v170, v171
    v_mfma_f32_16x16x32_bf16 v[120:123], v[92:95], v[56:59], v[120:123]
    v_cvt_pk_bf16_f32 v32, v152, v153
    v_cvt_pk_bf16_f32 v33, v154, v155
    v_mfma_f32_16x16x32_bf16 v[136:139], v[96:99], v[56:59], v[136:139]
    v_cvt_pk_bf16_f32 v34, v172, v173
    v_cvt_pk_bf16_f32 v35, v174, v175
    v_mfma_f32_16x16x32_bf16 v[124:127], v[92:95], v[60:63], v[124:127]
    v_cvt_pk_bf16_f32 v36, v156, v157
    v_cvt_pk_bf16_f32 v37, v158, v159
    v_mfma_f32_16x16x32_bf16 v[140:143], v[96:99], v[60:63], v[140:143]
    v_cvt_pk_bf16_f32 v38, v176, v177
    v_cvt_pk_bf16_f32 v39, v178, v179
    v_mfma_f32_16x16x32_bf16 v[128:131], v[92:95], v[64:67], v[128:131]
    v_cvt_pk_bf16_f32 v40, v160, v161
    v_cvt_pk_bf16_f32 v41, v162, v163
    v_mfma_f32_16x16x32_bf16 v[144:147], v[96:99], v[64:67], v[144:147]
    v_cvt_pk_bf16_f32 v42, v180, v181
    v_cvt_pk_bf16_f32 v43, v182, v183
    v_mfma_f32_16x16x32_bf16 v[188:191], v[48:51], v[108:111], v[188:191]
    v_cvt_pk_bf16_f32 v44, v164, v165
    v_cvt_pk_bf16_f32 v45, v166, v167
    v_mfma_f32_16x16x32_bf16 v[208:211], v[48:51], v[112:115], v[208:211]
    v_cvt_pk_bf16_f32 v46, v184, v185
    v_cvt_pk_bf16_f32 v47, v186, v187
    v_mfma_f32_16x16x32_bf16 v[192:195], v[52:55], v[108:111], v[192:195]
    v_cvt_pk_bf16_f32 v68, v116, v117
    v_cvt_pk_bf16_f32 v69, v118, v119
    v_mfma_f32_16x16x32_bf16 v[212:215], v[52:55], v[112:115], v[212:215]
    v_cvt_pk_bf16_f32 v70, v132, v133
    v_cvt_pk_bf16_f32 v71, v134, v135
    v_mfma_f32_16x16x32_bf16 v[196:199], v[56:59], v[108:111], v[196:199]
    v_cvt_pk_bf16_f32 v72, v120, v121
    v_cvt_pk_bf16_f32 v73, v122, v123
    v_mfma_f32_16x16x32_bf16 v[216:219], v[56:59], v[112:115], v[216:219]
    v_cvt_pk_bf16_f32 v74, v136, v137
    v_cvt_pk_bf16_f32 v75, v138, v139
    v_mfma_f32_16x16x32_bf16 v[200:203], v[60:63], v[108:111], v[200:203]
    v_cvt_pk_bf16_f32 v76, v124, v125
    v_cvt_pk_bf16_f32 v77, v126, v127
    v_mfma_f32_16x16x32_bf16 v[220:223], v[60:63], v[112:115], v[220:223]
    v_cvt_pk_bf16_f32 v78, v140, v141
    v_cvt_pk_bf16_f32 v79, v142, v143
    v_mfma_f32_16x16x32_bf16 v[204:207], v[64:67], v[108:111], v[204:207]
    v_cvt_pk_bf16_f32 v80, v128, v129
    v_cvt_pk_bf16_f32 v81, v130, v131
    v_mfma_f32_16x16x32_bf16 v[224:227], v[64:67], v[112:115], v[224:227]
    v_cvt_pk_bf16_f32 v82, v144, v145
    v_cvt_pk_bf16_f32 v83, v146, v147
    v_and_b32 v70, v244, v70
    v_and_b32 v71, v244, v71
    v_and_b32 v74, v244, v74
    v_and_b32 v75, v244, v75
    v_and_b32 v78, v244, v78
    v_and_b32 v79, v244, v79
    v_and_b32 v82, v244, v82
    v_and_b32 v83, v244, v83
    v_mfma_f32_16x16x32_bf16 v[148:151], v[28:31], v[68:71], v[236:239]
    v_cvt_pk_bf16_f32 v48, v188, v189
    v_cvt_pk_bf16_f32 v49, v190, v191
    v_mfma_f32_16x16x32_bf16 v[152:155], v[32:35], v[68:71], v[228:231]
    v_cvt_pk_bf16_f32 v58, v208, v209
    v_cvt_pk_bf16_f32 v59, v210, v211
    v_mfma_f32_16x16x32_bf16 v[156:159], v[32:35], v[72:75], v[232:235]
    v_cvt_pk_bf16_f32 v50, v192, v193
    v_cvt_pk_bf16_f32 v51, v194, v195
    v_mfma_f32_16x16x32_bf16 v[160:163], v[36:39], v[72:75], v[228:231]
    v_cvt_pk_bf16_f32 v60, v212, v213
    v_cvt_pk_bf16_f32 v61, v214, v215
    v_mfma_f32_16x16x32_bf16 v[164:167], v[36:39], v[76:79], v[232:235]
    v_cvt_pk_bf16_f32 v52, v196, v197
    v_cvt_pk_bf16_f32 v53, v198, v199
    v_mfma_f32_16x16x32_bf16 v[168:171], v[40:43], v[76:79], v[228:231]
    v_cvt_pk_bf16_f32 v62, v216, v217
    v_cvt_pk_bf16_f32 v63, v218, v219
    v_mfma_f32_16x16x32_bf16 v[172:175], v[40:43], v[80:83], v[232:235]
    v_cvt_pk_bf16_f32 v54, v200, v201
    v_cvt_pk_bf16_f32 v55, v202, v203
    v_mfma_f32_16x16x32_bf16 v[176:179], v[44:47], v[80:83], v[228:231]
    v_cvt_pk_bf16_f32 v64, v220, v221
    v_cvt_pk_bf16_f32 v65, v222, v223
    v_cvt_pk_bf16_f32 v56, v204, v205
    v_cvt_pk_bf16_f32 v57, v206, v207
    v_cvt_pk_bf16_f32 v66, v224, v225
    v_cvt_pk_bf16_f32 v67, v226, v227
    s_mov_b32 s31, 0x3e8b97f6
    v_max3_f32 v16, v148, v149, v152
    v_max3_f32 v17, v156, v157, v160
    v_max3_f32 v18, v164, v165, v168
    v_max3_f32 v19, v172, v173, v176
    v_max3_f32 v20, v150, v151, v154
    v_max3_f32 v21, v158, v159, v162
    v_max3_f32 v22, v166, v167, v170
    v_max3_f32 v23, v174, v175, v178
    v_max_f32 v16, v16, v153
    v_max_f32 v17, v17, v161
    v_max_f32 v18, v18, v169
    v_max_f32 v19, v19, v177
    v_max_f32 v20, v20, v155
    v_max_f32 v21, v21, v163
    v_max_f32 v22, v22, v171
    v_max_f32 v23, v23, v179
    v_max_f32 v24, v16, v20
    v_max_f32 v25, v17, v21
    v_max_f32 v26, v18, v22
    v_max_f32 v27, v19, v23
    v_permlane32_swap_b32 v24, v25
    s_nop 0
    v_permlane32_swap_b32 v26, v27
    v_max_f32 v24, v24, v25
    v_max_f32 v26, v26, v27
    s_nop 1
    v_permlane16_swap_b32 v24, v26
    v_max_f32 v24, v24, v26
    v_mul_f32 v26, s31, v24
    v_mul_f32 v24, s31, v24
    s_nop 1
    v_permlane16_swap_b32 v24, v26
    v_mov_b32 v25, v24
    v_mov_b32 v27, v26
    s_nop 0
    v_permlane32_swap_b32 v24, v25
    v_permlane32_swap_b32 v26, v27
    v_fma_f32 v16, v16, s31, -v24
    v_fma_f32 v17, v17, s31, -v25
    v_fma_f32 v18, v18, s31, -v26
    v_fma_f32 v19, v19, s31, -v27
    v_fma_f32 v20, v20, s31, -v24
    v_fma_f32 v21, v21, s31, -v25
    v_fma_f32 v22, v22, s31, -v26
    v_fma_f32 v23, v23, s31, -v27
    v_exp_f32 v16, v16
    v_exp_f32 v17, v17
    v_exp_f32 v18, v18
    v_exp_f32 v19, v19
    v_exp_f32 v20, v20
    v_exp_f32 v21, v21
    v_exp_f32 v22, v22
    v_exp_f32 v23, v23
    v_add_f32 v24, v16, v20
    v_add_f32 v25, v17, v21
    v_add_f32 v26, v18, v22
    v_add_f32 v27, v19, v23
    v_cvt_pk_bf16_f32 v16, v16, v16
    v_cvt_pk_bf16_f32 v17, v17, v17
    v_cvt_pk_bf16_f32 v18, v18, v18
    v_cvt_pk_bf16_f32 v19, v19, v19
    v_cvt_pk_bf16_f32 v20, v20, v20
    v_cvt_pk_bf16_f32 v21, v21, v21
    v_cvt_pk_bf16_f32 v22, v22, v22
    v_cvt_pk_bf16_f32 v23, v23, v23
    v_and_b32 v68, v240, v16
    v_and_b32 v69, v241, v20
    v_and_b32 v70, v242, v16
    v_and_b32 v71, v243, v20
    v_and_b32 v72, v240, v17
    v_and_b32 v73, v241, v21
    v_and_b32 v74, v242, v17
    v_and_b32 v75, v243, v21
    v_and_b32 v76, v240, v18
    v_and_b32 v77, v241, v22
    v_and_b32 v78, v242, v18
    v_and_b32 v79, v243, v22
    v_and_b32 v80, v240, v19
    v_and_b32 v81, v241, v23
    v_and_b32 v82, v242, v19
    v_and_b32 v83, v243, v23
    v_mfma_f32_16x16x32_bf16 v[116:119], v[48:51], v[68:71], 0
    v_mfma_f32_16x16x32_bf16 v[120:123], v[58:61], v[68:71], 0
    v_mfma_f32_16x16x32_bf16 v[124:127], v[50:53], v[72:75], 0
    v_mfma_f32_16x16x32_bf16 v[128:131], v[60:63], v[72:75], 0
    v_mfma_f32_16x16x32_bf16 v[132:135], v[52:55], v[76:79], 0
    v_mfma_f32_16x16x32_bf16 v[136:139], v[62:65], v[76:79], 0
    v_mfma_f32_16x16x32_bf16 v[140:143], v[54:57], v[80:83], 0
    v_mfma_f32_16x16x32_bf16 v[144:147], v[64:67], v[80:83], 0
    v_permlane32_swap_b32 v24, v25
    v_permlane32_swap_b32 v26, v27
    v_add_f32 v24, v24, v25
    v_add_f32 v26, v26, v27
    s_nop 1
    v_permlane16_swap_b32 v24, v26
    v_add_f32 v24, v24, v26
    v_rcp_f32 v26, v24
    v_rcp_f32 v24, v24
    s_nop 1
    v_permlane16_swap_b32 v24, v26
    v_mov_b32 v25, v24
    v_mov_b32 v27, v26
    s_nop 0
    v_permlane32_swap_b32 v24, v25
    v_permlane32_swap_b32 v26, v27
    v_pk_mul_f32 v[116:117], v[116:117], v[24:25] op_sel:[0,0] op_sel_hi:[1,0]
    v_pk_mul_f32 v[118:119], v[118:119], v[24:25] op_sel:[0,0] op_sel_hi:[1,0]
    v_pk_mul_f32 v[120:121], v[120:121], v[24:25] op_sel:[0,0] op_sel_hi:[1,0]
    v_pk_mul_f32 v[122:123], v[122:123], v[24:25] op_sel:[0,0] op_sel_hi:[1,0]
    v_cvt_pk_bf16_f32 v28, v116, v117
    v_cvt_pk_bf16_f32 v29, v118, v119
    v_cvt_pk_bf16_f32 v30, v120, v121
    v_cvt_pk_bf16_f32 v31, v122, v123
    ds_write_b64 v14, v[28:29] offset:0
    ds_write_b64 v15, v[30:31] offset:0
    v_pk_mul_f32 v[124:125], v[124:125], v[24:25] op_sel:[0,1] op_sel_hi:[1,1]
    v_pk_mul_f32 v[126:127], v[126:127], v[24:25] op_sel:[0,1] op_sel_hi:[1,1]
    v_pk_mul_f32 v[128:129], v[128:129], v[24:25] op_sel:[0,1] op_sel_hi:[1,1]
    v_pk_mul_f32 v[130:131], v[130:131], v[24:25] op_sel:[0,1] op_sel_hi:[1,1]
    v_cvt_pk_bf16_f32 v32, v124, v125
    v_cvt_pk_bf16_f32 v33, v126, v127
    v_cvt_pk_bf16_f32 v34, v128, v129
    v_cvt_pk_bf16_f32 v35, v130, v131
    ds_write_b64 v14, v[32:33] offset:3840
    ds_write_b64 v15, v[34:35] offset:3840
    v_pk_mul_f32 v[132:133], v[132:133], v[26:27] op_sel:[0,0] op_sel_hi:[1,0]
    v_pk_mul_f32 v[134:135], v[134:135], v[26:27] op_sel:[0,0] op_sel_hi:[1,0]
    v_pk_mul_f32 v[136:137], v[136:137], v[26:27] op_sel:[0,0] op_sel_hi:[1,0]
    v_pk_mul_f32 v[138:139], v[138:139], v[26:27] op_sel:[0,0] op_sel_hi:[1,0]
    v_cvt_pk_bf16_f32 v36, v132, v133
    v_cvt_pk_bf16_f32 v37, v134, v135
    v_cvt_pk_bf16_f32 v38, v136, v137
    v_cvt_pk_bf16_f32 v39, v138, v139
    ds_write_b64 v14, v[36:37] offset:7680
    ds_write_b64 v15, v[38:39] offset:7680
    v_pk_mul_f32 v[140:141], v[140:141], v[26:27] op_sel:[0,1] op_sel_hi:[1,1]
    v_pk_mul_f32 v[142:143], v[142:143], v[26:27] op_sel:[0,1] op_sel_hi:[1,1]
    v_pk_mul_f32 v[144:145], v[144:145], v[26:27] op_sel:[0,1] op_sel_hi:[1,1]
    v_pk_mul_f32 v[146:147], v[146:147], v[26:27] op_sel:[0,1] op_sel_hi:[1,1]
    v_cvt_pk_bf16_f32 v40, v140, v141
    v_cvt_pk_bf16_f32 v41, v142, v143
    v_cvt_pk_bf16_f32 v42, v144, v145
    v_cvt_pk_bf16_f32 v43, v146, v147
    ds_write_b64 v14, v[40:41] offset:11520
    ds_write_b64 v15, v[42:43] offset:11520
    s_waitcnt vmcnt(0)
    v_readfirstlane_b32 s31, v253
    s_nop 0
    s_cmp_lg_u32 s31, 0
    s_cbranch_scc0 L_ack_c
L_ackd_c:
    s_and_b32 s31, s31, 2
    s_lshl_b32 s1, s31, 12
    s_add_u32 s96, s96, s1
    s_add_u32 s58, s58, s1
    s_branch L_att_s2
.p2align 12
L_att_ld:
    v_lshrrev_b32 v16, 4, v0
    s_and_b32 s31, s32, 1
    s_lshl_b32 s31, s31, 2
    v_add_u32 v17, s31, v16
    v_lshlrev_b32 v17, 1, v17
    v_sub_u32 v17, v0, v17
    v_and_b32 v17, 15, v17
    v_min_u32 v17, 13, v17
    s_lshl_b32 s31, s32, 3
    v_add_u32 v16, s31, v16
    v_mul_u32_u24 v9, 2688, v16
    v_lshl_add_u32 v9, v17, 4, v9
    v_add_u32 v10, 9728, v9
    s_lshl_b32 s35, s32, 11
    s_mul_i32 s56, s26, 224
    v_lshrrev_b32 v16, 3, v0
    s_lshl_b32 s31, s32, 4
    v_add_u32 v16, s31, v16
    v_bfe_u32 v18, v0, 4, 1
    v_lshlrev_b32 v18, 2, v18
    v_and_b32 v17, 7, v0
    v_xor_b32 v17, v17, v18
    v_lshlrev_b32 v17, 4, v17
    v_mul_u32_u24 v11, 896, v16
    v_add_u32 v11, v11, v17
    v_add_u32 v12, 6144, v11
    s_lshl_b32 s31, s26, 2
    s_lshr_b32 s57, 29200, s31
    s_and_b32 s57, s57, 7
    s_cmp_eq_u32 s57, 7
    s_cselect_b32 s57, 0xfe0000, s57
    s_lshl_b32 s57, s57, 7
    s_lshl_b32 s31, s26, 2
    s_lshr_b32 s11, 25428, s31
    s_and_b32 s11, s11, 7
    s_cmp_eq_u32 s11, 7
    s_cselect_b32 s11, 0xfe0000, s11
    s_lshl_b32 s11, s11, 7
    v_mov_b32 v16, 0
    v_mov_b32 v17, 0
    s_waitcnt vmcnt(6)
    v_dot2c_f32_bf16 v16, s29, v32
    v_dot2c_f32_bf16 v17, v32, v32
    v_dot2c_f32_bf16 v16, s29, v33
    v_dot2c_f32_bf16 v17, v33, v33
    v_dot2c_f32_bf16 v16, s29, v34
    v_dot2c_f32_bf16 v17, v34, v34
    v_dot2c_f32_bf16 v16, s29, v35
    v_dot2c_f32_bf16 v17, v35, v35
    s_waitcnt vmcnt(5)
    v_dot2c_f32_bf16 v16, s29, v36
    v_dot2c_f32_bf16 v17, v36, v36
    v_dot2c_f32_bf16 v16, s29, v37
    v_dot2c_f32_bf16 v17, v37, v37
    v_dot2c_f32_bf16 v16, s29, v38
    v_dot2c_f32_bf16 v17, v38, v38
    v_dot2c_f32_bf16 v16, s29, v39
    v_dot2c_f32_bf16 v17, v39, v39
    s_waitcnt vmcnt(4)
    v_dot2c_f32_bf16 v16, s29, v40
    v_dot2c_f32_bf16 v17, v40, v40
    v_dot2c_f32_bf16 v16, s29, v41
    v_dot2c_f32_bf16 v17, v41, v41
    v_dot2c_f32_bf16 v16, s29, v42
    v_dot2c_f32_bf16 v17, v42, v42
    v_dot2c_f32_bf16 v16, s29, v43
    v_dot2c_f32_bf16 v17, v43, v43
    s_waitcnt vmcnt(3)
    v_dot2c_f32_bf16 v16, s29, v44
    v_dot2c_f32_bf16 v17, v44, v44
    v_dot2c_f32_bf16 v16, s29, v45
    v_dot2c_f32_bf16 v17, v45, v45
    v_dot2c_f32_bf16 v16, s29, v46
    v_dot2c_f32_bf16 v17, v46, v46
    v_dot2c_f32_bf16 v16, s29, v47
    v_dot2c_f32_bf16 v17, v47, v47
    s_waitcnt vmcnt(2)
    v_dot2c_f32_bf16 v16, s29, v48
    v_dot2c_f32_bf16 v17, v48, v48
    v_dot2c_f32_bf16 v16, s29, v49
    v_dot2c_f32_bf16 v17, v49, v49
    v_dot2c_f32_bf16 v16, s29, v50
    v_dot2c_f32_bf16 v17, v50, v50
    v_dot2c_f32_bf16 v16, s29, v51
    v_dot2c_f32_bf16 v17, v51, v51
    s_waitcnt vmcnt(1)
    v_dot2c_f32_bf16 v16, s29, v52
    v_dot2c_f32_bf16 v17, v52, v52
    v_dot2c_f32_bf16 v16, s29, v53
    v_dot2c_f32_bf16 v17, v53, v53
    v_dot2c_f32_bf16 v16, s29, v54
    v_dot2c_f32_bf16 v17, v54, v54
    v_dot2c_f32_bf16 v16, s29, v55
    v_dot2c_f32_bf16 v17, v55, v55
    s_waitcnt vmcnt(0)
    v_dot2c_f32_bf16 v16, s29, v56
    v_dot2c_f32_bf16 v17, v56, v56
    v_dot2c_f32_bf16 v16, s29, v57
    v_dot2c_f32_bf16 v17, v57, v57
    v_dot2c_f32_bf16 v16, s29, v58
    v_dot2c_f32_bf16 v17, v58, v58
    v_dot2c_f32_bf16 v16, s29, v59
    v_dot2c_f32_bf16 v17, v59, v59
    s_nop 1
    v_add_f32_dpp v16, v16, v16 quad_perm:[1,0,3,2] row_mask:0xf bank_mask:0xf
    v_add_f32_dpp v17, v17, v17 quad_perm:[1,0,3,2] row_mask:0xf bank_mask:0xf
    s_nop 0
    v_add_f32_dpp v16, v16, v16 quad_perm:[2,3,0,1] row_mask:0xf bank_mask:0xf
    v_add_f32_dpp v17, v17, v17 quad_perm:[2,3,0,1] row_mask:0xf bank_mask:0xf
    s_nop 0
    v_add_f32_dpp v16, v16, v16 row_half_mirror row_mask:0xf bank_mask:0xf
    v_add_f32_dpp v17, v17, v17 row_half_mirror row_mask:0xf bank_mask:0xf
    v_mul_f32 v16, 0x3b124925, v16
    v_mul_f32 v17, 0x3b124925, v17
    v_fma_f32 v17, -v16, v16, v17
    v_max_f32 v17, 0, v17
    v_add_f32 v17, 0x3727c5ac, v17
    v_rsq_f32 v18, v17
    s_nop 0
    v_mul_f32 v20, v16, v18
    v_sub_f32 v20, 0, v20
    s_lshl_b32 s15, s26, 3
    s_add_u32 s15, s15, s3
    s_cmp_lg_u32 s15, 4
    s_cbranch_scc1 L_noclr
    v_mov_b32 v64, 0
    v_and_b32 v68, 15, v0
    v_lshlrev_b32 v70, 9, v68
    v_lshrrev_b32 v69, 2, v68
    v_and_b32 v68, 3, v68
    v_mul_u32_u24 v69, 128, v69
    v_mul_u32_u24 v68, 4, v68
    v_add_u32 v68, v68, v69
    v_mov_b32 v65, 0
    v_mov_b32 v66, 0
    v_mov_b32 v67, 0
    v_and_b32 v68, 31, v0
    v_lshlrev_b32 v68, 4, v68
    v_lshrrev_b32 v69, 5, v0
    v_lshl_add_u32 v68, v69, 13, v68
    buffer_store_dwordx4 v[64:67], v68, s[48:51], s96 offen sc1
    v_lshrrev_b32 v69, 3, v0
    v_lshl_add_u32 v69, v69, 10, v2
    s_mov_b32 s31, 672256
    buffer_store_dwordx4 v[64:67], v69, s[48:51], s31 offen sc1
    s_mov_b32 s31, 680448
    buffer_store_dwordx4 v[64:67], v69, s[48:51], s31 offen sc1
L_noclr:
    v_lshlrev_b32 v22, 16, v32
    v_and_b32 v23, s30, v32
    v_lshlrev_b32 v24, 16, v33
    v_and_b32 v25, s30, v33
    v_lshlrev_b32 v26, 16, v34
    v_and_b32 v27, s30, v34
    v_lshlrev_b32 v28, 16, v35
    v_and_b32 v29, s30, v35
    v_pk_fma_f32 v[22:23], v[22:23], v[18:19], v[20:21] op_sel_hi:[1,0,0]
    v_pk_fma_f32 v[24:25], v[24:25], v[18:19], v[20:21] op_sel_hi:[1,0,0]
    v_pk_fma_f32 v[26:27], v[26:27], v[18:19], v[20:21] op_sel_hi:[1,0,0]
    v_pk_fma_f32 v[28:29], v[28:29], v[18:19], v[20:21] op_sel_hi:[1,0,0]
    v_cvt_pk_bf16_f32 v32, v22, v23
    v_cvt_pk_bf16_f32 v33, v24, v25
    v_cvt_pk_bf16_f32 v34, v26, v27
    v_cvt_pk_bf16_f32 v35, v28, v29
    ds_write_b128 v100, v[32:35] offset:14848
    v_lshlrev_b32 v22, 16, v36
    v_and_b32 v23, s30, v36
    v_lshlrev_b32 v24, 16, v37
    v_and_b32 v25, s30, v37
    v_lshlrev_b32 v26, 16, v38
    v_and_b32 v27, s30, v38
    v_lshlrev_b32 v28, 16, v39
    v_and_b32 v29, s30, v39
    v_pk_fma_f32 v[22:23], v[22:23], v[18:19], v[20:21] op_sel_hi:[1,0,0]
    v_pk_fma_f32 v[24:25], v[24:25], v[18:19], v[20:21] op_sel_hi:[1,0,0]
    v_pk_fma_f32 v[26:27], v[26:27], v[18:19], v[20:21] op_sel_hi:[1,0,0]
    v_pk_fma_f32 v[28:29], v[28:29], v[18:19], v[20:21] op_sel_hi:[1,0,0]
    v_cvt_pk_bf16_f32 v36, v22, v23
    v_cvt_pk_bf16_f32 v37, v24, v25
    v_cvt_pk_bf16_f32 v38, v26, v27
    v_cvt_pk_bf16_f32 v39, v28, v29
    ds_write_b128 v101, v[36:39] offset:14848
    v_lshlrev_b32 v22, 16, v40
    v_and_b32 v23, s30, v40
    v_lshlrev_b32 v24, 16, v41
    v_and_b32 v25, s30, v41
    v_lshlrev_b32 v26, 16, v42
    v_and_b32 v27, s30, v42
    v_lshlrev_b32 v28, 16, v43
    v_and_b32 v29, s30, v43
    v_pk_fma_f32 v[22:23], v[22:23], v[18:19], v[20:21] op_sel_hi:[1,0,0]
    v_pk_fma_f32 v[24:25], v[24:25], v[18:19], v[20:21] op_sel_hi:[1,0,0]
    v_pk_fma_f32 v[26:27], v[26:27], v[18:19], v[20:21] op_sel_hi:[1,0,0]
    v_pk_fma_f32 v[28:29], v[28:29], v[18:19], v[20:21] op_sel_hi:[1,0,0]
    v_cvt_pk_bf16_f32 v40, v22, v23
    v_cvt_pk_bf16_f32 v41, v24, v25
    v_cvt_pk_bf16_f32 v42, v26, v27
    v_cvt_pk_bf16_f32 v43, v28, v29
    ds_write_b128 v102, v[40:43] offset:14848
    v_lshlrev_b32 v22, 16, v44
    v_and_b32 v23, s30, v44
    v_lshlrev_b32 v24, 16, v45
    v_and_b32 v25, s30, v45
    v_lshlrev_b32 v26, 16, v46
    v_and_b32 v27, s30, v46
    v_lshlrev_b32 v28, 16, v47
    v_and_b32 v29, s30, v47
    v_pk_fma_f32 v[22:23], v[22:23], v[18:19], v[20:21] op_sel_hi:[1,0,0]
    v_pk_fma_f32 v[24:25], v[24:25], v[18:19], v[20:21] op_sel_hi:[1,0,0]
    v_pk_fma_f32 v[26:27], v[26:27], v[18:19], v[20:21] op_sel_hi:[1,0,0]
    v_pk_fma_f32 v[28:29], v[28:29], v[18:19], v[20:21] op_sel_hi:[1,0,0]
    v_cvt_pk_bf16_f32 v44, v22, v23
    v_cvt_pk_bf16_f32 v45, v24, v25
    v_cvt_pk_bf16_f32 v46, v26, v27
    v_cvt_pk_bf16_f32 v47, v28, v29
    ds_write_b128 v103, v[44:47] offset:14848
    v_lshlrev_b32 v22, 16, v48
    v_and_b32 v23, s30, v48
    v_lshlrev_b32 v24, 16, v49
    v_and_b32 v25, s30, v49
    v_lshlrev_b32 v26, 16, v50
    v_and_b32 v27, s30, v50
    v_lshlrev_b32 v28, 16, v51
    v_and_b32 v29, s30, v51
    v_pk_fma_f32 v[22:23], v[22:23], v[18:19], v[20:21] op_sel_hi:[1,0,0]
    v_pk_fma_f32 v[24:25], v[24:25], v[18:19], v[20:21] op_sel_hi:[1,0,0]
    v_pk_fma_f32 v[26:27], v[26:27], v[18:19], v[20:21] op_sel_hi:[1,0,0]
    v_pk_fma_f32 v[28:29], v[28:29], v[18:19], v[20:21] op_sel_hi:[1,0,0]
    v_cvt_pk_bf16_f32 v48, v22, v23
    v_cvt_pk_bf16_f32 v49, v24, v25
    v_cvt_pk_bf16_f32 v50, v26, v27
    v_cvt_pk_bf16_f32 v51, v28, v29
    ds_write_b128 v104, v[48:51] offset:14848
    v_lshlrev_b32 v22, 16, v52
    v_and_b32 v23, s30, v52
    v_lshlrev_b32 v24, 16, v53
    v_and_b32 v25, s30, v53
    v_lshlrev_b32 v26, 16, v54
    v_and_b32 v27, s30, v54
    v_lshlrev_b32 v28, 16, v55
    v_and_b32 v29, s30, v55
    v_pk_fma_f32 v[22:23], v[22:23], v[18:19], v[20:21] op_sel_hi:[1,0,0]
    v_pk_fma_f32 v[24:25], v[24:25], v[18:19], v[20:21] op_sel_hi:[1,0,0]
    v_pk_fma_f32 v[26:27], v[26:27], v[18:19], v[20:21] op_sel_hi:[1,0,0]
    v_pk_fma_f32 v[28:29], v[28:29], v[18:19], v[20:21] op_sel_hi:[1,0,0]
    v_cvt_pk_bf16_f32 v52, v22, v23
    v_cvt_pk_bf16_f32 v53, v24, v25
    v_cvt_pk_bf16_f32 v54, v26, v27
    v_cvt_pk_bf16_f32 v55, v28, v29
    ds_write_b128 v105, v[52:55] offset:14848
    v_lshlrev_b32 v22, 16, v56
    v_and_b32 v23, s30, v56
    v_lshlrev_b32 v24, 16, v57
    v_and_b32 v25, s30, v57
    v_lshlrev_b32 v26, 16, v58
    v_and_b32 v27, s30, v58
    v_lshlrev_b32 v28, 16, v59
    v_and_b32 v29, s30, v59
    v_pk_fma_f32 v[22:23], v[22:23], v[18:19], v[20:21] op_sel_hi:[1,0,0]
    v_pk_fma_f32 v[24:25], v[24:25], v[18:19], v[20:21] op_sel_hi:[1,0,0]
    v_pk_fma_f32 v[26:27], v[26:27], v[18:19], v[20:21] op_sel_hi:[1,0,0]
    v_pk_fma_f32 v[28:29], v[28:29], v[18:19], v[20:21] op_sel_hi:[1,0,0]
    v_cvt_pk_bf16_f32 v56, v22, v23
    v_cvt_pk_bf16_f32 v57, v24, v25
    v_cvt_pk_bf16_f32 v58, v26, v27
    v_cvt_pk_bf16_f32 v59, v28, v29
    ds_write_b128 v106, v[56:59] offset:14848
    s_cmp_lg_u32 s15, 4
    s_cbranch_scc1 L_noack
    s_waitcnt vmcnt(0)
    s_mov_b32 s62, 1
L_noack:
    s_mov_b32 s98, 0
    s_mov_b32 s99, 0
    s_mov_b32 s100, 0
    s_mov_b32 s101, 0
    s_mov_b32 s61, 0
    s_and_b32 s63, s3, 3
    s_lshl_b32 s63, s63, 4
    s_add_u32 s63, s63, s28
    v_and_b32 v252, 7, v0
    v_lshrrev_b32 v253, 3, v0
    v_cmp_gt_u32 s[52:53], 7, v252
    v_cmp_gt_u32 s[54:55], 7, v253
    v_mul_u32_u24 v253, 57344, v253
    v_lshl_add_u32 v252, v252, 7, v253
    s_mul_i32 s63, s63, 896
    s_and_b32 s31, s2, 3
    s_mul_i32 s31, s31, 401408
    s_add_u32 s63, s63, s31
    s_and_b64 exec, s[52:53], s[54:55]
    s_mov_b32 s52, s16
    s_mov_b32 s53, s17
    s_mov_b32 s54, 1605632
    s_mov_b32 s55, 0x20000
    buffer_load_dword v255, v252, s[52:55], s63 offen
    s_mov_b64 exec, -1
    s_and_b32 s63, s3, 3
    s_lshl_b32 s63, s63, 4
    s_add_u32 s63, s63, s28
    v_and_b32 v252, 7, v0
    v_lshrrev_b32 v253, 3, v0
    v_cmp_gt_u32 s[52:53], 7, v252
    v_cmp_gt_u32 s[54:55], 4, v253
    s_and_b32 s31, s26, 2
    v_and_b32 v254, 2, v253
    v_add3_u32 v253, v253, v254, s31
    v_min_u32 v253, 6, v253
    v_mul_u32_u24 v252, 896, v252
    v_lshl_add_u32 v252, v253, 7, v252
    s_mul_i32 s63, s63, 6272
    s_mov_b32 s31, 0
    s_add_u32 s63, s63, s31
    s_and_b64 exec, s[52:53], s[54:55]
    s_mov_b32 s52, s8
    s_mov_b32 s53, s9
    s_mov_b32 s54, 401408
    s_mov_b32 s55, 0x20000
    buffer_load_dword v255, v252, s[52:55], s63 offen
    s_mov_b64 exec, -1
    s_cmp_eq_u32 s3, 5
    s_cbranch_scc1 L_stub_L0
    s_cmp_eq_u32 s3, 6
    s_cbranch_scc1 L_stub_L1
    s_cmp_eq_u32 s3, 7
    s_cbranch_scc1 L_warm2
L_warm2:
    s_waitcnt lgkmcnt(0)
    s_barrier
    s_add_u32 m0, s35, 123392
    s_add_u32 s59, s5, 0
    buffer_load_dwordx4 v9, s[40:43], s59 offen lds
    buffer_load_dwordx4 v10, s[40:43], s59 offen offset:1024 lds
    s_add_u32 m0, s35, 131584
    s_add_u32 s59, s5, 896
    buffer_load_dwordx4 v9, s[40:43], s59 offen lds
    buffer_load_dwordx4 v10, s[40:43], s59 offen offset:1024 lds
    s_add_u32 m0, s35, 139776
    s_add_u32 s59, s5, 1792
    buffer_load_dwordx4 v9, s[40:43], s59 offen lds
    buffer_load_dwordx4 v10, s[40:43], s59 offen offset:1024 lds
    s_add_u32 m0, s35, 147968
    s_add_u32 s59, s5, 86016
    buffer_load_dwordx4 v9, s[40:43], s59 offen lds
    buffer_load_dwordx4 v10, s[40:43], s59 offen offset:1024 lds
    s_waitcnt vmcnt(0)
    s_barrier
    s_add_u32 m0, s35, 74240
    s_add_u32 s59, s5, 86912
    buffer_load_dwordx4 v9, s[40:43], s59 offen lds
    buffer_load_dwordx4 v10, s[40:43], s59 offen offset:1024 lds
    s_add_u32 m0, s35, 82432
    s_add_u32 s59, s5, 87808
    buffer_load_dwordx4 v9, s[40:43], s59 offen lds
    buffer_load_dwordx4 v10, s[40:43], s59 offen offset:1024 lds
    s_add_u32 m0, s35, 90624
    s_add_u32 s59, s6, 0
    buffer_load_dwordx4 v9, s[40:43], s59 offen lds
    buffer_load_dwordx4 v10, s[40:43], s59 offen offset:1024 lds
    s_waitcnt vmcnt(0)
    s_barrier
    s_add_u32 s61, s61, s98
    s_sub_u32 s61, s61, s99
    s_add_u32 s61, s61, s100
    s_sub_u32 s61, s61, s101
    s_add_u32 m0, s35, 98816
    s_add_u32 s59, s6, 896
    buffer_load_dwordx4 v9, s[40:43], s59 offen lds
    s_add_u32 s61, s61, s98
    s_sub_u32 s61, s61, s99
    s_add_u32 s61, s61, s100
    s_sub_u32 s61, s61, s101
    buffer_load_dwordx4 v10, s[40:43], s59 offen offset:1024 lds
    s_add_u32 s61, s61, s98
    s_sub_u32 s61, s61, s99
    s_add_u32 s61, s61, s100
    s_sub_u32 s61, s61, s101
    s_add_u32 m0, s35, 107008
    s_add_u32 s59, s6, 1792
    buffer_load_dwordx4 v9, s[40:43], s59 offen lds
    s_add_u32 s61, s61, s98
    s_sub_u32 s61, s61, s99
    s_add_u32 s61, s61, s100
    s_sub_u32 s61, s61, s101
    buffer_load_dwordx4 v10, s[40:43], s59 offen offset:1024 lds
    s_add_u32 s61, s61, s98
    s_sub_u32 s61, s61, s99
    s_add_u32 s61, s61, s100
    s_sub_u32 s61, s61, s101
    s_add_u32 m0, s35, 115200
    s_add_u32 s59, s6, 86016
    buffer_load_dwordx4 v9, s[40:43], s59 offen lds
    s_add_u32 s61, s61, s98
    s_sub_u32 s61, s61, s99
    s_add_u32 s61, s61, s100
    s_sub_u32 s61, s61, s101
    buffer_load_dwordx4 v10, s[40:43], s59 offen offset:1024 lds
    s_add_u32 s61, s61, s98
    s_sub_u32 s61, s61, s99
    s_add_u32 s61, s61, s100
    s_sub_u32 s61, s61, s101
    s_cmp_lg_u32 s15, 4
    s_cbranch_scc1 L_race2
    s_mov_b64 s[98:99], -1
    s_load_dword s99, s[48:49], 680448
    s_load_dword s98, s[48:49], 672256
L_race2:
    s_add_u32 s61, s61, s98
    s_sub_u32 s61, s61, s99
    s_add_u32 s61, s61, s100
    s_sub_u32 s61, s61, s101
    s_barrier
    s_add_u32 s61, s61, s98
    s_sub_u32 s61, s61, s99
    s_add_u32 s61, s61, s100
    s_sub_u32 s61, s61, s101
    s_add_u32 m0, s35, 123392
    s_add_u32 s59, s6, 86912
    buffer_load_dwordx4 v9, s[40:43], s59 offen lds
    s_add_u32 s61, s61, s98
    s_sub_u32 s61, s61, s99
    s_add_u32 s61, s61, s100
    s_sub_u32 s61, s61, s101
    buffer_load_dwordx4 v10, s[40:43], s59 offen offset:1024 lds
    s_add_u32 s61, s61, s98
    s_sub_u32 s61, s61, s99
    s_add_u32 s61, s61, s100
    s_sub_u32 s61, s61, s101
    s_add_u32 m0, s35, 131584
    s_add_u32 s59, s6, 87808
    buffer_load_dwordx4 v9, s[40:43], s59 offen lds
    s_add_u32 s61, s61, s98
    s_sub_u32 s61, s61, s99
    s_add_u32 s61, s61, s100
    s_sub_u32 s61, s61, s101
    buffer_load_dwordx4 v10, s[40:43], s59 offen offset:1024 lds
    s_add_u32 s61, s61, s98
    s_sub_u32 s61, s61, s99
    s_add_u32 s61, s61, s100
    s_sub_u32 s61, s61, s101
    s_add_u32 m0, s35, 139776
    s_add_u32 s59, s7, 0
    buffer_load_dwordx4 v9, s[40:43], s59 offen lds
    s_add_u32 s61, s61, s98
    s_sub_u32 s61, s61, s99
    s_add_u32 s61, s61, s100
    s_sub_u32 s61, s61, s101
    buffer_load_dwordx4 v10, s[40:43], s59 offen offset:1024 lds
    s_add_u32 s61, s61, s98
    s_sub_u32 s61, s61, s99
    s_add_u32 s61, s61, s100
    s_sub_u32 s61, s61, s101
    s_cmp_lg_u32 s15, 4
    s_cbranch_scc1 L_race3
    s_mov_b64 s[100:101], -1
    s_load_dword s100, s[48:49], 678400
    s_load_dword s101, s[48:49], 686592
L_race3:
    s_waitcnt vmcnt(8)
    s_add_u32 s61, s61, s98
    s_sub_u32 s61, s61, s99
    s_add_u32 s61, s61, s100
    s_sub_u32 s61, s61, s101
    s_barrier
    s_add_u32 s61, s61, s98
    s_sub_u32 s61, s61, s99
    s_add_u32 s61, s61, s100
    s_sub_u32 s61, s61, s101
    s_add_u32 m0, s35, 147968
    s_add_u32 s59, s7, 896
    buffer_load_dwordx4 v9, s[40:43], s59 offen lds
    s_add_u32 s61, s61, s98
    s_sub_u32 s61, s61, s99
    s_add_u32 s61, s61, s100
    s_sub_u32 s61, s61, s101
    buffer_load_dwordx4 v10, s[40:43], s59 offen offset:1024 lds
    s_add_u32 s61, s61, s98
    s_sub_u32 s61, s61, s99
    s_add_u32 s61, s61, s100
    s_sub_u32 s61, s61, s101
    s_add_u32 m0, s35, 74240
    s_add_u32 s59, s7, 1792
    buffer_load_dwordx4 v9, s[40:43], s59 offen lds
    s_add_u32 s61, s61, s98
    s_sub_u32 s61, s61, s99
    s_add_u32 s61, s61, s100
    s_sub_u32 s61, s61, s101
    buffer_load_dwordx4 v10, s[40:43], s59 offen offset:1024 lds
    s_add_u32 s61, s61, s98
    s_sub_u32 s61, s61, s99
    s_add_u32 s61, s61, s100
    s_sub_u32 s61, s61, s101
    s_add_u32 m0, s35, 82432
    s_add_u32 s59, s7, 86016
    buffer_load_dwordx4 v9, s[40:43], s59 offen lds
    s_add_u32 s61, s61, s98
    s_sub_u32 s61, s61, s99
    s_add_u32 s61, s61, s100
    s_sub_u32 s61, s61, s101
    buffer_load_dwordx4 v10, s[40:43], s59 offen offset:1024 lds
    s_add_u32 s61, s61, s98
    s_sub_u32 s61, s61, s99
    s_add_u32 s61, s61, s100
    s_sub_u32 s61, s61, s101
    s_cmp_lg_u32 s15, 4
    s_cbranch_scc1 L_race4
    s_mov_b64 s[98:99], -1
    s_load_dword s99, s[48:49], 682496
    s_load_dword s98, s[48:49], 674304
L_race4:
    s_waitcnt vmcnt(8)
    s_add_u32 s61, s61, s98
    s_sub_u32 s61, s61, s99
    s_add_u32 s61, s61, s100
    s_sub_u32 s61, s61, s101
    s_barrier
    s_add_u32 s61, s61, s98
    s_sub_u32 s61, s61, s99
    s_add_u32 s61, s61, s100
    s_sub_u32 s61, s61, s101
    s_add_u32 m0, s35, 90624
    s_add_u32 s59, s7, 86912
    buffer_load_dwordx4 v9, s[40:43], s59 offen lds
    s_add_u32 s61, s61, s98
    s_sub_u32 s61, s61, s99
    s_add_u32 s61, s61, s100
    s_sub_u32 s61, s61, s101
    buffer_load_dwordx4 v10, s[40:43], s59 offen offset:1024 lds
    s_add_u32 s61, s61, s98
    s_sub_u32 s61, s61, s99
    s_add_u32 s61, s61, s100
    s_sub_u32 s61, s61, s101
    s_add_u32 m0, s35, 98816
    s_add_u32 s59, s7, 87808
    buffer_load_dwordx4 v9, s[40:43], s59 offen lds
    s_add_u32 s61, s61, s98
    s_sub_u32 s61, s61, s99
    s_add_u32 s61, s61, s100
    s_sub_u32 s61, s61, s101
    buffer_load_dwordx4 v10, s[40:43], s59 offen offset:1024 lds
    s_add_u32 s61, s61, s98
    s_sub_u32 s61, s61, s99
    s_add_u32 s61, s61, s100
    s_sub_u32 s61, s61, s101
    s_add_u32 m0, s35, 107008
    s_add_u32 s59, s12, 0
    buffer_load_dwordx4 v9, s[40:43], s59 offen lds
    s_add_u32 s61, s61, s98
    s_sub_u32 s61, s61, s99
    s_add_u32 s61, s61, s100
    s_sub_u32 s61, s61, s101
    buffer_load_dwordx4 v10, s[40:43], s59 offen offset:1024 lds
    s_add_u32 s61, s61, s98
    s_sub_u32 s61, s61, s99
    s_add_u32 s61, s61, s100
    s_sub_u32 s61, s61, s101
    s_cmp_lg_u32 s15, 4
    s_cbranch_scc1 L_race5
    s_mov_b64 s[100:101], -1
    s_load_dword s100, s[48:49], 676352
    s_load_dword s101, s[48:49], 684544
L_race5:
    s_waitcnt vmcnt(8)
    s_add_u32 s61, s61, s98
    s_sub_u32 s61, s61, s99
    s_add_u32 s61, s61, s100
    s_sub_u32 s61, s61, s101
    s_barrier
    s_add_u32 s61, s61, s98
    s_sub_u32 s61, s61, s99
    s_add_u32 s61, s61, s100
    s_sub_u32 s61, s61, s101
    s_add_u32 m0, s35, 115200
    s_add_u32 s59, s12, 896
    buffer_load_dwordx4 v9, s[40:43], s59 offen lds
    s_add_u32 s61, s61, s98
    s_sub_u32 s61, s61, s99
    s_add_u32 s61, s61, s100
    s_sub_u32 s61, s61, s101
    buffer_load_dwordx4 v10, s[40:43], s59 offen offset:1024 lds
    s_add_u32 s61, s61, s98
    s_sub_u32 s61, s61, s99
    s_add_u32 s61, s61, s100
    s_sub_u32 s61, s61, s101
    s_add_u32 m0, s35, 123392
    s_add_u32 s59, s12, 1792
    buffer_load_dwordx4 v9, s[40:43], s59 offen lds
    s_add_u32 s61, s61, s98
    s_sub_u32 s61, s61, s99
    s_add_u32 s61, s61, s100
    s_sub_u32 s61, s61, s101
    buffer_load_dwordx4 v10, s[40:43], s59 offen offset:1024 lds
    s_add_u32 s61, s61, s98
    s_sub_u32 s61, s61, s99
    s_add_u32 s61, s61, s100
    s_sub_u32 s61, s61, s101
    s_add_u32 m0, s35, 131584
    s_add_u32 s59, s12, 86016
    buffer_load_dwordx4 v9, s[40:43], s59 offen lds
    s_add_u32 s61, s61, s98
    s_sub_u32 s61, s61, s99
    s_add_u32 s61, s61, s100
    s_sub_u32 s61, s61, s101
    buffer_load_dwordx4 v10, s[40:43], s59 offen offset:1024 lds
    s_add_u32 s61, s61, s98
    s_sub_u32 s61, s61, s99
    s_add_u32 s61, s61, s100
    s_sub_u32 s61, s61, s101
    s_cmp_lg_u32 s15, 4
    s_cbranch_scc1 L_race6
    s_mov_b64 s[98:99], -1
    s_load_dword s99, s[48:49], 681472
    s_load_dword s98, s[48:49], 673280
L_race6:
    s_waitcnt vmcnt(8)
    s_add_u32 s61, s61, s98
    s_sub_u32 s61, s61, s99
    s_add_u32 s61, s61, s100
    s_sub_u32 s61, s61, s101
    s_barrier
    s_add_u32 s61, s61, s98
    s_sub_u32 s61, s61, s99
    s_add_u32 s61, s61, s100
    s_sub_u32 s61, s61, s101
    s_add_u32 m0, s35, 139776
    s_add_u32 s59, s12, 86912
    buffer_load_dwordx4 v9, s[40:43], s59 offen lds
    s_add_u32 s61, s61, s98
    s_sub_u32 s61, s61, s99
    s_add_u32 s61, s61, s100
    s_sub_u32 s61, s61, s101
    buffer_load_dwordx4 v10, s[40:43], s59 offen offset:1024 lds
    s_add_u32 s61, s61, s98
    s_sub_u32 s61, s61, s99
    s_add_u32 s61, s61, s100
    s_sub_u32 s61, s61, s101
    s_add_u32 m0, s35, 147968
    s_add_u32 s59, s12, 87808
    buffer_load_dwordx4 v9, s[40:43], s59 offen lds
    s_add_u32 s61, s61, s98
    s_sub_u32 s61, s61, s99
    s_add_u32 s61, s61, s100
    s_sub_u32 s61, s61, s101
    buffer_load_dwordx4 v10, s[40:43], s59 offen offset:1024 lds
    s_add_u32 s61, s61, s98
    s_sub_u32 s61, s61, s99
    s_add_u32 s61, s61, s100
    s_sub_u32 s61, s61, s101
    s_add_u32 m0, s35, 74240
    s_add_u32 s59, s13, 0
    buffer_load_dwordx4 v9, s[40:43], s59 offen lds
    s_add_u32 s61, s61, s98
    s_sub_u32 s61, s61, s99
    s_add_u32 s61, s61, s100
    s_sub_u32 s61, s61, s101
    buffer_load_dwordx4 v10, s[40:43], s59 offen offset:1024 lds
    s_add_u32 s61, s61, s98
    s_sub_u32 s61, s61, s99
    s_add_u32 s61, s61, s100
    s_sub_u32 s61, s61, s101
    s_cmp_lg_u32 s15, 4
    s_cbranch_scc1 L_race7
    s_mov_b64 s[100:101], -1
    s_load_dword s100, s[48:49], 677376
    s_load_dword s101, s[48:49], 685568
L_race7:
    s_waitcnt vmcnt(8)
    s_add_u32 s61, s61, s98
    s_sub_u32 s61, s61, s99
    s_add_u32 s61, s61, s100
    s_sub_u32 s61, s61, s101
    s_barrier
    s_add_u32 s61, s61, s98
    s_sub_u32 s61, s61, s99
    s_add_u32 s61, s61, s100
    s_sub_u32 s61, s61, s101
    s_add_u32 m0, s35, 82432
    s_add_u32 s59, s13, 896
    buffer_load_dwordx4 v9, s[40:43], s59 offen lds
    s_add_u32 s61, s61, s98
    s_sub_u32 s61, s61, s99
    s_add_u32 s61, s61, s100
    s_sub_u32 s61, s61, s101
    buffer_load_dwordx4 v10, s[40:43], s59 offen offset:1024 lds
    s_add_u32 s61, s61, s98
    s_sub_u32 s61, s61, s99
    s_add_u32 s61, s61, s100
    s_sub_u32 s61, s61, s101
    s_add_u32 m0, s35, 90624
    s_add_u32 s59, s13, 1792
    buffer_load_dwordx4 v9, s[40:43], s59 offen lds
    s_add_u32 s61, s61, s98
    s_sub_u32 s61, s61, s99
    s_add_u32 s61, s61, s100
    s_sub_u32 s61, s61, s101
    buffer_load_dwordx4 v10, s[40:43], s59 offen offset:1024 lds
    s_add_u32 s61, s61, s98
    s_sub_u32 s61, s61, s99
    s_add_u32 s61, s61, s100
    s_sub_u32 s61, s61, s101
    s_add_u32 m0, s35, 98816
    s_add_u32 s59, s13, 86016
    buffer_load_dwordx4 v9, s[40:43], s59 offen lds
    s_add_u32 s61, s61, s98
    s_sub_u32 s61, s61, s99
    s_add_u32 s61, s61, s100
    s_sub_u32 s61, s61, s101
    buffer_load_dwordx4 v10, s[40:43], s59 offen offset:1024 lds
    s_add_u32 s61, s61, s98
    s_sub_u32 s61, s61, s99
    s_add_u32 s61, s61, s100
    s_sub_u32 s61, s61, s101
    s_cmp_lg_u32 s15, 4
    s_cbranch_scc1 L_race8
    s_mov_b64 s[98:99], -1
    s_load_dword s99, s[48:49], 683520
    s_load_dword s98, s[48:49], 675328
L_race8:
    s_waitcnt vmcnt(8)
    s_add_u32 s61, s61, s98
    s_sub_u32 s61, s61, s99
    s_add_u32 s61, s61, s100
    s_sub_u32 s61, s61, s101
    s_barrier
    s_add_u32 s61, s61, s98
    s_sub_u32 s61, s61, s99
    s_add_u32 s61, s61, s100
    s_sub_u32 s61, s61, s101
    s_add_u32 m0, s35, 107008
    s_add_u32 s59, s13, 86912
    buffer_load_dwordx4 v9, s[40:43], s59 offen lds
    s_add_u32 s61, s61, s98
    s_sub_u32 s61, s61, s99
    s_add_u32 s61, s61, s100
    s_sub_u32 s61, s61, s101
    buffer_load_dwordx4 v10, s[40:43], s59 offen offset:1024 lds
    s_add_u32 s61, s61, s98
    s_sub_u32 s61, s61, s99
    s_add_u32 s61, s61, s100
    s_sub_u32 s61, s61, s101
    s_add_u32 m0, s35, 115200
    s_add_u32 s59, s13, 87808
    buffer_load_dwordx4 v9, s[40:43], s59 offen lds
    s_add_u32 s61, s61, s98
    s_sub_u32 s61, s61, s99
    s_add_u32 s61, s61, s100
    s_sub_u32 s61, s61, s101
    buffer_load_dwordx4 v10, s[40:43], s59 offen offset:1024 lds
    s_add_u32 s61, s61, s98
    s_sub_u32 s61, s61, s99
    s_add_u32 s61, s61, s100
    s_sub_u32 s61, s61, s101
    s_add_u32 m0, s35, 123392
    s_add_u32 s59, s14, 0
    buffer_load_dwordx4 v9, s[40:43], s59 offen lds
    s_add_u32 s61, s61, s98
    s_sub_u32 s61, s61, s99
    s_add_u32 s61, s61, s100
    s_sub_u32 s61, s61, s101
    buffer_load_dwordx4 v10, s[40:43], s59 offen offset:1024 lds
    s_add_u32 s61, s61, s98
    s_sub_u32 s61, s61, s99
    s_add_u32 s61, s61, s100
    s_sub_u32 s61, s61, s101
    s_cmp_lg_u32 s15, 4
    s_cbranch_scc1 L_race9
    s_mov_b64 s[100:101], -1
    s_load_dword s100, s[48:49], 679424
    s_load_dword s101, s[48:49], 687616
L_race9:
    s_branch L_page11
.p2align 12
L_stub_L0:
    s_branch L_warm2
    s_nop 0
L_page11:
    s_waitcnt vmcnt(8)
    s_add_u32 s61, s61, s98
    s_sub_u32 s61, s61, s99
    s_add_u32 s61, s61, s100
    s_sub_u32 s61, s61, s101
    s_barrier
    s_add_u32 s61, s61, s98
    s_sub_u32 s61, s61, s99
    s_add_u32 s61, s61, s100
    s_sub_u32 s61, s61, s101
    s_add_u32 m0, s35, 131584
    s_add_u32 s59, s14, 896
    buffer_load_dwordx4 v9, s[40:43], s59 offen lds
    s_add_u32 s61, s61, s98
    s_sub_u32 s61, s61, s99
    s_add_u32 s61, s61, s100
    s_sub_u32 s61, s61, s101
    buffer_load_dwordx4 v10, s[40:43], s59 offen offset:1024 lds
    s_add_u32 s61, s61, s98
    s_sub_u32 s61, s61, s99
    s_add_u32 s61, s61, s100
    s_sub_u32 s61, s61, s101
    s_add_u32 m0, s35, 139776
    s_add_u32 s59, s14, 1792
    buffer_load_dwordx4 v9, s[40:43], s59 offen lds
    s_add_u32 s61, s61, s98
    s_sub_u32 s61, s61, s99
    s_add_u32 s61, s61, s100
    s_sub_u32 s61, s61, s101
    buffer_load_dwordx4 v10, s[40:43], s59 offen offset:1024 lds
    s_add_u32 s61, s61, s98
    s_sub_u32 s61, s61, s99
    s_add_u32 s61, s61, s100
    s_sub_u32 s61, s61, s101
    s_add_u32 m0, s35, 147968
    s_add_u32 s59, s14, 86016
    buffer_load_dwordx4 v9, s[40:43], s59 offen lds
    s_add_u32 s61, s61, s98
    s_sub_u32 s61, s61, s99
    s_add_u32 s61, s61, s100
    s_sub_u32 s61, s61, s101
    buffer_load_dwordx4 v10, s[40:43], s59 offen offset:1024 lds
    s_add_u32 s61, s61, s98
    s_sub_u32 s61, s61, s99
    s_add_u32 s61, s61, s100
    s_sub_u32 s61, s61, s101
    s_cmp_lg_u32 s15, 4
    s_cbranch_scc1 L_raced
    s_waitcnt lgkmcnt(0)
    s_cmp_lt_i32 s61, 0
    s_cselect_b32 s62, 3, 1
    s_mov_b32 s52, s22
    s_mov_b32 s53, s23
    s_mov_b32 s54, 256
    s_mov_b32 s55, 0x20000
    s_lshl_b32 s31, s27, 2
    v_mov_b32 v250, 0
    v_mov_b32 v251, s62
    s_mov_b64 exec, 1
    buffer_store_dword v251, v250, s[52:55], s31 offen sc1
    s_mov_b64 exec, -1
L_raced:
    s_waitcnt vmcnt(8)
    s_barrier
    s_add_u32 m0, s35, 74240
    s_add_u32 s59, s14, 86912
    buffer_load_dwordx4 v9, s[40:43], s59 offen lds
    buffer_load_dwordx4 v10, s[40:43], s59 offen offset:1024 lds
    s_add_u32 m0, s35, 82432
    s_add_u32 s59, s14, 87808
    buffer_load_dwordx4 v9, s[40:43], s59 offen lds
    buffer_load_dwordx4 v10, s[40:43], s59 offen offset:1024 lds
    s_waitcnt vmcnt(6)
    s_barrier
    s_add_u32 m0, s35, 90624
    s_add_u32 s59, s57, 0
    buffer_load_dwordx4 v11, s[44:47], s59 offen offset:0 lds
    buffer_load_dwordx4 v12, s[44:47], s59 offen offset:1024 lds
    s_add_u32 m0, s35, 98816
    s_add_u32 s59, s11, 0
    buffer_load_dwordx4 v11, s[44:47], s59 offen offset:0 lds
    buffer_load_dwordx4 v12, s[44:47], s59 offen offset:1024 lds
    s_add_u32 m0, s35, 107008
    s_add_u32 s59, s57, 57344
    buffer_load_dwordx4 v11, s[44:47], s59 offen offset:0 lds
    buffer_load_dwordx4 v12, s[44:47], s59 offen offset:1024 lds
    s_add_u32 m0, s35, 115200
    s_add_u32 s59, s11, 57344
    buffer_load_dwordx4 v11, s[44:47], s59 offen offset:0 lds
    buffer_load_dwordx4 v12, s[44:47], s59 offen offset:1024 lds
    s_waitcnt vmcnt(8)
    s_barrier
    s_add_u32 m0, s35, 123392
    s_add_u32 s59, s57, 286720
    buffer_load_dwordx4 v11, s[44:47], s59 offen offset:0 lds
    buffer_load_dwordx4 v12, s[44:47], s59 offen offset:1024 lds
    s_add_u32 m0, s35, 131584
    s_add_u32 s59, s11, 286720
    buffer_load_dwordx4 v11, s[44:47], s59 offen offset:0 lds
    buffer_load_dwordx4 v12, s[44:47], s59 offen offset:1024 lds
    s_barrier
    s_add_u32 m0, s35, 16384
    s_add_u32 s59, s57, 344064
    buffer_load_dwordx4 v11, s[44:47], s59 offen offset:0 lds
    buffer_load_dwordx4 v12, s[44:47], s59 offen offset:1024 lds
    s_add_u32 m0, s35, 24576
    s_add_u32 s59, s11, 344064
    buffer_load_dwordx4 v11, s[44:47], s59 offen offset:0 lds
    buffer_load_dwordx4 v12, s[44:47], s59 offen offset:1024 lds
    s_add_u32 m0, s35, 32768
    s_add_u32 s59, s57, 114688
    buffer_load_dwordx4 v11, s[44:47], s59 offen offset:0 lds
    buffer_load_dwordx4 v12, s[44:47], s59 offen offset:1024 lds
    s_add_u32 m0, s35, 40960
    s_add_u32 s59, s11, 114688
    buffer_load_dwordx4 v11, s[44:47], s59 offen offset:0 lds
    buffer_load_dwordx4 v12, s[44:47], s59 offen offset:1024 lds
    s_add_u32 m0, s35, 49152
    s_add_u32 s59, s57, 172032
    buffer_load_dwordx4 v11, s[44:47], s59 offen offset:0 lds
    buffer_load_dwordx4 v12, s[44:47], s59 offen offset:1024 lds
    s_add_u32 m0, s35, 57344
    s_add_u32 s59, s11, 172032
    buffer_load_dwordx4 v11, s[44:47], s59 offen offset:0 lds
    buffer_load_dwordx4 v12, s[44:47], s59 offen offset:1024 lds
    s_mul_i32 s31, s27, 57344
    s_add_u32 m0, s35, 81920
    s_add_u32 s59, s57, s31
    buffer_load_dwordx4 v11, s[36:39], s59 offen offset:0 lds
    buffer_load_dwordx4 v12, s[36:39], s59 offen offset:1024 lds
    s_add_u32 m0, s35, 147968
    s_add_u32 s59, s11, s31
    buffer_load_dwordx4 v11, s[36:39], s59 offen offset:0 lds
    buffer_load_dwordx4 v12, s[36:39], s59 offen offset:1024 lds
    s_mov_b32 s40, s18
    s_mov_b32 s41, s19
    s_mov_b32 s42, 896
    s_mov_b32 s43, 0x20000
    s_mov_b32 m0, 156160
    s_nop 0
    buffer_load_dwordx4 v5, s[40:43], 0 offen lds
    s_mov_b32 s52, s22
    s_mov_b32 s53, s23
    s_mov_b32 s54, 256
    s_mov_b32 s55, 0x20000
    s_lshl_b32 s0, s27, 2
    v_mov_b32 v252, 0
    buffer_load_dword v253, v252, s[52:55], s0 offen sc1
    s_waitcnt vmcnt(0)
    v_readfirstlane_b32 s31, v253
    s_nop 0
    s_cmp_lg_u32 s31, 0
    s_cbranch_scc0 L_ack_a
L_ackd_a:
    s_and_b32 s31, s31, 2
    s_lshl_b32 s1, s31, 12
    s_add_u32 s96, s96, s1
    s_add_u32 s58, s58, s1
    s_add_u32 s60, s1, 458752
    s_and_b32 s10, s3, 4
    s_add_u32 s10, s10, s26
    s_lshl_b32 s10, s10, 2
    s_lshr_b32 s10, 1666478608, s10
    s_and_b32 s10, s10, 7
    s_lshl_b32 s56, s10, 3
    s_lshl_b32 s31, s33, 1
    s_add_u32 s56, s56, s31
    s_add_u32 s56, s56, s34
    s_lshl_b32 s56, s56, 11
    s_add_u32 s56, s56, s1
    s_lshl_b32 s99, s10, 7
    s_lshl_b32 s31, s34, 6
    s_add_u32 s99, s99, s31
    s_lshl_b32 s58, s27, 1
    s_add_u32 s58, s58, s33
    s_mul_i32 s58, s58, 28672
    s_add_u32 s58, s58, s99
    s_cmp_eq_u32 s10, 7
    s_cselect_b32 s58, 0x7f000000, s58
    v_and_b32 v1, 31, v0
    v_lshrrev_b32 v2, 5, v0
    v_lshlrev_b32 v2, 5, v2
    v_mul_u32_u24 v1, 896, v1
    v_add_u32 v1, v1, v2
    s_mov_b32 s100, 0x3f80
    s_mov_b32 s101, 0x3f800000
    v_and_b32 v9, 31, v0
    v_bfe_u32 v10, v0, 1, 1
    v_xor_b32 v10, s34, v10
    v_lshlrev_b32 v9, 7, v9
    v_lshl_add_u32 v9, v10, 6, v9
    v_add_u32 v9, v9, v2
    s_cmp_ge_u32 s3, 4
    s_cselect_b32 s31, 66048, 0
    s_lshl_b32 s59, s33, 12
    s_add_u32 s31, s31, s59
    s_add_u32 s31, s31, 81920
    v_add_u32 v9, s31, v9
    s_add_u32 s31, s99, 156160
    v_add_u32 v10, s31, v2
    s_mul_i32 s31, s33, 28672
    s_add_u32 s31, s31, 90624
    v_add_u32 v3, s31, v5
    s_add_u32 s98, s26, 8
    s_lshl_b32 s98, s98, 14
    s_lshl_b32 s31, s32, 11
    s_add_u32 s98, s98, s31
    s_add_u32 s98, s98, s60
    s_add_u32 s31, s26, 1
    s_and_b32 s31, s31, 2
    s_add_u32 s97, s31, s3
L_att_s2:
    s_waitcnt vmcnt(0) lgkmcnt(0)
    s_barrier
    s_add_u32 s60, s1, 458752
    s_cmp_ge_u32 s3, 4
    s_cbranch_scc1 L_x1
    ds_read_b128 v[32:35], v6 offset:0
    ds_read_b128 v[36:39], v6 offset:7680
    ds_read_b128 v[40:43], v6 offset:32
    ds_read_b128 v[44:47], v6 offset:7712
    s_lshl_b32 s31, s26, 14
    s_lshl_b32 s59, s3, 11
    s_add_u32 s31, s31, s59
    s_add_u32 s31, s31, s60
    s_add_u32 s59, s31, 65536
    s_waitcnt lgkmcnt(3)
    buffer_store_dwordx4 v[32:35], v5, s[48:51], s31 offen offset:0 sc1
    s_waitcnt lgkmcnt(2)
    buffer_store_dwordx4 v[36:39], v5, s[48:51], s59 offen offset:0 sc1
    s_cmp_eq_u32 s3, 3
    s_cbranch_scc1 L_x2
    s_waitcnt lgkmcnt(1)
    buffer_store_dwordx4 v[40:43], v5, s[48:51], s31 offen offset:1024 sc1
    s_waitcnt lgkmcnt(0)
    buffer_store_dwordx4 v[44:47], v5, s[48:51], s59 offen offset:1024 sc1
    s_branch L_x2
L_x1:
    s_add_u32 m0, s35, 65536
    s_add_u32 s59, s57, 229376
    buffer_load_dwordx4 v11, s[44:47], s59 offen offset:0 lds
    buffer_load_dwordx4 v12, s[44:47], s59 offen offset:1024 lds
    s_add_u32 m0, s35, 73728
    s_add_u32 s59, s11, 229376
    buffer_load_dwordx4 v11, s[44:47], s59 offen offset:0 lds
    buffer_load_dwordx4 v12, s[44:47], s59 offen offset:1024 lds
L_x2:
    ds_read_b64_tr_b16 v[128:129], v7 offset:0
    ds_read_b64_tr_b16 v[130:131], v7 offset:512
    ds_read_b64_tr_b16 v[132:133], v7 offset:2048
    ds_read_b64_tr_b16 v[134:135], v7 offset:2560
    ds_read_b64_tr_b16 v[136:137], v7 offset:4096
    ds_read_b64_tr_b16 v[138:139], v7 offset:4608
    ds_read_b64_tr_b16 v[140:141], v7 offset:6144
    ds_read_b64_tr_b16 v[142:143], v7 offset:6656
    ds_read_b64_tr_b16 v[144:145], v7 offset:16384
    ds_read_b64_tr_b16 v[146:147], v7 offset:16896
    ds_read_b64_tr_b16 v[148:149], v7 offset:18432
    ds_read_b64_tr_b16 v[150:151], v7 offset:18944
    ds_read_b64_tr_b16 v[152:153], v7 offset:20480
    ds_read_b64_tr_b16 v[154:155], v7 offset:20992
    ds_read_b64_tr_b16 v[156:157], v7 offset:22528
    ds_read_b64_tr_b16 v[158:159], v7 offset:23040
    ds_read_b64_tr_b16 v[208:209], v7 offset:32768
    ds_read_b64_tr_b16 v[210:211], v7 offset:33280
    ds_read_b64_tr_b16 v[212:213], v7 offset:34816
    ds_read_b64_tr_b16 v[214:215], v7 offset:35328
    ds_read_b64_tr_b16 v[216:217], v7 offset:36864
    ds_read_b64_tr_b16 v[218:219], v7 offset:37376
    ds_read_b64_tr_b16 v[220:221], v7 offset:38912
    ds_read_b64_tr_b16 v[222:223], v7 offset:39424
    v_min_u32 v13, 15, v0
    v_lshrrev_b32 v14, 2, v13
    v_and_b32 v13, 3, v13
    v_mul_u32_u24 v14, 128, v14
    v_mul_u32_u24 v13, 4, v13
    v_add_u32 v13, v13, v14
    v_mov_b32 v15, v13
    v_mov_b32 v14, 1
    s_lshl_b32 s35, s3, 10
    s_add_u32 s57, s60, s35
    s_cmp_ge_u32 s3, 4
    s_cbranch_scc1 L_y0
    s_waitcnt vmcnt(0) lgkmcnt(0)
    s_barrier
    s_cmp_lg_u32 s3, 0
    s_cbranch_scc1 L_x3
    s_add_u32 s31, s26, 12
    s_lshl_b64 exec, 1, s31
    buffer_store_dword v14, v15, s[48:51], s96 offen sc1
    s_mov_b64 exec, -1
L_x3:
    s_barrier
    s_add_u32 m0, s35, 90624
    s_add_u32 s59, s57, 0
    buffer_load_dwordx4 v5, s[48:51], s59 offen sc1 lds
    s_add_u32 m0, s35, 119296
    s_add_u32 s59, s57, 65536
    buffer_load_dwordx4 v5, s[48:51], s59 offen sc1 lds
    s_add_u32 m0, s35, 112128
    s_add_u32 s59, s57, 49152
    buffer_load_dwordx4 v5, s[48:51], s59 offen sc1 lds
    s_add_u32 m0, s35, 140800
    s_add_u32 s59, s57, 114688
    buffer_load_dwordx4 v5, s[48:51], s59 offen sc1 lds
    ds_read_b64_tr_b16 v[224:225], v8 offset:0
    ds_read_b64_tr_b16 v[226:227], v8 offset:512
    ds_read_b64_tr_b16 v[228:229], v8 offset:2048
    ds_read_b64_tr_b16 v[230:231], v8 offset:2560
    ds_read_b64_tr_b16 v[232:233], v8 offset:4096
    ds_read_b64_tr_b16 v[234:235], v8 offset:4608
    ds_read_b64_tr_b16 v[236:237], v8 offset:6144
    ds_read_b64_tr_b16 v[238:239], v8 offset:6656
    ds_read_b64_tr_b16 v[160:161], v8 offset:16384
    ds_read_b64_tr_b16 v[162:163], v8 offset:16896
    ds_read_b64_tr_b16 v[164:165], v8 offset:18432
    ds_read_b64_tr_b16 v[166:167], v8 offset:18944
    ds_read_b64_tr_b16 v[168:169], v8 offset:20480
    ds_read_b64_tr_b16 v[170:171], v8 offset:20992
    ds_read_b64_tr_b16 v[172:173], v8 offset:22528
    ds_read_b64_tr_b16 v[174:175], v8 offset:23040
    ds_read_b64_tr_b16 v[176:177], v8 offset:32768
    ds_read_b64_tr_b16 v[178:179], v8 offset:33280
    ds_read_b64_tr_b16 v[180:181], v8 offset:34816
    ds_read_b64_tr_b16 v[182:183], v8 offset:35328
    ds_read_b64_tr_b16 v[184:185], v8 offset:36864
    ds_read_b64_tr_b16 v[186:187], v8 offset:37376
    ds_read_b64_tr_b16 v[188:189], v8 offset:38912
    ds_read_b64_tr_b16 v[190:191], v8 offset:39424
    s_and_b32 s10, s3, 4
    s_add_u32 s10, s10, s26
    s_lshl_b32 s10, s10, 2
    s_lshr_b32 s10, 1666478608, s10
    s_and_b32 s10, s10, 7
    s_lshl_b32 s56, s10, 3
    s_lshl_b32 s31, s33, 1
    s_add_u32 s56, s56, s31
    s_add_u32 s56, s56, s34
    s_lshl_b32 s56, s56, 11
    s_add_u32 s56, s56, s1
    s_lshl_b32 s99, s10, 7
    s_lshl_b32 s31, s34, 6
    s_add_u32 s99, s99, s31
    s_lshl_b32 s58, s27, 1
    s_add_u32 s58, s58, s33
    s_mul_i32 s58, s58, 28672
    s_add_u32 s58, s58, s99
    s_cmp_eq_u32 s10, 7
    s_cselect_b32 s58, 0x7f000000, s58
    v_and_b32 v1, 31, v0
    v_lshrrev_b32 v2, 5, v0
    v_lshlrev_b32 v2, 5, v2
    v_mul_u32_u24 v1, 896, v1
    v_add_u32 v1, v1, v2
    s_mov_b32 s100, 0x3f80
    s_mov_b32 s101, 0x3f800000
    v_and_b32 v9, 31, v0
    v_bfe_u32 v10, v0, 1, 1
    v_xor_b32 v10, s34, v10
    v_lshlrev_b32 v9, 7, v9
    v_lshl_add_u32 v9, v10, 6, v9
    v_add_u32 v9, v9, v2
    s_cmp_ge_u32 s3, 4
    s_cselect_b32 s31, 66048, 0
    s_lshl_b32 s59, s33, 12
    s_add_u32 s31, s31, s59
    s_add_u32 s31, s31, 81920
    v_add_u32 v9, s31, v9
    s_add_u32 s31, s99, 156160
    v_add_u32 v10, s31, v2
    s_mul_i32 s31, s33, 28672
    s_add_u32 s31, s31, 90624
    v_add_u32 v3, s31, v5
    s_add_u32 s98, s26, 8
    s_lshl_b32 s98, s98, 14
    s_lshl_b32 s31, s32, 11
    s_add_u32 s98, s98, s31
    s_add_u32 s98, s98, s60
    ds_read_b128 v[64:67], v9 offset:0
    ds_read_b128 v[68:71], v9 offset:16
    ds_read_b128 v[72:75], v10 offset:0
    ds_read_b128 v[76:79], v10 offset:16
    v_mov_b32 v16, 0
    v_mov_b32 v17, 0
    v_mov_b32 v18, 0
    v_mov_b32 v19, 0
    v_mov_b32 v20, 0
    v_mov_b32 v21, 0
    v_mov_b32 v22, 0
    v_mov_b32 v23, 0
    v_mov_b32 v24, 0
    v_mov_b32 v25, 0
    v_mov_b32 v26, 0
    v_mov_b32 v27, 0
    v_mov_b32 v28, 0
    v_mov_b32 v29, 0
    v_mov_b32 v30, 0
    v_mov_b32 v31, 0
    s_waitcnt lgkmcnt(0)
    v_dot2c_f32_bf16 v16, s100, v64
    v_dot2c_f32_bf16 v17, s101, v64
    v_dot2c_f32_bf16 v18, s100, v65
    v_dot2c_f32_bf16 v19, s101, v65
    v_dot2c_f32_bf16 v20, s100, v66
    v_dot2c_f32_bf16 v21, s101, v66
    v_dot2c_f32_bf16 v22, s100, v67
    v_dot2c_f32_bf16 v23, s101, v67
    v_dot2c_f32_bf16 v24, s100, v68
    v_dot2c_f32_bf16 v25, s101, v68
    v_dot2c_f32_bf16 v26, s100, v69
    v_dot2c_f32_bf16 v27, s101, v69
    v_dot2c_f32_bf16 v28, s100, v70
    v_dot2c_f32_bf16 v29, s101, v70
    v_dot2c_f32_bf16 v30, s100, v71
    v_dot2c_f32_bf16 v31, s101, v71
    v_dot2c_f32_bf16 v16, s100, v72
    v_dot2c_f32_bf16 v17, s101, v72
    v_dot2c_f32_bf16 v18, s100, v73
    v_dot2c_f32_bf16 v19, s101, v73
    v_dot2c_f32_bf16 v20, s100, v74
    v_dot2c_f32_bf16 v21, s101, v74
    v_dot2c_f32_bf16 v22, s100, v75
    v_dot2c_f32_bf16 v23, s101, v75
    v_dot2c_f32_bf16 v24, s100, v76
    v_dot2c_f32_bf16 v25, s101, v76
    v_dot2c_f32_bf16 v26, s100, v77
    v_dot2c_f32_bf16 v27, s101, v77
    v_dot2c_f32_bf16 v28, s100, v78
    v_dot2c_f32_bf16 v29, s101, v78
    v_dot2c_f32_bf16 v30, s100, v79
    v_dot2c_f32_bf16 v31, s101, v79
    s_mov_b32 s44, s20
    s_mov_b32 s45, s21
    s_mov_b32 s46, 1835008
    s_mov_b32 s47, 0x20000
    s_branch L_y1
L_y0:
    s_cmp_lg_u32 s3, 7
    s_cbranch_scc1 L_y2
    s_mov_b64 exec, 0x9000
    buffer_load_dword v253, v13, s[48:51], s96 offen sc1
    s_mov_b64 exec, -1
L_y2:
    ds_read_b64_tr_b16 v[224:225], v8 offset:0
    ds_read_b64_tr_b16 v[226:227], v8 offset:512
    ds_read_b64_tr_b16 v[228:229], v8 offset:2048
    ds_read_b64_tr_b16 v[230:231], v8 offset:2560
    ds_read_b64_tr_b16 v[232:233], v8 offset:4096
    ds_read_b64_tr_b16 v[234:235], v8 offset:4608
    ds_read_b64_tr_b16 v[236:237], v8 offset:6144
    ds_read_b64_tr_b16 v[238:239], v8 offset:6656
    s_waitcnt lgkmcnt(8)
    s_barrier
    s_cmp_lg_u32 s3, 7
    s_cbranch_scc1 L_g0
    s_waitcnt vmcnt(0)
    v_cmp_eq_u32 vcc, 1, v253
    s_nop 0
    s_and_b32 s31, vcc_lo, 0x9000
    s_cmp_eq_u32 s31, 0x9000
    s_cbranch_scc1 L_watcheda
    s_mov_b32 exec_lo, 36864
    s_mov_b32 exec_hi, 0
    s_mov_b32 s63, 4194304
L_watcha:
    buffer_load_dword v254, v13, s[48:51], s96 offen sc1
    s_waitcnt vmcnt(0)
    v_cmp_eq_u32 vcc, 1, v254
    s_nop 0
    s_cmp_eq_u32 vcc_lo, 36864
    s_cbranch_scc1 L_watcheda
    s_sub_u32 s63, s63, 1
    s_cmp_lg_u32 s63, 0
    s_cbranch_scc1 L_watcha
L_watcheda:
    s_mov_b64 exec, -1
    s_barrier
    ds_read_b64_tr_b16 v[160:161], v8 offset:16384
    ds_read_b64_tr_b16 v[162:163], v8 offset:16896
    ds_read_b64_tr_b16 v[164:165], v8 offset:18432
    ds_read_b64_tr_b16 v[166:167], v8 offset:18944
    ds_read_b64_tr_b16 v[168:169], v8 offset:20480
    ds_read_b64_tr_b16 v[170:171], v8 offset:20992
    ds_read_b64_tr_b16 v[172:173], v8 offset:22528
    ds_read_b64_tr_b16 v[174:175], v8 offset:23040
    ds_read_b64_tr_b16 v[176:177], v8 offset:32768
    ds_read_b64_tr_b16 v[178:179], v8 offset:33280
    ds_read_b64_tr_b16 v[180:181], v8 offset:34816
    ds_read_b64_tr_b16 v[182:183], v8 offset:35328
    ds_read_b64_tr_b16 v[184:185], v8 offset:36864
    ds_read_b64_tr_b16 v[186:187], v8 offset:37376
    ds_read_b64_tr_b16 v[188:189], v8 offset:38912
    ds_read_b64_tr_b16 v[190:191], v8 offset:39424
    ds_read_b128 v[64:67], v9 offset:0
    ds_read_b128 v[68:71], v9 offset:16
    ds_read_b128 v[72:75], v10 offset:0
    ds_read_b128 v[76:79], v10 offset:16
    v_mov_b32 v16, 0
    v_mov_b32 v17, 0
    v_mov_b32 v18, 0
    v_mov_b32 v19, 0
    v_mov_b32 v20, 0
    v_mov_b32 v21, 0
    v_mov_b32 v22, 0
    v_mov_b32 v23, 0
    v_mov_b32 v24, 0
    v_mov_b32 v25, 0
    v_mov_b32 v26, 0
    v_mov_b32 v27, 0
    v_mov_b32 v28, 0
    v_mov_b32 v29, 0
    v_mov_b32 v30, 0
    v_mov_b32 v31, 0
    s_waitcnt lgkmcnt(0)
    v_dot2c_f32_bf16 v16, s100, v64
    v_dot2c_f32_bf16 v17, s101, v64
    v_dot2c_f32_bf16 v18, s100, v65
    v_dot2c_f32_bf16 v19, s101, v65
    v_dot2c_f32_bf16 v20, s100, v66
    v_dot2c_f32_bf16 v21, s101, v66
    v_dot2c_f32_bf16 v22, s100, v67
    v_dot2c_f32_bf16 v23, s101, v67
    v_dot2c_f32_bf16 v24, s100, v68
    v_dot2c_f32_bf16 v25, s101, v68
    v_dot2c_f32_bf16 v26, s100, v69
    v_dot2c_f32_bf16 v27, s101, v69
    v_dot2c_f32_bf16 v28, s100, v70
    v_dot2c_f32_bf16 v29, s101, v70
    v_dot2c_f32_bf16 v30, s100, v71
    v_dot2c_f32_bf16 v31, s101, v71
    v_dot2c_f32_bf16 v16, s100, v72
    v_dot2c_f32_bf16 v17, s101, v72
    v_dot2c_f32_bf16 v18, s100, v73
    v_dot2c_f32_bf16 v19, s101, v73
    v_dot2c_f32_bf16 v20, s100, v74
    v_dot2c_f32_bf16 v21, s101, v74
    v_dot2c_f32_bf16 v22, s100, v75
    v_dot2c_f32_bf16 v23, s101, v75
    v_dot2c_f32_bf16 v24, s100, v76
    v_dot2c_f32_bf16 v25, s101, v76
    v_dot2c_f32_bf16 v26, s100, v77
    v_dot2c_f32_bf16 v27, s101, v77
    v_dot2c_f32_bf16 v28, s100, v78
    v_dot2c_f32_bf16 v29, s101, v78
    v_dot2c_f32_bf16 v30, s100, v79
    v_dot2c_f32_bf16 v31, s101, v79
    s_mov_b32 exec_lo, 24576
    s_mov_b32 exec_hi, 0
    s_mov_b32 s63, 4194304
L_watchb:
    buffer_load_dword v254, v13, s[48:51], s96 offen sc1
    s_waitcnt vmcnt(0)
    v_cmp_eq_u32 vcc, 1, v254
    s_nop 0
    s_cmp_eq_u32 vcc_lo, 24576
    s_cbranch_scc1 L_watchedb
    s_sub_u32 s63, s63, 1
    s_cmp_lg_u32 s63, 0
    s_cbranch_scc1 L_watchb
L_watchedb:
    s_mov_b64 exec, -1
    s_barrier
    s_branch L_h0
    s_branch L_page12
.p2align 12
L_stub_L1:
    s_branch L_warm2
    s_nop 0
L_page12:
L_g0:
    s_barrier
    s_add_u32 m0, s35, 90624
    s_add_u32 s59, s57, 0
    buffer_load_dwordx4 v5, s[48:51], s59 offen sc1 lds
    s_add_u32 m0, s35, 119296
    s_add_u32 s59, s57, 65536
    buffer_load_dwordx4 v5, s[48:51], s59 offen sc1 lds
    s_add_u32 m0, s35, 112128
    s_add_u32 s59, s57, 49152
    buffer_load_dwordx4 v5, s[48:51], s59 offen sc1 lds
    s_add_u32 m0, s35, 140800
    s_add_u32 s59, s57, 114688
    buffer_load_dwordx4 v5, s[48:51], s59 offen sc1 lds
    ds_read_b64_tr_b16 v[160:161], v8 offset:16384
    ds_read_b64_tr_b16 v[162:163], v8 offset:16896
    ds_read_b64_tr_b16 v[164:165], v8 offset:18432
    ds_read_b64_tr_b16 v[166:167], v8 offset:18944
    ds_read_b64_tr_b16 v[168:169], v8 offset:20480
    ds_read_b64_tr_b16 v[170:171], v8 offset:20992
    ds_read_b64_tr_b16 v[172:173], v8 offset:22528
    ds_read_b64_tr_b16 v[174:175], v8 offset:23040
    ds_read_b64_tr_b16 v[176:177], v8 offset:32768
    ds_read_b64_tr_b16 v[178:179], v8 offset:33280
    ds_read_b64_tr_b16 v[180:181], v8 offset:34816
    ds_read_b64_tr_b16 v[182:183], v8 offset:35328
    ds_read_b64_tr_b16 v[184:185], v8 offset:36864
    ds_read_b64_tr_b16 v[186:187], v8 offset:37376
    ds_read_b64_tr_b16 v[188:189], v8 offset:38912
    ds_read_b64_tr_b16 v[190:191], v8 offset:39424
    ds_read_b128 v[64:67], v9 offset:0
    ds_read_b128 v[68:71], v9 offset:16
    ds_read_b128 v[72:75], v10 offset:0
    ds_read_b128 v[76:79], v10 offset:16
    v_mov_b32 v16, 0
    v_mov_b32 v17, 0
    v_mov_b32 v18, 0
    v_mov_b32 v19, 0
    v_mov_b32 v20, 0
    v_mov_b32 v21, 0
    v_mov_b32 v22, 0
    v_mov_b32 v23, 0
    v_mov_b32 v24, 0
    v_mov_b32 v25, 0
    v_mov_b32 v26, 0
    v_mov_b32 v27, 0
    v_mov_b32 v28, 0
    v_mov_b32 v29, 0
    v_mov_b32 v30, 0
    v_mov_b32 v31, 0
    s_waitcnt lgkmcnt(0)
    v_dot2c_f32_bf16 v16, s100, v64
    v_dot2c_f32_bf16 v17, s101, v64
    v_dot2c_f32_bf16 v18, s100, v65
    v_dot2c_f32_bf16 v19, s101, v65
    v_dot2c_f32_bf16 v20, s100, v66
    v_dot2c_f32_bf16 v21, s101, v66
    v_dot2c_f32_bf16 v22, s100, v67
    v_dot2c_f32_bf16 v23, s101, v67
    v_dot2c_f32_bf16 v24, s100, v68
    v_dot2c_f32_bf16 v25, s101, v68
    v_dot2c_f32_bf16 v26, s100, v69
    v_dot2c_f32_bf16 v27, s101, v69
    v_dot2c_f32_bf16 v28, s100, v70
    v_dot2c_f32_bf16 v29, s101, v70
    v_dot2c_f32_bf16 v30, s100, v71
    v_dot2c_f32_bf16 v31, s101, v71
    v_dot2c_f32_bf16 v16, s100, v72
    v_dot2c_f32_bf16 v17, s101, v72
    v_dot2c_f32_bf16 v18, s100, v73
    v_dot2c_f32_bf16 v19, s101, v73
    v_dot2c_f32_bf16 v20, s100, v74
    v_dot2c_f32_bf16 v21, s101, v74
    v_dot2c_f32_bf16 v22, s100, v75
    v_dot2c_f32_bf16 v23, s101, v75
    v_dot2c_f32_bf16 v24, s100, v76
    v_dot2c_f32_bf16 v25, s101, v76
    v_dot2c_f32_bf16 v26, s100, v77
    v_dot2c_f32_bf16 v27, s101, v77
    v_dot2c_f32_bf16 v28, s100, v78
    v_dot2c_f32_bf16 v29, s101, v78
    v_dot2c_f32_bf16 v30, s100, v79
    v_dot2c_f32_bf16 v31, s101, v79
L_y1:
    s_waitcnt vmcnt(0) lgkmcnt(0)
    s_barrier
    s_add_u32 m0, s35, 97792
    s_add_u32 s59, s57, 16384
    buffer_load_dwordx4 v5, s[48:51], s59 offen sc1 lds
    s_add_u32 m0, s35, 126464
    s_add_u32 s59, s57, 81920
    buffer_load_dwordx4 v5, s[48:51], s59 offen sc1 lds
    s_add_u32 m0, s35, 104960
    s_add_u32 s59, s57, 32768
    buffer_load_dwordx4 v5, s[48:51], s59 offen sc1 lds
    s_add_u32 m0, s35, 133632
    s_add_u32 s59, s57, 98304
    buffer_load_dwordx4 v5, s[48:51], s59 offen sc1 lds
L_h0:
    s_cmp_lt_u32 s3, 4
    s_cbranch_scc1 L_i0
    s_setprio 1
L_mma:
    ds_read_b128 v[96:99], v3 offset:0
    ds_read_b128 v[100:103], v3 offset:1024
    ds_read_b128 v[104:107], v3 offset:2048
    ds_read_b128 v[108:111], v3 offset:3072
    ds_read_b128 v[112:115], v3 offset:4096
    ds_read_b128 v[116:119], v3 offset:5120
    s_waitcnt lgkmcnt(5)
    v_mfma_f32_32x32x16_bf16 v[16:31], v[128:131], v[96:99], v[16:31]
    ds_read_b128 v[120:123], v3 offset:6144
    s_waitcnt lgkmcnt(5)
    v_mfma_f32_32x32x16_bf16 v[16:31], v[132:135], v[100:103], v[16:31]
    ds_read_b128 v[124:127], v3 offset:21504
    s_waitcnt lgkmcnt(5)
    v_mfma_f32_32x32x16_bf16 v[16:31], v[136:139], v[104:107], v[16:31]
    ds_read_b128 v[96:99], v3 offset:22528
    s_waitcnt lgkmcnt(5)
    v_mfma_f32_32x32x16_bf16 v[16:31], v[140:143], v[108:111], v[16:31]
    ds_read_b128 v[100:103], v3 offset:23552
    s_waitcnt lgkmcnt(5)
    v_mfma_f32_32x32x16_bf16 v[16:31], v[144:147], v[112:115], v[16:31]
    ds_read_b128 v[104:107], v3 offset:24576
    s_waitcnt lgkmcnt(5)
    v_mfma_f32_32x32x16_bf16 v[16:31], v[148:151], v[116:119], v[16:31]
    ds_read_b128 v[108:111], v3 offset:25600
    s_waitcnt lgkmcnt(5)
    v_mfma_f32_32x32x16_bf16 v[16:31], v[152:155], v[120:123], v[16:31]
    ds_read_b128 v[112:115], v3 offset:26624
    s_waitcnt lgkmcnt(5)
    v_mfma_f32_32x32x16_bf16 v[16:31], v[212:215], v[124:127], v[16:31]
    ds_read_b128 v[116:119], v3 offset:27648
    s_waitcnt lgkmcnt(5)
    v_mfma_f32_32x32x16_bf16 v[16:31], v[216:219], v[96:99], v[16:31]
    s_waitcnt lgkmcnt(4)
    v_mfma_f32_32x32x16_bf16 v[16:31], v[220:223], v[100:103], v[16:31]
    s_waitcnt lgkmcnt(3)
    v_mfma_f32_32x32x16_bf16 v[16:31], v[224:227], v[104:107], v[16:31]
    s_waitcnt lgkmcnt(2)
    v_mfma_f32_32x32x16_bf16 v[16:31], v[228:231], v[108:111], v[16:31]
    s_waitcnt lgkmcnt(1)
    v_mfma_f32_32x32x16_bf16 v[16:31], v[232:235], v[112:115], v[16:31]
    s_waitcnt lgkmcnt(0)
    v_mfma_f32_32x32x16_bf16 v[16:31], v[236:239], v[116:119], v[16:31]
    s_cbranch_scc1 L_mmb
L_i0:
    ds_read_b64_tr_b16 v[192:193], v8 offset:49152
    ds_read_b64_tr_b16 v[194:195], v8 offset:49664
    ds_read_b64_tr_b16 v[196:197], v8 offset:51200
    ds_read_b64_tr_b16 v[198:199], v8 offset:51712
    ds_read_b64_tr_b16 v[200:201], v8 offset:53248
    ds_read_b64_tr_b16 v[202:203], v8 offset:53760
    ds_read_b64_tr_b16 v[204:205], v8 offset:55296
    ds_read_b64_tr_b16 v[206:207], v8 offset:55808
    s_waitcnt vmcnt(0) lgkmcnt(0)
    s_barrier
    s_cmp_lt_u32 s3, 4
    s_cbranch_scc1 L_x5
L_mmb:
    ds_read_b128 v[120:123], v3 offset:7168
    ds_read_b128 v[124:127], v3 offset:8192
    ds_read_b128 v[96:99], v3 offset:9216
    ds_read_b128 v[100:103], v3 offset:10240
    ds_read_b128 v[104:107], v3 offset:11264
    ds_read_b128 v[108:111], v3 offset:12288
    s_waitcnt lgkmcnt(5)
    v_mfma_f32_32x32x16_bf16 v[16:31], v[156:159], v[120:123], v[16:31]
    ds_read_b128 v[112:115], v3 offset:13312
    s_waitcnt lgkmcnt(5)
    v_mfma_f32_32x32x16_bf16 v[16:31], v[160:163], v[124:127], v[16:31]
    ds_read_b128 v[116:119], v3 offset:14336
    s_waitcnt lgkmcnt(5)
    v_mfma_f32_32x32x16_bf16 v[16:31], v[164:167], v[96:99], v[16:31]
    ds_read_b128 v[120:123], v3 offset:15360
    s_waitcnt lgkmcnt(5)
    v_mfma_f32_32x32x16_bf16 v[16:31], v[168:171], v[100:103], v[16:31]
    ds_read_b128 v[124:127], v3 offset:16384
    s_waitcnt lgkmcnt(5)
    v_mfma_f32_32x32x16_bf16 v[16:31], v[172:175], v[104:107], v[16:31]
    ds_read_b128 v[96:99], v3 offset:17408
    s_waitcnt lgkmcnt(5)
    v_mfma_f32_32x32x16_bf16 v[16:31], v[176:179], v[108:111], v[16:31]
    ds_read_b128 v[100:103], v3 offset:18432
    s_waitcnt lgkmcnt(5)
    v_mfma_f32_32x32x16_bf16 v[16:31], v[180:183], v[112:115], v[16:31]
    ds_read_b128 v[104:107], v3 offset:19456
    s_waitcnt lgkmcnt(5)
    v_mfma_f32_32x32x16_bf16 v[16:31], v[184:187], v[116:119], v[16:31]
    ds_read_b128 v[108:111], v3 offset:20480
    s_waitcnt lgkmcnt(5)
    v_mfma_f32_32x32x16_bf16 v[16:31], v[188:191], v[120:123], v[16:31]
    s_waitcnt lgkmcnt(4)
    v_mfma_f32_32x32x16_bf16 v[16:31], v[192:195], v[124:127], v[16:31]
    s_waitcnt lgkmcnt(3)
    v_mfma_f32_32x32x16_bf16 v[16:31], v[196:199], v[96:99], v[16:31]
    s_waitcnt lgkmcnt(2)
    v_mfma_f32_32x32x16_bf16 v[16:31], v[200:203], v[100:103], v[16:31]
    s_waitcnt lgkmcnt(1)
    v_mfma_f32_32x32x16_bf16 v[16:31], v[204:207], v[104:107], v[16:31]
    s_waitcnt lgkmcnt(0)
    v_mfma_f32_32x32x16_bf16 v[16:31], v[208:211], v[108:111], v[16:31]
    s_cbranch_scc1 L_i1
    s_nop 10
    v_cvt_pk_bf16_f32 v16, v16, v17
    v_cvt_pk_bf16_f32 v17, v18, v19
    v_cvt_pk_bf16_f32 v18, v20, v21
    v_cvt_pk_bf16_f32 v19, v22, v23
    v_cvt_pk_bf16_f32 v20, v24, v25
    v_cvt_pk_bf16_f32 v21, v26, v27
    v_cvt_pk_bf16_f32 v22, v28, v29
    v_cvt_pk_bf16_f32 v23, v30, v31
    buffer_store_dwordx4 v[16:19], v5, s[48:51], s98 offen sc1
    buffer_store_dwordx4 v[20:23], v5, s[48:51], s98 offen offset:1024 sc1
    s_waitcnt vmcnt(0)
    s_barrier
    s_cmp_lg_u32 s3, 7
    s_cbranch_scc1 L_x8
    s_lshl_b64 exec, 1, s26
    buffer_store_dword v14, v15, s[48:51], s96 offen sc1
    s_mov_b64 exec, -1
    s_cmp_eq_u32 s26, 3
    s_cbranch_scc1 L_x8
    s_mov_b32 s97, 240
    s_mov_b32 exec_lo, s97
    s_mov_b32 exec_hi, 0
    s_mov_b32 s63, 4194304
L_watchg:
    buffer_load_dword v254, v13, s[48:51], s96 offen sc1
    s_waitcnt vmcnt(0)
    v_cmp_eq_u32 vcc, 1, v254
    s_nop 0
    s_cmp_eq_u32 vcc_lo, s97
    s_cbranch_scc1 L_watchedg
    s_sub_u32 s63, s63, 1
    s_cmp_lg_u32 s63, 0
    s_cbranch_scc1 L_watchg
L_watchedg:
    s_mov_b64 exec, -1
    s_branch L_x8
L_x5:
    s_mov_b64 vcc, -1
    s_barrier
    s_cmp_lg_u32 s10, 7
    s_cbranch_scc1 L_mma
L_i1:
    s_barrier
    s_cmp_eq_u32 s10, 7
    s_cbranch_scc1 L_rdone
    buffer_load_dwordx4 v[32:35], v5, s[48:51], s56 offen offset:0 sc1
    buffer_load_dwordx4 v[36:39], v5, s[48:51], s56 offen offset:1024 sc1
    s_add_u32 s56, s56, 114688
    buffer_load_dwordx4 v[40:43], v5, s[48:51], s56 offen offset:0 sc1
    buffer_load_dwordx4 v[44:47], v5, s[48:51], s56 offen offset:1024 sc1
    s_add_u32 s56, s56, 114688
    buffer_load_dwordx4 v[48:51], v5, s[48:51], s56 offen offset:0 sc1
    buffer_load_dwordx4 v[52:55], v5, s[48:51], s56 offen offset:1024 sc1
    s_add_u32 s56, s56, 114688
    buffer_load_dwordx4 v[56:59], v5, s[48:51], s56 offen offset:0 sc1
    buffer_load_dwordx4 v[60:63], v5, s[48:51], s56 offen offset:1024 sc1
    s_waitcnt vmcnt(7)
    v_dot2c_f32_bf16 v16, s100, v32
    v_dot2c_f32_bf16 v17, s101, v32
    v_dot2c_f32_bf16 v18, s100, v33
    v_dot2c_f32_bf16 v19, s101, v33
    v_dot2c_f32_bf16 v20, s100, v34
    v_dot2c_f32_bf16 v21, s101, v34
    v_dot2c_f32_bf16 v22, s100, v35
    v_dot2c_f32_bf16 v23, s101, v35
    s_waitcnt vmcnt(6)
    v_dot2c_f32_bf16 v24, s100, v36
    v_dot2c_f32_bf16 v25, s101, v36
    v_dot2c_f32_bf16 v26, s100, v37
    v_dot2c_f32_bf16 v27, s101, v37
    v_dot2c_f32_bf16 v28, s100, v38
    v_dot2c_f32_bf16 v29, s101, v38
    v_dot2c_f32_bf16 v30, s100, v39
    v_dot2c_f32_bf16 v31, s101, v39
    s_waitcnt vmcnt(5)
    v_dot2c_f32_bf16 v16, s100, v40
    v_dot2c_f32_bf16 v17, s101, v40
    v_dot2c_f32_bf16 v18, s100, v41
    v_dot2c_f32_bf16 v19, s101, v41
    v_dot2c_f32_bf16 v20, s100, v42
    v_dot2c_f32_bf16 v21, s101, v42
    v_dot2c_f32_bf16 v22, s100, v43
    v_dot2c_f32_bf16 v23, s101, v43
    s_waitcnt vmcnt(4)
    v_dot2c_f32_bf16 v24, s100, v44
    v_dot2c_f32_bf16 v25, s101, v44
    v_dot2c_f32_bf16 v26, s100, v45
    v_dot2c_f32_bf16 v27, s101, v45
    v_dot2c_f32_bf16 v28, s100, v46
    v_dot2c_f32_bf16 v29, s101, v46
    v_dot2c_f32_bf16 v30, s100, v47
    v_dot2c_f32_bf16 v31, s101, v47
    s_waitcnt vmcnt(3)
    v_dot2c_f32_bf16 v16, s100, v48
    v_dot2c_f32_bf16 v17, s101, v48
    v_dot2c_f32_bf16 v18, s100, v49
    v_dot2c_f32_bf16 v19, s101, v49
    v_dot2c_f32_bf16 v20, s100, v50
    v_dot2c_f32_bf16 v21, s101, v50
    v_dot2c_f32_bf16 v22, s100, v51
    v_dot2c_f32_bf16 v23, s101, v51
    s_waitcnt vmcnt(2)
    v_dot2c_f32_bf16 v24, s100, v52
    v_dot2c_f32_bf16 v25, s101, v52
    v_dot2c_f32_bf16 v26, s100, v53
    v_dot2c_f32_bf16 v27, s101, v53
    v_dot2c_f32_bf16 v28, s100, v54
    v_dot2c_f32_bf16 v29, s101, v54
    v_dot2c_f32_bf16 v30, s100, v55
    v_dot2c_f32_bf16 v31, s101, v55
    s_waitcnt vmcnt(1)
    v_dot2c_f32_bf16 v16, s100, v56
    v_dot2c_f32_bf16 v17, s101, v56
    v_dot2c_f32_bf16 v18, s100, v57
    v_dot2c_f32_bf16 v19, s101, v57
    v_dot2c_f32_bf16 v20, s100, v58
    v_dot2c_f32_bf16 v21, s101, v58
    v_dot2c_f32_bf16 v22, s100, v59
    v_dot2c_f32_bf16 v23, s101, v59
    s_waitcnt vmcnt(0)
    v_dot2c_f32_bf16 v24, s100, v60
    v_dot2c_f32_bf16 v25, s101, v60
    v_dot2c_f32_bf16 v26, s100, v61
    v_dot2c_f32_bf16 v27, s101, v61
    v_dot2c_f32_bf16 v28, s100, v62
    v_dot2c_f32_bf16 v29, s101, v62
    v_dot2c_f32_bf16 v30, s100, v63
    v_dot2c_f32_bf16 v31, s101, v63
    v_cvt_pk_bf16_f32 v32, v16, v17
    v_cvt_pk_bf16_f32 v33, v18, v19
    v_cvt_pk_bf16_f32 v34, v20, v21
    v_cvt_pk_bf16_f32 v35, v22, v23
    v_cvt_pk_bf16_f32 v36, v24, v25
    v_cvt_pk_bf16_f32 v37, v26, v27
    v_cvt_pk_bf16_f32 v38, v28, v29
    v_cvt_pk_bf16_f32 v39, v30, v31
    buffer_store_dwordx4 v[32:35], v1, s[44:47], s58 offen offset:0
    buffer_store_dwordx4 v[36:39], v1, s[44:47], s58 offen offset:16
L_rdone:
    s_endpgm
L_x8:
    s_barrier
    s_branch L_rdone
L_ack_f:
    s_mov_b32 s63, 4194304
L_ackl_f:
    buffer_load_dword v253, v252, s[52:55], s0 offen sc1
    s_waitcnt vmcnt(0)
    v_readfirstlane_b32 s31, v253
    s_nop 0
    s_cmp_lg_u32 s31, 0
    s_cbranch_scc1 L_ackd_f
    s_sub_u32 s63, s63, 1
    s_cmp_lg_u32 s63, 0
    s_cbranch_scc1 L_ackl_f
    s_branch L_ackd_f
L_ack_b:
    s_mov_b32 s63, 4194304
L_ackl_b:
    buffer_load_dword v253, v252, s[52:55], s0 offen sc1
    s_waitcnt vmcnt(0)
    v_readfirstlane_b32 s31, v253
    s_nop 0
    s_cmp_lg_u32 s31, 0
    s_cbranch_scc1 L_ackd_b
    s_sub_u32 s63, s63, 1
    s_cmp_lg_u32 s63, 0
    s_cbranch_scc1 L_ackl_b
    s_branch L_ackd_b
L_ack_c:
    s_mov_b32 s63, 4194304
L_ackl_c:
    buffer_load_dword v253, v252, s[52:55], s0 offen sc1
    s_waitcnt vmcnt(0)
    v_readfirstlane_b32 s31, v253
    s_nop 0
    s_cmp_lg_u32 s31, 0
    s_cbranch_scc1 L_ackd_c
    s_sub_u32 s63, s63, 1
    s_cmp_lg_u32 s63, 0
    s_cbranch_scc1 L_ackl_c
    s_branch L_ackd_c
L_ack_a:
    s_mov_b32 s63, 4194304
L_ackl_a:
    buffer_load_dword v253, v252, s[52:55], s0 offen sc1
    s_waitcnt vmcnt(0)
    v_readfirstlane_b32 s31, v253
    s_nop 0
    s_cmp_lg_u32 s31, 0
    s_cbranch_scc1 L_ackd_a
    s_sub_u32 s63, s63, 1
    s_cmp_lg_u32 s63, 0
    s_cbranch_scc1 L_ackl_a
    s_branch L_ackd_a
L_end:
    s_endpgm
.section .rodata,"a"
.p2align 6
.amdhsa_kernel parallel_sum__sliding_local_dilated__dense_activation_gelu__prompt_kernel
  .amdhsa_next_free_vgpr 256
  .amdhsa_next_free_sgpr 102
  .amdhsa_accum_offset 256
  .amdhsa_group_segment_fixed_size 0
  .amdhsa_kernarg_size 88
  .amdhsa_user_sgpr_count 2
  .amdhsa_user_sgpr_kernarg_segment_ptr 1
  .amdhsa_system_sgpr_workgroup_id_x 1
.end_amdhsa_kernel
```
